```python
import torch

def _softmax(x, axis=-1):
    return torch.softmax(x, dim=axis)
def _gelu(x):
    return torch.nn.functional.gelu(x, approximate="tanh")
def _silu(x):
    return torch.nn.functional.silu(x)
def _sigmoid(x):
    return torch.sigmoid(x)
def _layernorm(x, axis=-1, eps=1e-5):
    m = x.mean(dim=axis, keepdim=True)
    v = x.var(dim=axis, keepdim=True, unbiased=False)
    return (x - m) / torch.sqrt(v + eps)
def _scatter_add(tgt, idx, src, axis=0):
    return tgt.clone().index_add_(axis, idx, src)
def _segment_sum(src, seg, n):
    out = torch.zeros((n,) + src.shape[1:], dtype=src.dtype)
    return out.index_add_(0, seg, src)
def _pad(x, pw):
    flat = tuple(v for pair in reversed(pw) for v in pair)
    return torch.nn.functional.pad(x, flat)

kernel_name = 'parallel_sum__sliding_local_dilated__geglu_ffn__prompt'

def setup_inputs():

    _w = (lambda a: (lambda t: t.to(torch.bfloat16) if t.is_floating_point() else t)(torch.as_tensor(a)))
    def _A_setup():
        B, S, D = 1, 2048, 512
        return {
            "x": _w((lambda *s: torch.randn(*s, dtype=torch.bfloat16) * 0.05)(B, S, D)),
            "wqkv": _w((lambda *s: torch.randn(*s, dtype=torch.bfloat16) * 0.05)(D, 3 * D)),
            "wo": _w((lambda *s: torch.randn(*s, dtype=torch.bfloat16) * 0.05)(D, D)),
        }
    _A_in = _A_setup()

    def _B_setup():
        B, S, D, F = 1, 2048, 512, 1376
        return {
            "x": _w((lambda *s: torch.randn(*s, dtype=torch.bfloat16) * 0.05)(B, S, D)),
            "w_gate": _w((lambda *s: torch.randn(*s, dtype=torch.bfloat16) * 0.05)(D, F)),
            "w_up": _w((lambda *s: torch.randn(*s, dtype=torch.bfloat16) * 0.05)(D, F)),
            "w_down": _w((lambda *s: torch.randn(*s, dtype=torch.bfloat16) * 0.05)(F, D)),
        }
    _B_in = _B_setup()

    return {
        "A_x": _A_in["x"],
        "A_wqkv": _A_in["wqkv"],
        "A_wo": _A_in["wo"],
        "B_x": _B_in["x"],
        "B_w_gate": _B_in["w_gate"],
        "B_w_up": _B_in["w_up"],
        "B_w_down": _B_in["w_down"],
    }

def reference(A_x, A_wqkv, A_wo, B_x, B_w_gate, B_w_up, B_w_down):
    def _A_ref(x, wqkv, wo):
        B, S, D = x.shape
        H = 32; Dh = D // H
        W, dil = 8, 2
        qkv = (lambda x, *d: x.permute(*d))((x @ wqkv).reshape(B, S, 3, H, Dh), 2, 0, 3, 1, 4)
        q, k, v = qkv[0], qkv[1], qkv[2]
        scale = Dh ** -0.5
        pos = torch.arange(S)
        off = torch.arange(W) * dil
        idx = pos[:, None] - off[None, :]
        mask = idx >= 0
        idx_c = torch.where(mask, idx, 0).reshape(-1)
        kg = k[:, :, idx_c, :].reshape(B, H, S, W, Dh)
        vg = v[:, :, idx_c, :].reshape(B, H, S, W, Dh)
        logits = torch.einsum("bhsd,bhswd->bhsw", q, kg) * scale
        logits = torch.where(mask[None, None, :, :], logits, -1e9)
        attn = _softmax(logits, axis=-1)
        o = torch.einsum("bhsw,bhswd->bhsd", attn, vg)
        return (lambda x, *d: x.permute(*d))(o, 0, 2, 1, 3).reshape(B, S, D) @ wo

    def _B_ref(x, w_gate, w_up, w_down):
        return (_gelu(x @ w_gate) * (x @ w_up)) @ w_down

    x = A_x
    xn = _layernorm(x, axis=-1)
    return x + _A_ref(xn, A_wqkv, A_wo) + _B_ref(xn, B_w_gate, B_w_up, B_w_down)
```

```asm
; @launch grid=(256,1,1) block=(256,1,1) lds=163840
.amdgcn_target "amdgcn-amd-amdhsa--gfx950"
.text
.globl parallel_sum__sliding_local_dilated__geglu_ffn__prompt_kernel
.p2align 8
.type parallel_sum__sliding_local_dilated__geglu_ffn__prompt_kernel,@function
parallel_sum__sliding_local_dilated__geglu_ffn__prompt_kernel:
  s_cmp_ge_u32 s2, 0x100
  s_cbranch_scc1 L_end
  s_load_dwordx16 s[4:19], s[0:1], 0
  s_load_dwordx4 s[20:23], s[0:1], 64
  v_lshrrev_b32 v1, 6, v0
  s_and_b32 s86, s2, 7
  s_lshr_b32 s87, s2, 3
  v_readfirstlane_b32 s26, v1
  v_and_b32 v0, 63, v0
  s_and_b32 s88, s86, 1
  s_lshl_b32 s88, s88, 3
  s_and_b32 s89, s87, 7
  s_add_u32 s24, s88, s89
  s_lshr_b32 s88, s86, 1
  s_lshl_b32 s88, s88, 2
  s_lshr_b32 s89, s87, 3
  s_add_u32 s30, s88, s89
  s_lshr_b32 s89, s87, 4
  s_bfe_u32 s88, s87, 0x10002
  s_lshl1_add_u32 s89, s89, s88
  s_lshl2_add_u32 s27, s86, s89
  s_bfe_u32 s88, s87, 0x10003
  s_and_b32 s89, s87, 3
  s_lshl2_add_u32 s28, s88, s89
  s_lshr_b32 s25, s30, 1
  s_and_b32 s31, s24, 7
  s_bitcmp1_b32 s30, 0
  s_cbranch_scc1 L_pathB
  v_and_b32 v5, 7, v0
  v_lshrrev_b32 v6, 4, v0
  v_xor_b32 v5, v5, v6
  v_lshlrev_b32 v5, 4, v5
  v_lshrrev_b32 v6, 3, v0
  v_lshlrev_b32 v6, 11, v6
  s_lshl_b32 s86, s24, 17
  s_lshl_b32 s87, s26, 15
  s_add_u32 s86, s86, s87
  s_add_u32 s86, s86, 0x1000
  v_add_u32 v6, s86, v6
  v_add_u32 v1, v6, v5
  v_xor_b32 v5, 64, v5
  v_add_u32 v5, v6, v5
  v_add_u32 v2, 0x3c00, v5
  v_add_u32 v3, 0xfffffc00, v1
  v_add_u32 v4, 0x3800, v5
  v_lshrrev_b32 v6, 5, v0
  s_lshl_b32 s86, s24, 7
  s_lshl3_add_u32 s86, s30, s86
  s_lshl1_add_u32 s86, s26, s86
  v_add_u32 v6, s86, v6
  v_and_b32 v5, 31, v0
  v_lshlrev_b32 v5, 5, v5
  v_lshl_add_u32 v5, v6, 10, v5
  v_add_u32 v5, 0x1000, v5
  s_and_b32 s86, s26, 1
  s_lshl_b32 s86, s86, 3
  s_lshr_b32 s87, s26, 1
  s_add_u32 s86, s86, s87
  s_lshl_b32 s87, s24, 7
  s_add_u32 s86, s86, s87
  s_sub_u32 s86, s86, 16
  v_lshrrev_b32 v24, 3, v0
  v_lshlrev_b32 v24, 1, v24
  v_add_u32 v24, s86, v24
  v_max_i32 v24, 0, v24
  v_lshrrev_b32 v25, 4, v0
  s_lshl_b32 s87, s26, 1
  v_add_u32 v25, s87, v25
  v_xor_b32 v25, v25, v0
  v_and_b32 v25, 7, v25
  v_lshlrev_b32 v25, 4, v25
  v_lshl_add_u32 v24, v24, 10, v25
  v_add_u32 v7, 0x1000, v24
  v_lshrrev_b32 v24, 3, v0
  s_lshl_b32 s86, s26, 3
  v_add_u32 v24, s86, v24
  v_mul_u32_u24 v24, 0xc00, v24
  s_lshl_b32 s86, s25, 7
  s_add_u32 s86, s86, 0x1000
  v_add_u32 v24, s86, v24
  v_bfe_u32 v25, v0, 4, 1
  v_lshlrev_b32 v25, 1, v25
  s_and_b32 s87, s26, 1
  s_lshl_b32 s86, s87, 2
  v_xor_b32 v25, s86, v25
  v_xor_b32 v25, v25, v0
  v_and_b32 v25, 7, v25
  v_lshl_add_u32 v18, v25, 4, v24
  v_add_u32 v19, 0xfffffc00, v18
  v_add_u32 v20, 0x800, v18
  v_add_u32 v21, 0x18000, v18
  v_add_u32 v22, 0x18000, v19
  v_add_u32 v23, 0x18000, v20
  v_lshrrev_b32 v24, 2, v0
  s_lshr_b32 s88, s26, 1
  s_lshl_b32 s86, s88, 4
  v_add_u32 v24, s86, v24
  v_mul_u32_u24 v24, 0xac0, v24
  v_lshrrev_b32 v25, 5, v0
  v_lshlrev_b32 v25, 1, v25
  v_xor_b32 v25, v25, v0
  v_and_b32 v25, 3, v25
  v_lshl_add_u32 v24, v25, 4, v24
  s_lshl_b32 s86, s25, 6
  s_add_u32 s86, s86, 0x800
  v_add_u32 v16, s86, v24
  v_add_u32 v17, 0x15800, v16
  s_lshl_b32 s83, s26, 12
  s_lshl_b32 s84, s88, 13
  s_lshl_b32 s87, s87, 10
  s_add_u32 s84, s84, s87
  s_add_u32 s84, s84, 0x4800
  s_lshl_b32 s85, s26, 9
  s_add_u32 s85, s85, 0x4000
  s_lshl_b32 s80, s31, 7
  s_mul_i32 s81, s31, 0x30000
  s_mul_i32 s82, s31, 0x2b000
  s_waitcnt lgkmcnt(0)
  s_sub_u32 s32, s4, 0x1000
  s_subb_u32 s33, s5, 0
  s_mov_b32 s34, 0x201000
  s_mov_b32 s35, 0x20000
  s_sub_u32 s36, s6, 0x1000
  s_subb_u32 s37, s7, 0
  s_mov_b32 s38, 0x181000
  s_mov_b32 s39, 0x20000
  buffer_load_dwordx4 v[8:11], v5, s[32:35], 0 offen
  buffer_load_dwordx4 v[12:15], v5, s[32:35], 0 offen offset:16
  s_bitcmp1_b32 s26, 0
  s_cselect_b32 s44, s14, s12
  s_cselect_b32 s45, s15, s13
  s_sub_u32 s40, s44, 0x1000
  s_subb_u32 s41, s45, 0
  s_mov_b32 s42, 0x159000
  s_mov_b32 s43, 0x20000
  s_add_u32 m0, s83, 0
  s_mov_b32 s48, s22
  buffer_load_dwordx4 v1, s[32:35], s80 offen lds
  s_mov_b32 s49, s23
  s_mov_b32 s50, 0x890000
  s_mov_b32 s51, 0x20000
  v_mov_b32 v28, 0x874000
  buffer_load_dword v27, v28, s[48:51], 0 offen sc1
  s_getpc_b64 s[86:87]
L_pcA:
  s_sub_u32 s86, s86, L_pcA-parallel_sum__sliding_local_dilated__geglu_ffn__prompt_kernel
  s_subb_u32 s87, s87, 0
  s_lshr_b32 s88, s2, 3
  s_lshl2_add_u32 s88, s88, s26
  s_lshl_b32 s88, s88, 9
  v_and_b32 v28, 3, v0
  v_lshl_add_u32 v28, v28, 7, s88
  v_min_u32 v28, L_end-parallel_sum__sliding_local_dilated__geglu_ffn__prompt_kernel, v28
  v_mov_b32 v29, s87
  v_add_co_u32 v28, vcc, s86, v28
  s_nop 1
  v_addc_co_u32 v29, vcc, 0, v29, vcc
  global_load_dword v30, v[28:29], off
  v_and_b32 v24, 15, v0
  v_lshrrev_b32 v25, 1, v24
  v_lshrrev_b32 v26, 4, v0
  v_xor_b32 v25, v25, v26
  v_lshlrev_b32 v25, 4, v25
  v_lshl_add_u32 v28, v24, 7, v25
  v_xor_b32 v29, 64, v28
  v_add_u32 v35, s83, v28
  v_add_u32 v31, 0xc800, v28
  v_add_u32 v37, 0xc800, v35
  v_add_u32 v33, 0x19000, v28
  v_add_u32 v39, 0x19000, v35
  v_add_u32 v36, s83, v29
  v_add_u32 v32, 0xc800, v29
  v_add_u32 v38, 0xc800, v36
  v_add_u32 v34, 0x19000, v29
  buffer_load_dwordx4 v2, s[32:35], s80 offen offset:1024 lds
  v_add_u32 v40, 0x19000, v36
  v_lshrrev_b32 v24, 5, v0
  v_lshlrev_b32 v24, 13, v24
  v_and_b32 v25, 3, v0
  v_lshl_add_u32 v24, v25, 3, v24
  v_add_u32 v50, 0x4800, v24
  v_bfe_u32 v24, v0, 4, 1
  v_bfe_u32 v25, v0, 2, 2
  v_lshl_add_u32 v51, v24, 3, v25
  v_lshrrev_b32 v25, 1, v25
  v_lshl_add_u32 v52, v24, 1, v25
  v_lshl_add_u32 v26, v51, 7, v50
  v_xor_b32 v25, s26, v52
  v_lshl_add_u32 v41, v25, 5, v26
  v_add_u32 v42, 0xc800, v41
  v_add_u32 v43, 0x19000, v41
  buffer_load_dwordx4 v3, s[32:35], s80 offen offset:2048 lds
  v_lshl_add_u32 v25, v51, 6, v50
  v_lshl_add_u32 v25, v24, 5, v25
  v_add_u32 v44, 0x1800, v25
  v_xor_b32 v45, 32, v44
  v_add_u32 v46, 0xc800, v44
  v_add_u32 v47, 0xc800, v45
  v_add_u32 v48, 0x19000, v44
  v_add_u32 v49, 0x19000, v45
  s_lshr_b32 s86, s26, 1
  s_lshl_b32 s86, s86, 10
  s_and_b32 s87, s26, 1
  s_lshl_b32 s87, s87, 5
  v_xor_b32 v53, s87, v46
  v_add_u32 v53, s86, v53
  v_bfe_u32 v24, v0, 2, 2
  v_mov_b32 v25, 0x3f803f80
  buffer_load_dwordx4 v4, s[32:35], s80 offen offset:3072 lds
  v_cmp_eq_u32 vcc, 0, v24
  s_nop 1
  v_cndmask_b32 v26, 0, v25, vcc
  v_accvgpr_write_b32 a108, v26
  v_accvgpr_write_b32 a109, v26
  v_accvgpr_write_b32 a110, v26
  v_accvgpr_write_b32 a111, v26
  v_cmp_eq_u32 vcc, 1, v24
  s_nop 1
  v_cndmask_b32 v26, 0, v25, vcc
  v_accvgpr_write_b32 a112, v26
  v_accvgpr_write_b32 a113, v26
  v_accvgpr_write_b32 a114, v26
  v_accvgpr_write_b32 a115, v26
  v_cmp_eq_u32 vcc, 2, v24
  s_nop 1
  v_cndmask_b32 v26, 0, v25, vcc
  v_accvgpr_write_b32 a116, v26
  v_accvgpr_write_b32 a117, v26
  s_add_u32 m0, s85, 0
  s_mov_b64 exec, 0xffffffff
  buffer_load_dwordx4 v7, s[32:35], s80 offen lds
  s_mov_b64 exec, -1
  s_add_u32 m0, s84, 0
  v_accvgpr_write_b32 a118, v26
  v_accvgpr_write_b32 a119, v26
  v_cmp_eq_u32 vcc, 3, v24
  s_nop 1
  v_cndmask_b32 v26, 0, v25, vcc
  v_accvgpr_write_b32 a120, v26
  v_accvgpr_write_b32 a121, v26
  v_accvgpr_write_b32 a122, v26
  s_cmp_lg_u32 s26, 0
  s_cbranch_scc1 L_nt1A
  s_call_b64 s[20:21], L_pad1A
L_nt1A:
  s_cmp_lg_u32 s26, 1
  s_cbranch_scc1 L_nt2A
  s_call_b64 s[20:21], L_pad2A
L_nt2A:
  s_cmp_lg_u32 s26, 2
  s_cbranch_scc1 L_nt3A
  s_call_b64 s[20:21], L_pad3A
L_nt3A:
  buffer_load_dwordx4 v18, s[36:39], s81 offen lds
  s_cmp_lg_u32 s26, 3
  s_cbranch_scc1 L_nt4A
  s_call_b64 s[20:21], L_pad4A
L_nt4A:
  v_accvgpr_write_b32 a123, v26
  s_add_u32 s86, s24, 1
  s_and_b32 s86, s86, 7
  s_mul_i32 s88, s86, 0xc00
  s_lshl_b32 s89, s25, 7
  s_add_u32 s88, s88, s89
  s_lshl_b32 s89, s26, 5
  s_add_u32 s88, s88, s89
  s_add_u32 s88, s88, 0x850000
  v_and_b32 v24, 15, v0
  v_lshlrev_b32 v24, 1, v24
  v_lshrrev_b32 v25, 4, v0
  buffer_load_dwordx4 v19, s[36:39], s81 offen offset:2048 lds
  s_add_u32 m0, s84, 0x1000
  v_lshl_add_u32 v25, v25, 10, v24
  v_add_u32 v25, s88, v25
  s_mul_i32 s88, s86, 0xac0
  s_lshl_b32 s89, s25, 6
  s_add_u32 s88, s88, s89
  s_and_b32 s89, s26, 1
  s_lshl_b32 s89, s89, 5
  s_add_u32 s88, s88, s89
  s_lshr_b32 s89, s26, 1
  s_lshl_b32 s89, s89, 17
  s_add_u32 s88, s88, s89
  s_add_u32 s88, s88, 0x810000
  v_add_u32 v24, s88, v24
  v_cmp_gt_u32 vcc, 48, v0
  s_nop 1
  v_cndmask_b32 v50, v24, v25, vcc
  v_add_u32 v24, 0x5600, v24
  buffer_load_dwordx4 v20, s[36:39], s81 offen lds
  v_add_u32 v25, 0x6000, v25
  v_cndmask_b32 v51, v24, v25, vcc
  v_mov_b32 v52, 0xf149f2ca
  v_lshrrev_b32 v24, 4, v0
  v_lshlrev_b32 v24, 2, v24
  v_and_b32 v25, 15, v0
  v_sub_u32 v25, v24, v25
  s_cmp_eq_u32 s24, 0
  s_cselect_b32 s86, 64, 9
  s_cselect_b32 s87, 0, 7
  v_add_u32 v26, 7, v25
  v_cmp_ge_u32 vcc, 7, v26
  s_nop 1
  v_cndmask_b32 v56, v52, 0, vcc
  v_add_u32 v26, 0, v25
  v_cmp_le_i32 vcc, 9, v26
  s_nop 1
  v_cndmask_b32 v60, v52, 0, vcc
  buffer_load_dwordx4 v16, s[40:43], s82 offen offset:2048 lds
  s_add_u32 m0, s84, 0x4000
  v_cmp_le_i32 vcc, s86, v26
  s_nop 1
  v_cndmask_b32 v68, v52, 0, vcc
  v_cmp_ge_i32 vcc, 0, v26
  v_mov_b32 v54, 0xffff
  s_nop 0
  v_cndmask_b32 v74, 0, v54, vcc
  v_cmp_le_i32 vcc, 1, v26
  s_nop 1
  v_cndmask_b32 v64, v52, 0, vcc
  v_add_u32 v54, 0, v24
  v_cmp_ge_u32 vcc, s87, v54
  s_nop 1
  v_cndmask_b32 v64, v52, v64, vcc
  v_add_u32 v26, 8, v25
  v_cmp_ge_u32 vcc, 7, v26
  s_nop 1
  v_cndmask_b32 v57, v52, 0, vcc
  v_add_u32 v26, 1, v25
  v_cmp_le_i32 vcc, 9, v26
  s_nop 1
  v_cndmask_b32 v61, v52, 0, vcc
  buffer_load_dwordx4 v21, s[36:39], s81 offen lds
  v_cmp_le_i32 vcc, s86, v26
  s_nop 1
  v_cndmask_b32 v69, v52, 0, vcc
  v_cmp_ge_i32 vcc, 0, v26
  v_mov_b32 v54, 0xffff0000
  s_nop 0
  v_cndmask_b32 v54, 0, v54, vcc
  v_or_b32 v74, v74, v54
  v_not_b32 v72, v74
  v_cmp_le_i32 vcc, 1, v26
  s_nop 1
  v_cndmask_b32 v65, v52, 0, vcc
  v_add_u32 v54, 1, v24
  v_cmp_ge_u32 vcc, s87, v54
  s_nop 1
  v_cndmask_b32 v65, v52, v65, vcc
  v_add_u32 v26, 9, v25
  v_cmp_ge_u32 vcc, 7, v26
  s_nop 1
  v_cndmask_b32 v58, v52, 0, vcc
  v_add_u32 v26, 2, v25
  buffer_load_dwordx4 v22, s[36:39], s81 offen offset:2048 lds
  s_add_u32 m0, s84, 0x5000
  v_cmp_le_i32 vcc, 9, v26
  s_nop 1
  v_cndmask_b32 v62, v52, 0, vcc
  v_cmp_le_i32 vcc, s86, v26
  s_nop 1
  v_cndmask_b32 v70, v52, 0, vcc
  v_cmp_ge_i32 vcc, 0, v26
  v_mov_b32 v54, 0xffff
  s_nop 0
  v_cndmask_b32 v75, 0, v54, vcc
  v_cmp_le_i32 vcc, 1, v26
  s_nop 1
  v_cndmask_b32 v66, v52, 0, vcc
  v_add_u32 v54, 2, v24
  v_cmp_ge_u32 vcc, s87, v54
  s_nop 1
  v_cndmask_b32 v66, v52, v66, vcc
  v_add_u32 v26, 10, v25
  v_cmp_ge_u32 vcc, 7, v26
  s_nop 1
  v_cndmask_b32 v59, v52, 0, vcc
  v_add_u32 v26, 3, v25
  buffer_load_dwordx4 v23, s[36:39], s81 offen lds
  v_cmp_le_i32 vcc, 9, v26
  s_nop 1
  v_cndmask_b32 v63, v52, 0, vcc
  v_cmp_le_i32 vcc, s86, v26
  s_nop 1
  v_cndmask_b32 v71, v52, 0, vcc
  v_cmp_ge_i32 vcc, 0, v26
  v_mov_b32 v54, 0xffff0000
  s_nop 0
  v_cndmask_b32 v54, 0, v54, vcc
  v_or_b32 v75, v75, v54
  v_not_b32 v73, v75
  v_cmp_le_i32 vcc, 1, v26
  s_nop 1
  v_cndmask_b32 v67, v52, 0, vcc
  v_add_u32 v54, 3, v24
  v_cmp_ge_u32 vcc, s87, v54
  s_nop 1
  v_cndmask_b32 v67, v52, v67, vcc
  v_lshrrev_b32 v86, 2, v0
  v_lshlrev_b32 v86, 8, v86
  buffer_load_dwordx4 v17, s[40:43], s82 offen offset:2048 lds
  s_add_u32 s31, s31, 1
  s_and_b32 s31, s31, 7
  s_lshl_b32 s80, s31, 7
  s_mul_i32 s81, s31, 0x30000
  s_mul_i32 s82, s31, 0x2b000
  s_add_u32 m0, s83, 0xc800
  v_and_b32 v25, 3, v0
  v_lshl_add_u32 v86, v25, 4, v86
  v_add_u32 v86, 0x870000, v86
  v_and_b32 v24, 15, v0
  v_lshlrev_b32 v24, 1, v24
  v_bfe_u32 v25, v0, 4, 1
  v_add_u32 v24, v24, v25
  s_lshl_b32 s86, s24, 7
  s_lshl_b32 s87, s26, 5
  s_add_u32 s87, s86, s87
  v_add_u32 v24, s87, v24
  v_lshlrev_b32 v24, 3, v24
  v_add_u32 v52, 0x800000, v24
  v_and_b32 v24, 7, v0
  v_lshlrev_b32 v24, 1, v24
  v_bfe_u32 v25, v0, 3, 1
  buffer_load_dwordx4 v1, s[32:35], s80 offen lds
  v_add_u32 v24, v24, v25
  s_sub_u32 s86, s86, 16
  s_cmp_lg_u32 s26, 0
  s_cbranch_scc1 L_nt5A
  s_call_b64 s[20:21], L_pad5A
L_nt5A:
  v_add_u32 v24, s86, v24
  v_max_i32 v24, 0, v24
  v_lshlrev_b32 v24, 3, v24
  v_add_u32 v54, 0x800000, v24
  s_add_u32 s68, s22, 0x84f000
  s_addc_u32 s69, s23, 0
  s_mov_b32 s70, 0xd000
  s_mov_b32 s71, 0x20000
  s_and_b32 s86, s26, 1
  s_lshl_b32 s86, s86, 17
  buffer_load_dwordx4 v2, s[32:35], s80 offen offset:1024 lds
  s_add_u32 s86, s86, 0x80f000
  s_add_u32 s72, s22, s86
  s_addc_u32 s73, s23, 0
  s_mov_b32 s74, 0xbc00
  s_mov_b32 s75, 0x20000
  v_and_b32 v24, 31, v0
  s_lshl_b32 s86, s26, 9
  v_lshlrev_b32 v26, 4, v24
  v_add_u32 v26, s86, v26
  v_add_u32 v55, 0x25d00, v26
  v_and_b32 v26, 15, v0
  v_lshlrev_b32 v26, 4, v26
  v_add_u32 v76, 0x26500, v26
  v_add_u32 v87, 0x25d00, v26
  v_add_u32 v88, s86, v87
  s_lshl_b32 s86, s26, 5
  buffer_load_dwordx4 v3, s[32:35], s80 offen offset:2048 lds
  v_add_u32 v24, s86, v24
  v_lshlrev_b32 v24, 2, v24
  v_add_u32 v77, 0x25800, v24
  v_and_b32 v25, 15, v0
  v_lshlrev_b32 v25, 2, v25
  v_add_u32 v79, 0x25800, v25
  v_add_u32 v78, 0x200, v79
  v_lshrrev_b32 v80, 4, v0
  v_lshlrev_b32 v80, 4, v80
  v_add_u32 v80, 0x25800, v80
  s_lshl_b32 s86, s26, 7
  v_add_u32 v81, s86, v79
  s_mov_b32 s56, s8
  s_mov_b32 s57, s9
  s_mov_b32 s58, 0x80000
  s_mov_b32 s59, 0x20000
  buffer_load_dwordx4 v4, s[32:35], s80 offen offset:3072 lds
  s_mov_b32 s60, s16
  s_mov_b32 s61, s17
  s_mov_b32 s62, 0x158000
  s_mov_b32 s63, 0x20000
  s_lshl_b32 s6, s26, 16
  s_lshl_b32 s13, s26, 17
  s_mul_i32 s86, s26, 18
  s_add_u32 s86, s86, 16
  s_lshl_b32 s7, s86, 14
  s_add_u32 s86, s86, 9
  s_min_u32 s86, s86, 0x4d
  s_lshl_b32 s12, s86, 14
  s_mul_i32 s3, s26, 0x3000
  v_bfe_u32 v97, v0, 4, 1
  v_lshlrev_b32 v97, 1, v97
  v_xor_b32 v97, v97, v0
  s_add_u32 m0, s85, 0xc800
  s_mov_b64 exec, 0xffffffff
  buffer_load_dwordx4 v7, s[32:35], s80 offen lds
  s_mov_b64 exec, -1
  s_add_u32 m0, s84, 0xc800
  v_and_b32 v97, 7, v97
  v_lshlrev_b32 v97, 4, v97
  v_lshrrev_b32 v98, 3, v0
  v_lshl_add_u32 v97, v98, 10, v97
  s_lshl_b32 s86, s28, 7
  v_add_u32 v89, s86, v97
  v_xor_b32 v90, 64, v89
  v_add_u32 v90, 0x1c00, v90
  v_lshrrev_b32 v97, 5, v0
  v_lshlrev_b32 v97, 4, v97
  v_bfe_u32 v98, v0, 4, 1
  v_lshl_add_u32 v97, v98, 3, v97
  v_bfe_u32 v92, v0, 2, 2
  v_add_u32 v97, v97, v92
  v_lshlrev_b32 v97, 7, v97
  v_and_b32 v92, 3, v0
  buffer_load_dwordx4 v18, s[36:39], s81 offen lds
  v_lshl_add_u32 v97, v92, 3, v97
  v_add_u32 v97, s3, v97
  v_lshlrev_b32 v98, 1, v98
  v_bfe_u32 v92, v0, 3, 1
  v_or_b32 v98, v98, v92
  s_and_b32 s86, s26, 2
  v_xor_b32 v98, s86, v98
  v_lshl_add_u32 v91, v98, 5, v97
  v_xor_b32 v92, 32, v91
  v_xor_b32 v93, 64, v91
  s_branch L_skip1A
.p2align 12
L_pad1A:
  s_setpc_b64 s[20:21]
L_skip1A:
  v_xor_b32 v94, 0x60, v91
  s_lshr_b32 s86, s2, 3
  s_lshl_b32 s86, s86, 9
  v_and_b32 v97, 3, v0
  v_lshl_add_u32 v97, v97, 7, s86
  v_lshrrev_b32 v98, 2, v0
  buffer_load_dwordx4 v19, s[36:39], s81 offen offset:2048 lds
  s_add_u32 m0, s84, 0xd800
  v_lshl_add_u32 v95, v98, 14, v97
  v_lshlrev_b32 v99, 7, v0
  s_lshl2_add_u32 s86, s2, s26
  s_lshl_b32 s14, s86, 9
  s_mul_i32 s15, s86, 0x580
  v_mov_b32 v100, 0x3f803f80
  v_mov_b32 v97, 0
  v_mov_b32 v98, 0
  s_waitcnt vmcnt(23)
  v_dot2_f32_bf16 v97, v8, v100, v97
  v_dot2_f32_bf16 v98, v8, v8, v98
  v_dot2_f32_bf16 v97, v9, v100, v97
  v_dot2_f32_bf16 v98, v9, v9, v98
  v_dot2_f32_bf16 v97, v10, v100, v97
  v_dot2_f32_bf16 v98, v10, v10, v98
  v_dot2_f32_bf16 v97, v11, v100, v97
  v_dot2_f32_bf16 v98, v11, v11, v98
  buffer_load_dwordx4 v20, s[36:39], s81 offen lds
  s_waitcnt vmcnt(23)
  v_dot2_f32_bf16 v97, v12, v100, v97
  v_dot2_f32_bf16 v98, v12, v12, v98
  v_dot2_f32_bf16 v97, v13, v100, v97
  v_dot2_f32_bf16 v98, v13, v13, v98
  v_dot2_f32_bf16 v97, v14, v100, v97
  v_dot2_f32_bf16 v98, v14, v14, v98
  v_dot2_f32_bf16 v97, v15, v100, v97
  v_dot2_f32_bf16 v98, v15, v15, v98
  s_nop 1
  v_add_f32_dpp v97, v97, v97 row_ror:8 row_mask:0xf bank_mask:0xf
  v_add_f32_dpp v98, v98, v98 row_ror:8 row_mask:0xf bank_mask:0xf
  s_nop 0
  v_add_f32_dpp v97, v97, v97 row_ror:4 row_mask:0xf bank_mask:0xf
  v_add_f32_dpp v98, v98, v98 row_ror:4 row_mask:0xf bank_mask:0xf
  s_nop 0
  v_add_f32_dpp v97, v97, v97 row_ror:2 row_mask:0xf bank_mask:0xf
  v_add_f32_dpp v98, v98, v98 row_ror:2 row_mask:0xf bank_mask:0xf
  s_nop 0
  v_add_f32_dpp v97, v97, v97 row_ror:1 row_mask:0xf bank_mask:0xf
  v_add_f32_dpp v98, v98, v98 row_ror:1 row_mask:0xf bank_mask:0xf
  buffer_load_dwordx4 v16, s[40:43], s82 offen offset:2048 lds
  s_add_u32 m0, s84, 0x10800
  v_mov_b32 v101, v97
  v_mov_b32 v100, v98
  s_nop 0
  v_permlane16_swap_b32 v97, v101
  v_permlane16_swap_b32 v98, v100
  v_add_f32 v97, v97, v101
  v_add_f32 v98, v98, v100
  v_mul_f32 v97, 0x3b000000, v97
  v_mul_f32 v98, 0x3b000000, v98
  v_fma_f32 v98, -v97, v97, v98
  v_max_f32 v98, 0, v98
  v_add_f32 v103, 0x3727c5ac, v98
  v_cvt_pk_bf16_f32 v102, -v97, -v97
  v_lshlrev_b32 v6, 3, v6
  v_add_u32 v6, 0x800000, v6
  v_and_b32 v101, 31, v0
  v_cmp_eq_u32 vcc, 0, v101
  buffer_load_dwordx4 v21, s[36:39], s81 offen lds
  v_mov_b32 v101, 0x7ffffff0
  v_cndmask_b32 v6, v101, v6, vcc
  buffer_store_dwordx2 v[102:103], v6, s[48:51], 0 offen sc1
  s_waitcnt vmcnt(24)
  v_readfirstlane_b32 s29, v27
  s_nop 0
  s_mul_i32 s29, s29, 0x9e3779b1
  s_add_u32 s29, s29, 0x7f4a7c15
  buffer_load_dwordx4 v22, s[36:39], s81 offen offset:2048 lds
  s_add_u32 m0, s84, 0x11800
  s_nop 0
  buffer_load_dwordx4 v23, s[36:39], s81 offen lds
  buffer_load_dwordx4 v17, s[40:43], s82 offen offset:2048 lds
  s_waitcnt vmcnt(14)
  s_barrier
  ds_read_b64_tr_b16 a[48:49], v41 offset:2048
  ds_read_b64_tr_b16 a[50:51], v41 offset:2560
  ds_read_b64_tr_b16 a[52:53], v41 offset:4096
  ds_read_b64_tr_b16 a[54:55], v41 offset:4608
  ds_read_b128 a[0:3], v28 offset:16384
  ds_read_b64_tr_b16 a[44:45], v41
  ds_read_b64_tr_b16 a[46:47], v41 offset:512
  ds_read_b128 a[4:7], v28
  ds_read_b128 a[8:11], v28 offset:2048
  ds_read_b128 a[12:15], v28 offset:4096
  ds_read_b128 a[16:19], v28 offset:6144
  ds_read_b128 a[20:23], v28 offset:8192
  s_waitcnt lgkmcnt(7)
  v_mfma_f32_16x16x32_bf16 v[152:155], a[48:51], a[0:3], 0
  s_add_u32 s31, s31, 1
  s_and_b32 s31, s31, 7
  s_lshl_b32 s80, s31, 7
  s_mul_i32 s81, s31, 0x30000
  s_mul_i32 s82, s31, 0x2b000
  s_add_u32 m0, s83, 0x19000
  v_mfma_f32_16x16x32_bf16 v[188:191], a[0:3], a[52:55], 0
  buffer_load_dwordx4 v1, s[32:35], s80 offen lds
  s_waitcnt lgkmcnt(4)
  v_mfma_f32_16x16x32_bf16 v[120:123], a[44:47], a[4:7], 0
  ds_read_b128 a[24:27], v28 offset:10240
  ds_read_b128 a[28:31], v28 offset:12288
  v_mfma_f32_16x16x32_bf16 v[156:159], a[48:51], a[4:7], 0
  ds_read_b128 a[32:35], v28 offset:14336
  ds_read_b64_tr_b16 a[76:77], v41 offset:18432
  v_mfma_f32_16x16x32_bf16 v[192:195], a[4:7], a[52:55], 0
  ds_read_b64_tr_b16 a[56:57], v44
  ds_read_b64_tr_b16 a[58:59], v44 offset:256
  s_waitcnt lgkmcnt(9)
  v_mfma_f32_16x16x32_bf16 v[124:127], a[44:47], a[8:11], 0
  buffer_load_dwordx4 v2, s[32:35], s80 offen offset:1024 lds
  v_mfma_f32_16x16x32_bf16 v[160:163], a[48:51], a[8:11], 0
  ds_read_b64_tr_b16 a[64:65], v44 offset:1024
  ds_read_b64_tr_b16 a[66:67], v44 offset:1280
  v_mfma_f32_16x16x32_bf16 v[196:199], a[8:11], a[52:55], 0
  ds_read_b64_tr_b16 a[60:61], v45
  ds_read_b64_tr_b16 a[62:63], v45 offset:256
  s_waitcnt lgkmcnt(12)
  v_mfma_f32_16x16x32_bf16 v[128:131], a[44:47], a[12:15], 0
  ds_read_b64_tr_b16 a[68:69], v45 offset:1024
  ds_read_b64_tr_b16 a[70:71], v45 offset:1280
  v_mfma_f32_16x16x32_bf16 v[164:167], a[48:51], a[12:15], 0
  ds_read_b128 a[36:39], v35
  ds_read_b128 a[40:43], v35 offset:2048
  v_mfma_f32_16x16x32_bf16 v[200:203], a[12:15], a[52:55], 0
  buffer_load_dwordx4 v3, s[32:35], s80 offen offset:2048 lds
  s_waitcnt lgkmcnt(14)
  v_mfma_f32_16x16x32_bf16 v[132:135], a[44:47], a[16:19], 0
  ds_read_b128 a[0:3], v29 offset:16384
  ds_read_b64_tr_b16 a[78:79], v41 offset:18944
  v_mfma_f32_16x16x32_bf16 v[168:171], a[48:51], a[16:19], 0
  ds_read_b64_tr_b16 a[80:81], v41 offset:20480
  ds_read_b64_tr_b16 a[82:83], v41 offset:20992
  v_mfma_f32_16x16x32_bf16 v[204:207], a[16:19], a[52:55], 0
  ds_read_b64_tr_b16 a[72:73], v41 offset:16384
  ds_read_b64_tr_b16 a[74:75], v41 offset:16896
  v_mfma_f32_16x16x32_bf16 v[136:139], a[44:47], a[20:23], 0
  ds_read_b128 a[4:7], v29
  ds_read_b128 a[8:11], v29 offset:2048
  v_mfma_f32_16x16x32_bf16 v[172:175], a[48:51], a[20:23], 0
  buffer_load_dwordx4 v4, s[32:35], s80 offen offset:3072 lds
  v_mfma_f32_16x16x32_bf16 v[208:211], a[20:23], a[52:55], 0
  ds_read_b128 a[12:15], v29 offset:4096
  ds_read_b128 a[16:19], v29 offset:6144
  s_waitcnt lgkmcnt(14)
  v_mfma_f32_16x16x32_bf16 v[140:143], a[44:47], a[24:27], 0
  ds_read_b128 a[20:23], v29 offset:8192
  ds_read_b64_tr_b16 a[84:85], v44 offset:16384
  v_mfma_f32_16x16x32_bf16 v[176:179], a[48:51], a[24:27], 0
  ds_read_b64_tr_b16 a[86:87], v44 offset:16640
  ds_read_b64_tr_b16 a[92:93], v44 offset:17408
  v_mfma_f32_16x16x32_bf16 v[212:215], a[24:27], a[52:55], 0
  ds_read_b128 a[24:27], v29 offset:10240
  ds_read_b64_tr_b16 a[94:95], v44 offset:17664
  v_mfma_f32_16x16x32_bf16 v[144:147], a[44:47], a[28:31], 0
  s_add_u32 m0, s85, 0x19000
  s_mov_b64 exec, 0xffffffff
  buffer_load_dwordx4 v7, s[32:35], s80 offen lds
  s_mov_b64 exec, -1
  v_mfma_f32_16x16x32_bf16 v[180:183], a[48:51], a[28:31], 0
  ds_read_b64_tr_b16 a[88:89], v45 offset:16384
  ds_read_b64_tr_b16 a[90:91], v45 offset:16640
  v_mfma_f32_16x16x32_bf16 v[216:219], a[28:31], a[52:55], 0
  ds_read_b128 a[28:31], v29 offset:12288
  ds_read_b64_tr_b16 a[96:97], v45 offset:17408
  v_mfma_f32_16x16x32_bf16 v[148:151], a[44:47], a[32:35], 0
  ds_read_b64_tr_b16 a[98:99], v45 offset:17664
  v_mfma_f32_16x16x32_bf16 v[184:187], a[48:51], a[32:35], 0
  v_mfma_f32_16x16x32_bf16 v[220:223], a[32:35], a[52:55], 0
  s_add_u32 m0, s84, 0x19000
  ds_read_b128 a[32:35], v29 offset:14336
  s_waitcnt lgkmcnt(14)
  v_mfma_f32_16x16x32_bf16 v[224:227], a[56:59], a[36:39], 0
  buffer_load_dwordx4 v18, s[36:39], s81 offen lds
  v_mfma_f32_16x16x32_bf16 v[240:243], a[64:67], a[36:39], 0
  v_mfma_f32_16x16x32_bf16 v[232:235], a[60:63], a[36:39], 0
  v_mfma_f32_16x16x32_bf16 v[248:251], a[68:71], a[36:39], 0
  ds_read_b128 a[36:39], v36
  v_mfma_f32_16x16x32_bf16 v[228:231], a[56:59], a[40:43], 0
  v_mfma_f32_16x16x32_bf16 v[244:247], a[64:67], a[40:43], 0
  buffer_load_dwordx4 v19, s[36:39], s81 offen offset:2048 lds
  v_mfma_f32_16x16x32_bf16 v[236:239], a[60:63], a[40:43], 0
  v_mfma_f32_16x16x32_bf16 v[252:255], a[68:71], a[40:43], 0
  ds_read_b128 a[40:43], v36 offset:2048
  v_mfma_f32_16x16x32_bf16 v[152:155], a[76:79], a[0:3], v[152:155]
  v_mfma_f32_16x16x32_bf16 v[188:191], a[0:3], a[80:83], v[188:191]
  s_add_u32 m0, s84, 0x1a000
  v_mfma_f32_16x16x32_bf16 v[120:123], a[72:75], a[4:7], v[120:123]
  buffer_load_dwordx4 v20, s[36:39], s81 offen lds
  v_mfma_f32_16x16x32_bf16 v[156:159], a[76:79], a[4:7], v[156:159]
  v_mfma_f32_16x16x32_bf16 v[192:195], a[4:7], a[80:83], v[192:195]
  v_mfma_f32_16x16x32_bf16 v[124:127], a[72:75], a[8:11], v[124:127]
  s_waitcnt vmcnt(8)
  s_waitcnt lgkmcnt(0)
  s_barrier
  ds_read_b128 a[0:3], v31 offset:16384
  v_mfma_f32_16x16x32_bf16 v[160:163], a[76:79], a[8:11], v[160:163]
  ds_read_b64_tr_b16 a[48:49], v42 offset:2048
  ds_read_b64_tr_b16 a[50:51], v42 offset:2560
  v_mfma_f32_16x16x32_bf16 v[196:199], a[8:11], a[80:83], v[196:199]
  buffer_load_dwordx4 v16, s[40:43], s82 offen offset:2048 lds
  v_mfma_f32_16x16x32_bf16 v[128:131], a[72:75], a[12:15], v[128:131]
  ds_read_b64_tr_b16 a[52:53], v42 offset:4096
  ds_read_b64_tr_b16 a[54:55], v42 offset:4608
  v_mfma_f32_16x16x32_bf16 v[164:167], a[76:79], a[12:15], v[164:167]
  ds_read_b64_tr_b16 a[44:45], v42
  ds_read_b64_tr_b16 a[46:47], v42 offset:512
  v_mfma_f32_16x16x32_bf16 v[200:203], a[12:15], a[80:83], v[200:203]
  ds_read_b128 a[4:7], v31
  ds_read_b128 a[8:11], v31 offset:2048
  v_mfma_f32_16x16x32_bf16 v[132:135], a[72:75], a[16:19], v[132:135]
  ds_read_b128 a[12:15], v31 offset:4096
  ds_read_b64_tr_b16 a[56:57], v46
  v_mfma_f32_16x16x32_bf16 v[168:171], a[76:79], a[16:19], v[168:171]
  s_add_u32 m0, s84, 0x1d000
  ds_read_b64_tr_b16 a[58:59], v46 offset:256
  v_mfma_f32_16x16x32_bf16 v[204:207], a[16:19], a[80:83], v[204:207]
  buffer_load_dwordx4 v21, s[36:39], s81 offen lds
  v_mfma_f32_16x16x32_bf16 v[136:139], a[72:75], a[20:23], v[136:139]
  ds_read_b128 a[16:19], v31 offset:6144
  ds_read_b64_tr_b16 a[64:65], v46 offset:1024
  v_mfma_f32_16x16x32_bf16 v[172:175], a[76:79], a[20:23], v[172:175]
  ds_read_b64_tr_b16 a[66:67], v46 offset:1280
  ds_read_b64_tr_b16 a[60:61], v47
  v_mfma_f32_16x16x32_bf16 v[208:211], a[20:23], a[80:83], v[208:211]
  ds_read_b128 a[20:23], v31 offset:8192
  ds_read_b64_tr_b16 a[62:63], v47 offset:256
  v_mfma_f32_16x16x32_bf16 v[140:143], a[72:75], a[24:27], v[140:143]
  ds_read_b64_tr_b16 a[68:69], v47 offset:1024
  ds_read_b64_tr_b16 a[70:71], v47 offset:1280
  v_mfma_f32_16x16x32_bf16 v[176:179], a[76:79], a[24:27], v[176:179]
  buffer_load_dwordx4 v22, s[36:39], s81 offen offset:2048 lds
  v_mfma_f32_16x16x32_bf16 v[212:215], a[24:27], a[80:83], v[212:215]
  ds_read_b128 a[24:27], v31 offset:10240
  v_mfma_f32_16x16x32_bf16 v[144:147], a[72:75], a[28:31], v[144:147]
  v_mfma_f32_16x16x32_bf16 v[180:183], a[76:79], a[28:31], v[180:183]
  s_mov_b64 exec, 15
  buffer_load_dword v96, v99, s[56:59], s14 offen
  s_mov_b64 exec, -1
  v_mfma_f32_16x16x32_bf16 v[216:219], a[28:31], a[80:83], v[216:219]
  s_add_u32 m0, s84, 0x1e000
  ds_read_b128 a[28:31], v31 offset:12288
  v_mfma_f32_16x16x32_bf16 v[148:151], a[72:75], a[32:35], v[148:151]
  buffer_load_dwordx4 v23, s[36:39], s81 offen lds
  v_mfma_f32_16x16x32_bf16 v[184:187], a[76:79], a[32:35], v[184:187]
  s_mov_b64 exec, 0x7ff
  buffer_load_dword v96, v99, s[60:63], s15 offen
  s_mov_b64 exec, -1
  v_mfma_f32_16x16x32_bf16 v[220:223], a[32:35], a[80:83], v[220:223]
  ds_read_b128 a[32:35], v31 offset:14336
  v_mfma_f32_16x16x32_bf16 v[224:227], a[84:87], a[36:39], v[224:227]
  v_mfma_f32_16x16x32_bf16 v[240:243], a[92:95], a[36:39], v[240:243]
  v_mfma_f32_16x16x32_bf16 v[232:235], a[88:91], a[36:39], v[232:235]
  buffer_load_dwordx4 v17, s[40:43], s82 offen offset:2048 lds
  v_mfma_f32_16x16x32_bf16 v[248:251], a[96:99], a[36:39], v[248:251]
  ds_read_b128 a[36:39], v37
  v_mfma_f32_16x16x32_bf16 v[228:231], a[84:87], a[40:43], v[228:231]
  v_mfma_f32_16x16x32_bf16 v[244:247], a[92:95], a[40:43], v[244:247]
  v_mfma_f32_16x16x32_bf16 v[236:239], a[88:91], a[40:43], v[236:239]
  s_add_u32 s31, s31, 1
  s_and_b32 s31, s31, 7
  v_mfma_f32_16x16x32_bf16 v[252:255], a[96:99], a[40:43], v[252:255]
  s_lshl_b32 s80, s31, 7
  s_mul_i32 s81, s31, 0x30000
  s_waitcnt lgkmcnt(2)
  v_mfma_f32_16x16x32_bf16 v[152:155], a[48:51], a[0:3], v[152:155]
  s_mul_i32 s82, s31, 0x2b000
  s_add_u32 m0, s83, 0
  v_mfma_f32_16x16x32_bf16 v[188:191], a[0:3], a[52:55], v[188:191]
  buffer_load_dwordx4 v1, s[32:35], s80 offen lds
  v_mfma_f32_16x16x32_bf16 v[120:123], a[44:47], a[4:7], v[120:123]
  ds_read_b64_tr_b16 a[100:101], v53
  ds_read_b64_tr_b16 a[102:103], v53 offset:256
  v_mfma_f32_16x16x32_bf16 v[156:159], a[48:51], a[4:7], v[156:159]
  ds_read_b64_tr_b16 a[104:105], v53 offset:16384
  ds_read_b64_tr_b16 a[106:107], v53 offset:16640
  v_mfma_f32_16x16x32_bf16 v[192:195], a[4:7], a[52:55], v[192:195]
  ds_read_b128 a[40:43], v37 offset:2048
  ds_read_b128 a[0:3], v32 offset:16384
  v_mfma_f32_16x16x32_bf16 v[124:127], a[44:47], a[8:11], v[124:127]
  buffer_load_dwordx4 v2, s[32:35], s80 offen offset:1024 lds
  v_mfma_f32_16x16x32_bf16 v[160:163], a[48:51], a[8:11], v[160:163]
  v_mfma_f32_16x16x32_bf16 v[8:11], a[108:111], a[44:47], 0
  ds_read_b64_tr_b16 a[76:77], v42 offset:18432
  v_mfma_f32_16x16x32_bf16 v[196:199], a[8:11], a[52:55], v[196:199]
  ds_read_b64_tr_b16 a[78:79], v42 offset:18944
  ds_read_b64_tr_b16 a[80:81], v42 offset:20480
  v_mfma_f32_16x16x32_bf16 v[128:131], a[44:47], a[12:15], v[128:131]
  ds_read_b64_tr_b16 a[82:83], v42 offset:20992
  ds_read_b64_tr_b16 a[72:73], v42 offset:16384
  v_mfma_f32_16x16x32_bf16 v[164:167], a[48:51], a[12:15], v[164:167]
  ds_read_b64_tr_b16 a[74:75], v42 offset:16896
  ds_read_b128 a[4:7], v32
  v_mfma_f32_16x16x32_bf16 v[200:203], a[12:15], a[52:55], v[200:203]
  buffer_load_dwordx4 v3, s[32:35], s80 offen offset:2048 lds
  v_mfma_f32_16x16x32_bf16 v[132:135], a[44:47], a[16:19], v[132:135]
  ds_read_b128 a[8:11], v32 offset:2048
  ds_read_b128 a[12:15], v32 offset:4096
  v_mfma_f32_16x16x32_bf16 v[168:171], a[48:51], a[16:19], v[168:171]
  v_mfma_f32_16x16x32_bf16 v[8:11], a[112:115], a[48:51], v[8:11]
  ds_read_b64_tr_b16 a[84:85], v46 offset:16384
  v_mfma_f32_16x16x32_bf16 v[204:207], a[16:19], a[52:55], v[204:207]
  ds_read_b128 a[16:19], v32 offset:6144
  ds_read_b64_tr_b16 a[86:87], v46 offset:16640
  v_mfma_f32_16x16x32_bf16 v[136:139], a[44:47], a[20:23], v[136:139]
  ds_read_b64_tr_b16 a[92:93], v46 offset:17408
  ds_read_b64_tr_b16 a[94:95], v46 offset:17664
  v_mfma_f32_16x16x32_bf16 v[172:175], a[48:51], a[20:23], v[172:175]
  buffer_load_dwordx4 v4, s[32:35], s80 offen offset:3072 lds
  v_mfma_f32_16x16x32_bf16 v[208:211], a[20:23], a[52:55], v[208:211]
  ds_read_b128 a[20:23], v32 offset:8192
  ds_read_b64_tr_b16 a[88:89], v47 offset:16384
  v_mfma_f32_16x16x32_bf16 v[140:143], a[44:47], a[24:27], v[140:143]
  ds_read_b64_tr_b16 a[90:91], v47 offset:16640
  ds_read_b64_tr_b16 a[96:97], v47 offset:17408
  v_mfma_f32_16x16x32_bf16 v[176:179], a[48:51], a[24:27], v[176:179]
  v_mfma_f32_16x16x32_bf16 v[8:11], a[116:119], a[52:55], v[8:11]
  ds_read_b64_tr_b16 a[98:99], v47 offset:17664
  v_mfma_f32_16x16x32_bf16 v[212:215], a[24:27], a[52:55], v[212:215]
  ds_read_b128 a[24:27], v32 offset:10240
  v_mfma_f32_16x16x32_bf16 v[144:147], a[44:47], a[28:31], v[144:147]
  s_add_u32 m0, s85, 0
  s_mov_b64 exec, 0xffffffff
  buffer_load_dwordx4 v7, s[32:35], s80 offen lds
  s_mov_b64 exec, -1
  v_mfma_f32_16x16x32_bf16 v[180:183], a[48:51], a[28:31], v[180:183]
  v_mfma_f32_16x16x32_bf16 v[216:219], a[28:31], a[52:55], v[216:219]
  ds_read_b128 a[28:31], v32 offset:12288
  s_waitcnt lgkmcnt(11)
  v_mfma_f32_16x16x32_bf16 v[148:151], a[44:47], a[32:35], v[148:151]
  v_mfma_f32_16x16x32_bf16 v[184:187], a[48:51], a[32:35], v[184:187]
  v_mfma_f32_16x16x32_bf16 v[8:11], a[120:123], a[100:103], v[8:11]
  v_mfma_f32_16x16x32_bf16 v[220:223], a[32:35], a[52:55], v[220:223]
  s_add_u32 m0, s84, 0
  ds_read_b128 a[32:35], v32 offset:14336
  v_mfma_f32_16x16x32_bf16 v[224:227], a[56:59], a[36:39], v[224:227]
  buffer_load_dwordx4 v18, s[36:39], s81 offen lds
  v_mfma_f32_16x16x32_bf16 v[240:243], a[64:67], a[36:39], v[240:243]
  v_mfma_f32_16x16x32_bf16 v[232:235], a[60:63], a[36:39], v[232:235]
  v_mfma_f32_16x16x32_bf16 v[248:251], a[68:71], a[36:39], v[248:251]
  ds_read_b128 a[36:39], v38
  v_mfma_f32_16x16x32_bf16 v[228:231], a[56:59], a[40:43], v[228:231]
  v_mfma_f32_16x16x32_bf16 v[244:247], a[64:67], a[40:43], v[244:247]
  buffer_load_dwordx4 v19, s[36:39], s81 offen offset:2048 lds
  v_mfma_f32_16x16x32_bf16 v[236:239], a[60:63], a[40:43], v[236:239]
  v_mfma_f32_16x16x32_bf16 v[252:255], a[68:71], a[40:43], v[252:255]
  ds_read_b128 a[40:43], v38 offset:2048
  v_mfma_f32_16x16x32_bf16 v[152:155], a[76:79], a[0:3], v[152:155]
  v_mfma_f32_16x16x32_bf16 v[188:191], a[0:3], a[80:83], v[188:191]
  s_add_u32 m0, s84, 0x1000
  v_mfma_f32_16x16x32_bf16 v[120:123], a[72:75], a[4:7], v[120:123]
  buffer_load_dwordx4 v20, s[36:39], s81 offen lds
  v_mfma_f32_16x16x32_bf16 v[156:159], a[76:79], a[4:7], v[156:159]
  v_mfma_f32_16x16x32_bf16 v[192:195], a[4:7], a[80:83], v[192:195]
  v_mfma_f32_16x16x32_bf16 v[124:127], a[72:75], a[8:11], v[124:127]
  s_waitcnt vmcnt(8)
  s_waitcnt lgkmcnt(0)
  s_barrier
  ds_read_b128 a[0:3], v33 offset:16384
  v_mfma_f32_16x16x32_bf16 v[160:163], a[76:79], a[8:11], v[160:163]
  v_mfma_f32_16x16x32_bf16 v[8:11], a[108:111], a[72:75], v[8:11]
  ds_read_b64_tr_b16 a[48:49], v43 offset:2048
  v_mfma_f32_16x16x32_bf16 v[196:199], a[8:11], a[80:83], v[196:199]
  buffer_load_dwordx4 v16, s[40:43], s82 offen offset:2048 lds
  v_mfma_f32_16x16x32_bf16 v[128:131], a[72:75], a[12:15], v[128:131]
  ds_read_b64_tr_b16 a[50:51], v43 offset:2560
  ds_read_b64_tr_b16 a[52:53], v43 offset:4096
  v_mfma_f32_16x16x32_bf16 v[164:167], a[76:79], a[12:15], v[164:167]
  ds_read_b64_tr_b16 a[54:55], v43 offset:4608
  ds_read_b64_tr_b16 a[44:45], v43
  v_mfma_f32_16x16x32_bf16 v[200:203], a[12:15], a[80:83], v[200:203]
  ds_read_b64_tr_b16 a[46:47], v43 offset:512
  ds_read_b128 a[4:7], v33
  v_mfma_f32_16x16x32_bf16 v[132:135], a[72:75], a[16:19], v[132:135]
  ds_read_b128 a[8:11], v33 offset:2048
  ds_read_b128 a[12:15], v33 offset:4096
  v_mfma_f32_16x16x32_bf16 v[168:171], a[76:79], a[16:19], v[168:171]
  v_mfma_f32_16x16x32_bf16 v[8:11], a[112:115], a[76:79], v[8:11]
  s_add_u32 m0, s84, 0x4000
  v_mfma_f32_16x16x32_bf16 v[204:207], a[16:19], a[80:83], v[204:207]
  buffer_load_dwordx4 v21, s[36:39], s81 offen lds
  v_mfma_f32_16x16x32_bf16 v[136:139], a[72:75], a[20:23], v[136:139]
  ds_read_b128 a[16:19], v33 offset:6144
  ds_read_b64_tr_b16 a[56:57], v48
  v_mfma_f32_16x16x32_bf16 v[172:175], a[76:79], a[20:23], v[172:175]
  ds_read_b64_tr_b16 a[58:59], v48 offset:256
  ds_read_b64_tr_b16 a[64:65], v48 offset:1024
  v_mfma_f32_16x16x32_bf16 v[208:211], a[20:23], a[80:83], v[208:211]
  ds_read_b128 a[20:23], v33 offset:8192
  ds_read_b64_tr_b16 a[66:67], v48 offset:1280
  v_mfma_f32_16x16x32_bf16 v[140:143], a[72:75], a[24:27], v[140:143]
  ds_read_b64_tr_b16 a[60:61], v49
  ds_read_b64_tr_b16 a[62:63], v49 offset:256
  v_mfma_f32_16x16x32_bf16 v[176:179], a[76:79], a[24:27], v[176:179]
  v_mfma_f32_16x16x32_bf16 v[8:11], a[116:119], a[80:83], v[8:11]
  ds_read_b64_tr_b16 a[68:69], v49 offset:1024
  v_mfma_f32_16x16x32_bf16 v[212:215], a[24:27], a[80:83], v[212:215]
  buffer_load_dwordx4 v22, s[36:39], s81 offen offset:2048 lds
  v_mfma_f32_16x16x32_bf16 v[144:147], a[72:75], a[28:31], v[144:147]
  ds_read_b128 a[24:27], v33 offset:10240
  ds_read_b64_tr_b16 a[70:71], v49 offset:1280
  v_mfma_f32_16x16x32_bf16 v[180:183], a[76:79], a[28:31], v[180:183]
  s_mov_b64 exec, 0xffff
  buffer_load_dword v96, v95, s[60:63], s6 offen
  s_mov_b64 exec, -1
  v_mfma_f32_16x16x32_bf16 v[216:219], a[28:31], a[80:83], v[216:219]
  s_add_u32 m0, s84, 0x5000
  ds_read_b128 a[28:31], v33 offset:12288
  v_mfma_f32_16x16x32_bf16 v[148:151], a[72:75], a[32:35], v[148:151]
  buffer_load_dwordx4 v23, s[36:39], s81 offen lds
  v_mfma_f32_16x16x32_bf16 v[184:187], a[76:79], a[32:35], v[184:187]
  v_mfma_f32_16x16x32_bf16 v[8:11], a[120:123], a[104:107], v[8:11]
  v_mfma_f32_16x16x32_bf16 v[220:223], a[32:35], a[80:83], v[220:223]
  ds_read_b128 a[32:35], v33 offset:14336
  v_mfma_f32_16x16x32_bf16 v[224:227], a[84:87], a[36:39], v[224:227]
  v_mfma_f32_16x16x32_bf16 v[240:243], a[92:95], a[36:39], v[240:243]
  v_mfma_f32_16x16x32_bf16 v[232:235], a[88:91], a[36:39], v[232:235]
  buffer_load_dwordx4 v17, s[40:43], s82 offen offset:2048 lds
  v_mfma_f32_16x16x32_bf16 v[248:251], a[96:99], a[36:39], v[248:251]
  s_nop 0
  v_cvt_pk_bf16_f32 v9, v8, v8
  v_and_b32 v10, 0xffff0000, v9
  v_mfma_f32_16x16x32_bf16 v[228:231], a[84:87], a[40:43], v[228:231]
  v_sub_f32 v10, v8, v10
  v_cvt_pk_bf16_f32 v11, v10, v10
  v_mfma_f32_16x16x32_bf16 v[244:247], a[92:95], a[40:43], v[244:247]
  buffer_store_short v9, v50, s[48:51], 0 offen sc1
  v_mfma_f32_16x16x32_bf16 v[236:239], a[88:91], a[40:43], v[236:239]
  s_add_u32 s31, s31, 1
  s_and_b32 s31, s31, 7
  v_mfma_f32_16x16x32_bf16 v[252:255], a[96:99], a[40:43], v[252:255]
  s_lshl_b32 s80, s31, 7
  s_mul_i32 s81, s31, 0x30000
  s_mul_i32 s82, s31, 0x2b000
  s_add_u32 m0, s83, 0xc800
  s_waitcnt lgkmcnt(1)
  v_mfma_f32_16x16x32_bf16 v[152:155], a[48:51], a[0:3], v[152:155]
  buffer_store_short v11, v51, s[48:51], 0 offen sc1
  buffer_load_dwordx4 v1, s[32:35], s80 offen lds
  v_mfma_f32_16x16x32_bf16 v[188:191], a[0:3], a[52:55], v[188:191]
  ds_read_b128 a[36:39], v39
  ds_read_b128 a[40:43], v39 offset:2048
  v_mfma_f32_16x16x32_bf16 v[120:123], a[44:47], a[4:7], v[120:123]
  ds_read_b128 a[0:3], v34 offset:16384
  ds_read_b64_tr_b16 a[76:77], v43 offset:18432
  v_mfma_f32_16x16x32_bf16 v[156:159], a[48:51], a[4:7], v[156:159]
  ds_read_b64_tr_b16 a[78:79], v43 offset:18944
  ds_read_b64_tr_b16 a[80:81], v43 offset:20480
  v_mfma_f32_16x16x32_bf16 v[192:195], a[4:7], a[52:55], v[192:195]
  ds_read_b64_tr_b16 a[82:83], v43 offset:20992
  ds_read_b64_tr_b16 a[72:73], v43 offset:16384
  v_mfma_f32_16x16x32_bf16 v[124:127], a[44:47], a[8:11], v[124:127]
  buffer_load_dwordx4 v2, s[32:35], s80 offen offset:1024 lds
  v_mfma_f32_16x16x32_bf16 v[160:163], a[48:51], a[8:11], v[160:163]
  ds_read_b64_tr_b16 a[74:75], v43 offset:16896
  ds_read_b128 a[4:7], v34
  v_mfma_f32_16x16x32_bf16 v[196:199], a[8:11], a[52:55], v[196:199]
  ds_read_b128 a[8:11], v34 offset:2048
  ds_read_b64_tr_b16 a[84:85], v48 offset:16384
  v_mfma_f32_16x16x32_bf16 v[128:131], a[44:47], a[12:15], v[128:131]
  ds_read_b64_tr_b16 a[86:87], v48 offset:16640
  ds_read_b64_tr_b16 a[92:93], v48 offset:17408
  v_mfma_f32_16x16x32_bf16 v[164:167], a[48:51], a[12:15], v[164:167]
  ds_read_b64_tr_b16 a[94:95], v48 offset:17664
  ds_read_b64_tr_b16 a[88:89], v49 offset:16384
  v_mfma_f32_16x16x32_bf16 v[200:203], a[12:15], a[52:55], v[200:203]
  buffer_load_dwordx4 v3, s[32:35], s80 offen offset:2048 lds
  v_mfma_f32_16x16x32_bf16 v[132:135], a[44:47], a[16:19], v[132:135]
  ds_read_b128 a[12:15], v34 offset:4096
  ds_read_b64_tr_b16 a[90:91], v49 offset:16640
  v_mfma_f32_16x16x32_bf16 v[168:171], a[48:51], a[16:19], v[168:171]
  ds_read_b64_tr_b16 a[96:97], v49 offset:17408
  ds_read_b64_tr_b16 a[98:99], v49 offset:17664
  v_mfma_f32_16x16x32_bf16 v[204:207], a[16:19], a[52:55], v[204:207]
  ds_read_b128 a[16:19], v34 offset:6144
  v_mfma_f32_16x16x32_bf16 v[136:139], a[44:47], a[20:23], v[136:139]
  v_mfma_f32_16x16x32_bf16 v[172:175], a[48:51], a[20:23], v[172:175]
  buffer_load_dwordx4 v4, s[32:35], s80 offen offset:3072 lds
  v_mfma_f32_16x16x32_bf16 v[208:211], a[20:23], a[52:55], v[208:211]
  ds_read_b128 a[20:23], v34 offset:8192
  v_mfma_f32_16x16x32_bf16 v[140:143], a[44:47], a[24:27], v[140:143]
  v_mfma_f32_16x16x32_bf16 v[176:179], a[48:51], a[24:27], v[176:179]
  v_mfma_f32_16x16x32_bf16 v[212:215], a[24:27], a[52:55], v[212:215]
  ds_read_b128 a[24:27], v34 offset:10240
  v_mfma_f32_16x16x32_bf16 v[144:147], a[44:47], a[28:31], v[144:147]
  s_add_u32 m0, s85, 0xc800
  s_mov_b64 exec, 0xffffffff
  buffer_load_dwordx4 v7, s[32:35], s80 offen lds
  s_mov_b64 exec, -1
  v_mfma_f32_16x16x32_bf16 v[180:183], a[48:51], a[28:31], v[180:183]
  v_mfma_f32_16x16x32_bf16 v[216:219], a[28:31], a[52:55], v[216:219]
  ds_read_b128 a[28:31], v34 offset:12288
  s_waitcnt lgkmcnt(6)
  v_mfma_f32_16x16x32_bf16 v[148:151], a[44:47], a[32:35], v[148:151]
  v_mfma_f32_16x16x32_bf16 v[184:187], a[48:51], a[32:35], v[184:187]
  v_mfma_f32_16x16x32_bf16 v[220:223], a[32:35], a[52:55], v[220:223]
  s_add_u32 m0, s84, 0xc800
  ds_read_b128 a[32:35], v34 offset:14336
  v_mfma_f32_16x16x32_bf16 v[224:227], a[56:59], a[36:39], v[224:227]
  buffer_load_dwordx4 v18, s[36:39], s81 offen lds
  v_mfma_f32_16x16x32_bf16 v[240:243], a[64:67], a[36:39], v[240:243]
  v_mfma_f32_16x16x32_bf16 v[232:235], a[60:63], a[36:39], v[232:235]
  v_mfma_f32_16x16x32_bf16 v[248:251], a[68:71], a[36:39], v[248:251]
  ds_read_b128 a[36:39], v40
  v_mfma_f32_16x16x32_bf16 v[228:231], a[56:59], a[40:43], v[228:231]
  v_mfma_f32_16x16x32_bf16 v[244:247], a[64:67], a[40:43], v[244:247]
  buffer_load_dwordx4 v19, s[36:39], s81 offen offset:2048 lds
  v_mfma_f32_16x16x32_bf16 v[236:239], a[60:63], a[40:43], v[236:239]
  v_mfma_f32_16x16x32_bf16 v[252:255], a[68:71], a[40:43], v[252:255]
  ds_read_b128 a[40:43], v40 offset:2048
  v_mfma_f32_16x16x32_bf16 v[152:155], a[76:79], a[0:3], v[152:155]
  v_mfma_f32_16x16x32_bf16 v[188:191], a[0:3], a[80:83], v[188:191]
  s_add_u32 m0, s84, 0xd800
  v_mfma_f32_16x16x32_bf16 v[120:123], a[72:75], a[4:7], v[120:123]
  buffer_load_dwordx4 v20, s[36:39], s81 offen lds
  v_mfma_f32_16x16x32_bf16 v[156:159], a[76:79], a[4:7], v[156:159]
  v_mfma_f32_16x16x32_bf16 v[192:195], a[4:7], a[80:83], v[192:195]
  v_mfma_f32_16x16x32_bf16 v[124:127], a[72:75], a[8:11], v[124:127]
  s_waitcnt vmcnt(8)
  s_waitcnt lgkmcnt(0)
  s_barrier
  ds_read_b128 a[0:3], v28 offset:16384
  v_mfma_f32_16x16x32_bf16 v[160:163], a[76:79], a[8:11], v[160:163]
  s_cmp_lg_u32 s26, 0
  s_cbranch_scc1 L_A_pub1
  s_lshl_b32 s86, s24, 8
  s_lshl2_add_u32 s86, s30, s86
  s_add_u32 s86, s86, 0x870000
  v_mov_b32 v27, s86
  v_mov_b32 v30, s29
  s_mov_b64 exec, 1
  buffer_store_dword v30, v27, s[48:51], 0 offen sc0 sc1
  s_mov_b64 exec, -1
L_A_pub1:
  v_mfma_f32_16x16x32_bf16 v[196:199], a[8:11], a[80:83], v[196:199]
  buffer_load_dwordx4 v16, s[40:43], s82 offen offset:2048 lds
  v_mfma_f32_16x16x32_bf16 v[128:131], a[72:75], a[12:15], v[128:131]
  ds_read_b64_tr_b16 a[48:49], v41 offset:2048
  ds_read_b64_tr_b16 a[50:51], v41 offset:2560
  v_mfma_f32_16x16x32_bf16 v[164:167], a[76:79], a[12:15], v[164:167]
  ds_read_b64_tr_b16 a[52:53], v41 offset:4096
  ds_read_b64_tr_b16 a[54:55], v41 offset:4608
  v_mfma_f32_16x16x32_bf16 v[200:203], a[12:15], a[80:83], v[200:203]
  ds_read_b64_tr_b16 a[44:45], v41
  ds_read_b64_tr_b16 a[46:47], v41 offset:512
  v_mfma_f32_16x16x32_bf16 v[132:135], a[72:75], a[16:19], v[132:135]
  s_branch L_skip2A
.p2align 12
L_pad2A:
  s_setpc_b64 s[20:21]
L_skip2A:
  ds_read_b128 a[4:7], v28
  ds_read_b128 a[8:11], v28 offset:2048
  v_mfma_f32_16x16x32_bf16 v[168:171], a[76:79], a[16:19], v[168:171]
  s_add_u32 m0, s84, 0x10800
  ds_read_b128 a[12:15], v28 offset:4096
  v_mfma_f32_16x16x32_bf16 v[204:207], a[16:19], a[80:83], v[204:207]
  buffer_load_dwordx4 v21, s[36:39], s81 offen lds
  v_mfma_f32_16x16x32_bf16 v[136:139], a[72:75], a[20:23], v[136:139]
  ds_read_b128 a[16:19], v28 offset:6144
  ds_read_b64_tr_b16 a[56:57], v44
  v_mfma_f32_16x16x32_bf16 v[172:175], a[76:79], a[20:23], v[172:175]
  ds_read_b64_tr_b16 a[58:59], v44 offset:256
  ds_read_b64_tr_b16 a[64:65], v44 offset:1024
  v_mfma_f32_16x16x32_bf16 v[208:211], a[20:23], a[80:83], v[208:211]
  ds_read_b128 a[20:23], v28 offset:8192
  ds_read_b64_tr_b16 a[66:67], v44 offset:1280
  v_mfma_f32_16x16x32_bf16 v[140:143], a[72:75], a[24:27], v[140:143]
  ds_read_b64_tr_b16 a[60:61], v45
  ds_read_b64_tr_b16 a[62:63], v45 offset:256
  v_mfma_f32_16x16x32_bf16 v[176:179], a[76:79], a[24:27], v[176:179]
  buffer_load_dwordx4 v22, s[36:39], s81 offen offset:2048 lds
  v_mfma_f32_16x16x32_bf16 v[212:215], a[24:27], a[80:83], v[212:215]
  ds_read_b128 a[24:27], v28 offset:10240
  ds_read_b64_tr_b16 a[68:69], v45 offset:1024
  v_mfma_f32_16x16x32_bf16 v[144:147], a[72:75], a[28:31], v[144:147]
  ds_read_b64_tr_b16 a[70:71], v45 offset:1280
  v_mfma_f32_16x16x32_bf16 v[180:183], a[76:79], a[28:31], v[180:183]
  s_mov_b64 exec, 0xffff
  buffer_load_dword v96, v95, s[60:63], s7 offen
  s_mov_b64 exec, -1
  v_mfma_f32_16x16x32_bf16 v[216:219], a[28:31], a[80:83], v[216:219]
  s_add_u32 m0, s84, 0x11800
  ds_read_b128 a[28:31], v28 offset:12288
  v_mfma_f32_16x16x32_bf16 v[148:151], a[72:75], a[32:35], v[148:151]
  buffer_load_dwordx4 v23, s[36:39], s81 offen lds
  v_mfma_f32_16x16x32_bf16 v[184:187], a[76:79], a[32:35], v[184:187]
  v_mfma_f32_16x16x32_bf16 v[220:223], a[32:35], a[80:83], v[220:223]
  ds_read_b128 a[32:35], v28 offset:14336
  v_mfma_f32_16x16x32_bf16 v[224:227], a[84:87], a[36:39], v[224:227]
  v_mfma_f32_16x16x32_bf16 v[240:243], a[92:95], a[36:39], v[240:243]
  v_mfma_f32_16x16x32_bf16 v[232:235], a[88:91], a[36:39], v[232:235]
  buffer_load_dwordx4 v17, s[40:43], s82 offen offset:2048 lds
  v_mfma_f32_16x16x32_bf16 v[248:251], a[96:99], a[36:39], v[248:251]
  ds_read_b128 a[36:39], v35
  v_mfma_f32_16x16x32_bf16 v[228:231], a[84:87], a[40:43], v[228:231]
  v_mfma_f32_16x16x32_bf16 v[244:247], a[92:95], a[40:43], v[244:247]
  s_add_u32 s31, s31, 1
  s_and_b32 s31, s31, 7
  v_mfma_f32_16x16x32_bf16 v[236:239], a[88:91], a[40:43], v[236:239]
  s_lshl_b32 s80, s31, 7
  s_mul_i32 s81, s31, 0x30000
  v_mfma_f32_16x16x32_bf16 v[252:255], a[96:99], a[40:43], v[252:255]
  s_mul_i32 s82, s31, 0x2b000
  s_add_u32 m0, s83, 0x19000
  s_waitcnt lgkmcnt(2)
  v_mfma_f32_16x16x32_bf16 v[152:155], a[48:51], a[0:3], v[152:155]
  buffer_load_dwordx4 v1, s[32:35], s80 offen lds
  v_mfma_f32_16x16x32_bf16 v[188:191], a[0:3], a[52:55], v[188:191]
  ds_read_b128 a[40:43], v35 offset:2048
  ds_read_b128 a[0:3], v29 offset:16384
  v_mfma_f32_16x16x32_bf16 v[120:123], a[44:47], a[4:7], v[120:123]
  ds_read_b64_tr_b16 a[76:77], v41 offset:18432
  ds_read_b64_tr_b16 a[78:79], v41 offset:18944
  v_mfma_f32_16x16x32_bf16 v[156:159], a[48:51], a[4:7], v[156:159]
  ds_read_b64_tr_b16 a[80:81], v41 offset:20480
  ds_read_b64_tr_b16 a[82:83], v41 offset:20992
  v_mfma_f32_16x16x32_bf16 v[192:195], a[4:7], a[52:55], v[192:195]
  ds_read_b64_tr_b16 a[72:73], v41 offset:16384
  ds_read_b64_tr_b16 a[74:75], v41 offset:16896
  v_mfma_f32_16x16x32_bf16 v[124:127], a[44:47], a[8:11], v[124:127]
  buffer_load_dwordx4 v2, s[32:35], s80 offen offset:1024 lds
  v_mfma_f32_16x16x32_bf16 v[160:163], a[48:51], a[8:11], v[160:163]
  ds_read_b128 a[4:7], v29
  ds_read_b64_tr_b16 a[84:85], v44 offset:16384
  v_mfma_f32_16x16x32_bf16 v[196:199], a[8:11], a[52:55], v[196:199]
  ds_read_b128 a[8:11], v29 offset:2048
  ds_read_b64_tr_b16 a[86:87], v44 offset:16640
  v_mfma_f32_16x16x32_bf16 v[128:131], a[44:47], a[12:15], v[128:131]
  ds_read_b64_tr_b16 a[92:93], v44 offset:17408
  ds_read_b64_tr_b16 a[94:95], v44 offset:17664
  v_mfma_f32_16x16x32_bf16 v[164:167], a[48:51], a[12:15], v[164:167]
  ds_read_b64_tr_b16 a[88:89], v45 offset:16384
  ds_read_b64_tr_b16 a[90:91], v45 offset:16640
  v_mfma_f32_16x16x32_bf16 v[200:203], a[12:15], a[52:55], v[200:203]
  buffer_load_dwordx4 v3, s[32:35], s80 offen offset:2048 lds
  v_mfma_f32_16x16x32_bf16 v[132:135], a[44:47], a[16:19], v[132:135]
  ds_read_b128 a[12:15], v29 offset:4096
  ds_read_b64_tr_b16 a[96:97], v45 offset:17408
  v_mfma_f32_16x16x32_bf16 v[168:171], a[48:51], a[16:19], v[168:171]
  ds_read_b64_tr_b16 a[98:99], v45 offset:17664
  v_mfma_f32_16x16x32_bf16 v[204:207], a[16:19], a[52:55], v[204:207]
  ds_read_b128 a[16:19], v29 offset:6144
  v_mfma_f32_16x16x32_bf16 v[136:139], a[44:47], a[20:23], v[136:139]
  v_mfma_f32_16x16x32_bf16 v[172:175], a[48:51], a[20:23], v[172:175]
  buffer_load_dwordx4 v4, s[32:35], s80 offen offset:3072 lds
  v_mfma_f32_16x16x32_bf16 v[208:211], a[20:23], a[52:55], v[208:211]
  ds_read_b128 a[20:23], v29 offset:8192
  v_mfma_f32_16x16x32_bf16 v[140:143], a[44:47], a[24:27], v[140:143]
  v_mfma_f32_16x16x32_bf16 v[176:179], a[48:51], a[24:27], v[176:179]
  v_mfma_f32_16x16x32_bf16 v[212:215], a[24:27], a[52:55], v[212:215]
  ds_read_b128 a[24:27], v29 offset:10240
  v_mfma_f32_16x16x32_bf16 v[144:147], a[44:47], a[28:31], v[144:147]
  s_add_u32 m0, s85, 0x19000
  s_mov_b64 exec, 0xffffffff
  buffer_load_dwordx4 v7, s[32:35], s80 offen lds
  s_mov_b64 exec, -1
  v_mfma_f32_16x16x32_bf16 v[180:183], a[48:51], a[28:31], v[180:183]
  v_mfma_f32_16x16x32_bf16 v[216:219], a[28:31], a[52:55], v[216:219]
  ds_read_b128 a[28:31], v29 offset:12288
  s_waitcnt lgkmcnt(5)
  v_mfma_f32_16x16x32_bf16 v[148:151], a[44:47], a[32:35], v[148:151]
  v_mfma_f32_16x16x32_bf16 v[184:187], a[48:51], a[32:35], v[184:187]
  v_mfma_f32_16x16x32_bf16 v[220:223], a[32:35], a[52:55], v[220:223]
  s_add_u32 m0, s84, 0x19000
  ds_read_b128 a[32:35], v29 offset:14336
  v_mfma_f32_16x16x32_bf16 v[224:227], a[56:59], a[36:39], v[224:227]
  buffer_load_dwordx4 v18, s[36:39], s81 offen lds
  v_mfma_f32_16x16x32_bf16 v[240:243], a[64:67], a[36:39], v[240:243]
  v_mfma_f32_16x16x32_bf16 v[232:235], a[60:63], a[36:39], v[232:235]
  v_mfma_f32_16x16x32_bf16 v[248:251], a[68:71], a[36:39], v[248:251]
  ds_read_b128 a[36:39], v36
  v_mfma_f32_16x16x32_bf16 v[228:231], a[56:59], a[40:43], v[228:231]
  v_mfma_f32_16x16x32_bf16 v[244:247], a[64:67], a[40:43], v[244:247]
  buffer_load_dwordx4 v19, s[36:39], s81 offen offset:2048 lds
  v_mfma_f32_16x16x32_bf16 v[236:239], a[60:63], a[40:43], v[236:239]
  v_mfma_f32_16x16x32_bf16 v[252:255], a[68:71], a[40:43], v[252:255]
  ds_read_b128 a[40:43], v36 offset:2048
  v_mfma_f32_16x16x32_bf16 v[152:155], a[76:79], a[0:3], v[152:155]
  v_mfma_f32_16x16x32_bf16 v[188:191], a[0:3], a[80:83], v[188:191]
  s_add_u32 m0, s84, 0x1a000
  v_mfma_f32_16x16x32_bf16 v[120:123], a[72:75], a[4:7], v[120:123]
  buffer_load_dwordx4 v20, s[36:39], s81 offen lds
  v_mfma_f32_16x16x32_bf16 v[156:159], a[76:79], a[4:7], v[156:159]
  v_mfma_f32_16x16x32_bf16 v[192:195], a[4:7], a[80:83], v[192:195]
  v_mfma_f32_16x16x32_bf16 v[124:127], a[72:75], a[8:11], v[124:127]
  s_waitcnt vmcnt(8)
  s_waitcnt lgkmcnt(0)
  s_barrier
  ds_read_b128 a[0:3], v31 offset:16384
  v_mfma_f32_16x16x32_bf16 v[160:163], a[76:79], a[8:11], v[160:163]
  ds_read_b64_tr_b16 a[48:49], v42 offset:2048
  ds_read_b64_tr_b16 a[50:51], v42 offset:2560
  v_mfma_f32_16x16x32_bf16 v[196:199], a[8:11], a[80:83], v[196:199]
  buffer_load_dwordx4 v16, s[40:43], s82 offen offset:2048 lds
  v_mfma_f32_16x16x32_bf16 v[128:131], a[72:75], a[12:15], v[128:131]
  ds_read_b64_tr_b16 a[52:53], v42 offset:4096
  ds_read_b64_tr_b16 a[54:55], v42 offset:4608
  v_mfma_f32_16x16x32_bf16 v[164:167], a[76:79], a[12:15], v[164:167]
  ds_read_b64_tr_b16 a[44:45], v42
  ds_read_b64_tr_b16 a[46:47], v42 offset:512
  v_mfma_f32_16x16x32_bf16 v[200:203], a[12:15], a[80:83], v[200:203]
  ds_read_b128 a[4:7], v31
  ds_read_b128 a[8:11], v31 offset:2048
  v_mfma_f32_16x16x32_bf16 v[132:135], a[72:75], a[16:19], v[132:135]
  ds_read_b128 a[12:15], v31 offset:4096
  ds_read_b64_tr_b16 a[56:57], v46
  v_mfma_f32_16x16x32_bf16 v[168:171], a[76:79], a[16:19], v[168:171]
  s_add_u32 m0, s84, 0x1d000
  ds_read_b64_tr_b16 a[58:59], v46 offset:256
  v_mfma_f32_16x16x32_bf16 v[204:207], a[16:19], a[80:83], v[204:207]
  buffer_load_dwordx4 v21, s[36:39], s81 offen lds
  v_mfma_f32_16x16x32_bf16 v[136:139], a[72:75], a[20:23], v[136:139]
  ds_read_b128 a[16:19], v31 offset:6144
  ds_read_b64_tr_b16 a[64:65], v46 offset:1024
  v_mfma_f32_16x16x32_bf16 v[172:175], a[76:79], a[20:23], v[172:175]
  ds_read_b64_tr_b16 a[66:67], v46 offset:1280
  ds_read_b64_tr_b16 a[60:61], v47
  v_mfma_f32_16x16x32_bf16 v[208:211], a[20:23], a[80:83], v[208:211]
  ds_read_b128 a[20:23], v31 offset:8192
  ds_read_b64_tr_b16 a[62:63], v47 offset:256
  v_mfma_f32_16x16x32_bf16 v[140:143], a[72:75], a[24:27], v[140:143]
  ds_read_b64_tr_b16 a[68:69], v47 offset:1024
  ds_read_b64_tr_b16 a[70:71], v47 offset:1280
  v_mfma_f32_16x16x32_bf16 v[176:179], a[76:79], a[24:27], v[176:179]
  buffer_load_dwordx4 v22, s[36:39], s81 offen offset:2048 lds
  v_mfma_f32_16x16x32_bf16 v[212:215], a[24:27], a[80:83], v[212:215]
  ds_read_b128 a[24:27], v31 offset:10240
  v_mfma_f32_16x16x32_bf16 v[144:147], a[72:75], a[28:31], v[144:147]
  v_mfma_f32_16x16x32_bf16 v[180:183], a[76:79], a[28:31], v[180:183]
  s_add_u32 s90, s7, 0x10000
  s_mov_b64 exec, 0xfffff
  buffer_load_dword v96, v95, s[60:63], s90 offen
  s_mov_b64 exec, -1
  v_mfma_f32_16x16x32_bf16 v[216:219], a[28:31], a[80:83], v[216:219]
  s_add_u32 m0, s84, 0x1e000
  ds_read_b128 a[28:31], v31 offset:12288
  v_mfma_f32_16x16x32_bf16 v[148:151], a[72:75], a[32:35], v[148:151]
  buffer_load_dwordx4 v23, s[36:39], s81 offen lds
  v_mfma_f32_16x16x32_bf16 v[184:187], a[76:79], a[32:35], v[184:187]
  v_mfma_f32_16x16x32_bf16 v[220:223], a[32:35], a[80:83], v[220:223]
  ds_read_b128 a[32:35], v31 offset:14336
  v_mfma_f32_16x16x32_bf16 v[224:227], a[84:87], a[36:39], v[224:227]
  v_mfma_f32_16x16x32_bf16 v[240:243], a[92:95], a[36:39], v[240:243]
  v_mfma_f32_16x16x32_bf16 v[232:235], a[88:91], a[36:39], v[232:235]
  buffer_load_dwordx4 v17, s[40:43], s82 offen offset:2048 lds
  v_mfma_f32_16x16x32_bf16 v[248:251], a[96:99], a[36:39], v[248:251]
  ds_read_b128 a[36:39], v37
  v_mfma_f32_16x16x32_bf16 v[228:231], a[84:87], a[40:43], v[228:231]
  v_mfma_f32_16x16x32_bf16 v[244:247], a[92:95], a[40:43], v[244:247]
  s_add_u32 s31, s31, 1
  s_and_b32 s31, s31, 7
  v_mfma_f32_16x16x32_bf16 v[236:239], a[88:91], a[40:43], v[236:239]
  s_lshl_b32 s80, s31, 7
  s_mul_i32 s81, s31, 0x30000
  v_mfma_f32_16x16x32_bf16 v[252:255], a[96:99], a[40:43], v[252:255]
  s_mul_i32 s82, s31, 0x2b000
  s_add_u32 m0, s83, 0
  s_waitcnt lgkmcnt(2)
  v_mfma_f32_16x16x32_bf16 v[152:155], a[48:51], a[0:3], v[152:155]
  buffer_load_dwordx4 v1, s[32:35], s80 offen lds
  v_mfma_f32_16x16x32_bf16 v[188:191], a[0:3], a[52:55], v[188:191]
  ds_read_b128 a[40:43], v37 offset:2048
  ds_read_b128 a[0:3], v32 offset:16384
  v_mfma_f32_16x16x32_bf16 v[120:123], a[44:47], a[4:7], v[120:123]
  ds_read_b64_tr_b16 a[76:77], v42 offset:18432
  ds_read_b64_tr_b16 a[78:79], v42 offset:18944
  v_mfma_f32_16x16x32_bf16 v[156:159], a[48:51], a[4:7], v[156:159]
  ds_read_b64_tr_b16 a[80:81], v42 offset:20480
  ds_read_b64_tr_b16 a[82:83], v42 offset:20992
  v_mfma_f32_16x16x32_bf16 v[192:195], a[4:7], a[52:55], v[192:195]
  ds_read_b64_tr_b16 a[72:73], v42 offset:16384
  ds_read_b64_tr_b16 a[74:75], v42 offset:16896
  v_mfma_f32_16x16x32_bf16 v[124:127], a[44:47], a[8:11], v[124:127]
  buffer_load_dwordx4 v2, s[32:35], s80 offen offset:1024 lds
  v_mfma_f32_16x16x32_bf16 v[160:163], a[48:51], a[8:11], v[160:163]
  ds_read_b128 a[4:7], v32
  ds_read_b64_tr_b16 a[84:85], v46 offset:16384
  v_mfma_f32_16x16x32_bf16 v[196:199], a[8:11], a[52:55], v[196:199]
  ds_read_b128 a[8:11], v32 offset:2048
  ds_read_b64_tr_b16 a[86:87], v46 offset:16640
  v_mfma_f32_16x16x32_bf16 v[128:131], a[44:47], a[12:15], v[128:131]
  ds_read_b64_tr_b16 a[92:93], v46 offset:17408
  ds_read_b64_tr_b16 a[94:95], v46 offset:17664
  v_mfma_f32_16x16x32_bf16 v[164:167], a[48:51], a[12:15], v[164:167]
  ds_read_b64_tr_b16 a[88:89], v47 offset:16384
  ds_read_b64_tr_b16 a[90:91], v47 offset:16640
  v_mfma_f32_16x16x32_bf16 v[200:203], a[12:15], a[52:55], v[200:203]
  buffer_load_dwordx4 v3, s[32:35], s80 offen offset:2048 lds
  v_mfma_f32_16x16x32_bf16 v[132:135], a[44:47], a[16:19], v[132:135]
  ds_read_b128 a[12:15], v32 offset:4096
  ds_read_b64_tr_b16 a[96:97], v47 offset:17408
  v_mfma_f32_16x16x32_bf16 v[168:171], a[48:51], a[16:19], v[168:171]
  ds_read_b64_tr_b16 a[98:99], v47 offset:17664
  v_mfma_f32_16x16x32_bf16 v[204:207], a[16:19], a[52:55], v[204:207]
  ds_read_b128 a[16:19], v32 offset:6144
  v_mfma_f32_16x16x32_bf16 v[136:139], a[44:47], a[20:23], v[136:139]
  v_mfma_f32_16x16x32_bf16 v[172:175], a[48:51], a[20:23], v[172:175]
  buffer_load_dwordx4 v4, s[32:35], s80 offen offset:3072 lds
  v_mfma_f32_16x16x32_bf16 v[208:211], a[20:23], a[52:55], v[208:211]
  ds_read_b128 a[20:23], v32 offset:8192
  v_mfma_f32_16x16x32_bf16 v[140:143], a[44:47], a[24:27], v[140:143]
  v_mfma_f32_16x16x32_bf16 v[176:179], a[48:51], a[24:27], v[176:179]
  v_mfma_f32_16x16x32_bf16 v[212:215], a[24:27], a[52:55], v[212:215]
  ds_read_b128 a[24:27], v32 offset:10240
  v_mfma_f32_16x16x32_bf16 v[144:147], a[44:47], a[28:31], v[144:147]
  s_add_u32 m0, s85, 0
  s_mov_b64 exec, 0xffffffff
  buffer_load_dwordx4 v7, s[32:35], s80 offen lds
  s_mov_b64 exec, -1
  v_mfma_f32_16x16x32_bf16 v[180:183], a[48:51], a[28:31], v[180:183]
  v_mfma_f32_16x16x32_bf16 v[216:219], a[28:31], a[52:55], v[216:219]
  ds_read_b128 a[28:31], v32 offset:12288
  s_waitcnt lgkmcnt(5)
  v_mfma_f32_16x16x32_bf16 v[148:151], a[44:47], a[32:35], v[148:151]
  v_mfma_f32_16x16x32_bf16 v[184:187], a[48:51], a[32:35], v[184:187]
  v_mfma_f32_16x16x32_bf16 v[220:223], a[32:35], a[52:55], v[220:223]
  s_add_u32 m0, s84, 0
  ds_read_b128 a[32:35], v32 offset:14336
  v_mfma_f32_16x16x32_bf16 v[224:227], a[56:59], a[36:39], v[224:227]
  buffer_load_dwordx4 v18, s[36:39], s81 offen lds
  v_mfma_f32_16x16x32_bf16 v[240:243], a[64:67], a[36:39], v[240:243]
  v_mfma_f32_16x16x32_bf16 v[232:235], a[60:63], a[36:39], v[232:235]
  v_mfma_f32_16x16x32_bf16 v[248:251], a[68:71], a[36:39], v[248:251]
  ds_read_b128 a[36:39], v38
  v_mfma_f32_16x16x32_bf16 v[228:231], a[56:59], a[40:43], v[228:231]
  v_mfma_f32_16x16x32_bf16 v[244:247], a[64:67], a[40:43], v[244:247]
  buffer_load_dwordx4 v19, s[36:39], s81 offen offset:2048 lds
  v_mfma_f32_16x16x32_bf16 v[236:239], a[60:63], a[40:43], v[236:239]
  v_mfma_f32_16x16x32_bf16 v[252:255], a[68:71], a[40:43], v[252:255]
  ds_read_b128 a[40:43], v38 offset:2048
  v_mfma_f32_16x16x32_bf16 v[152:155], a[76:79], a[0:3], v[152:155]
  v_mfma_f32_16x16x32_bf16 v[188:191], a[0:3], a[80:83], v[188:191]
  s_add_u32 m0, s84, 0x1000
  v_mfma_f32_16x16x32_bf16 v[120:123], a[72:75], a[4:7], v[120:123]
  buffer_load_dwordx4 v20, s[36:39], s81 offen lds
  v_mfma_f32_16x16x32_bf16 v[156:159], a[76:79], a[4:7], v[156:159]
  v_mfma_f32_16x16x32_bf16 v[192:195], a[4:7], a[80:83], v[192:195]
  v_mfma_f32_16x16x32_bf16 v[124:127], a[72:75], a[8:11], v[124:127]
  s_waitcnt vmcnt(8)
  s_waitcnt lgkmcnt(0)
  s_barrier
  ds_read_b128 a[0:3], v33 offset:16384
  v_mfma_f32_16x16x32_bf16 v[160:163], a[76:79], a[8:11], v[160:163]
  ds_read_b64_tr_b16 a[48:49], v43 offset:2048
  ds_read_b64_tr_b16 a[50:51], v43 offset:2560
  v_mfma_f32_16x16x32_bf16 v[196:199], a[8:11], a[80:83], v[196:199]
  buffer_load_dwordx4 v16, s[40:43], s82 offen offset:2048 lds
  v_mfma_f32_16x16x32_bf16 v[128:131], a[72:75], a[12:15], v[128:131]
  buffer_load_dwordx4 v[82:85], v86, s[48:51], 0 offen sc0 sc1
  v_mfma_f32_16x16x32_bf16 v[164:167], a[76:79], a[12:15], v[164:167]
  ds_read_b64_tr_b16 a[52:53], v43 offset:4096
  ds_read_b64_tr_b16 a[54:55], v43 offset:4608
  v_mfma_f32_16x16x32_bf16 v[200:203], a[12:15], a[80:83], v[200:203]
  ds_read_b64_tr_b16 a[44:45], v43
  ds_read_b64_tr_b16 a[46:47], v43 offset:512
  v_mfma_f32_16x16x32_bf16 v[132:135], a[72:75], a[16:19], v[132:135]
  ds_read_b128 a[4:7], v33
  ds_read_b128 a[8:11], v33 offset:2048
  v_mfma_f32_16x16x32_bf16 v[168:171], a[76:79], a[16:19], v[168:171]
  s_add_u32 m0, s84, 0x4000
  ds_read_b128 a[12:15], v33 offset:4096
  v_mfma_f32_16x16x32_bf16 v[204:207], a[16:19], a[80:83], v[204:207]
  buffer_load_dwordx4 v21, s[36:39], s81 offen lds
  v_mfma_f32_16x16x32_bf16 v[136:139], a[72:75], a[20:23], v[136:139]
  ds_read_b128 a[16:19], v33 offset:6144
  ds_read_b64_tr_b16 a[56:57], v48
  v_mfma_f32_16x16x32_bf16 v[172:175], a[76:79], a[20:23], v[172:175]
  ds_read_b64_tr_b16 a[58:59], v48 offset:256
  ds_read_b64_tr_b16 a[64:65], v48 offset:1024
  v_mfma_f32_16x16x32_bf16 v[208:211], a[20:23], a[80:83], v[208:211]
  ds_read_b128 a[20:23], v33 offset:8192
  ds_read_b64_tr_b16 a[66:67], v48 offset:1280
  v_mfma_f32_16x16x32_bf16 v[140:143], a[72:75], a[24:27], v[140:143]
  ds_read_b64_tr_b16 a[60:61], v49
  ds_read_b64_tr_b16 a[62:63], v49 offset:256
  v_mfma_f32_16x16x32_bf16 v[176:179], a[76:79], a[24:27], v[176:179]
  buffer_load_dwordx4 v22, s[36:39], s81 offen offset:2048 lds
  v_mfma_f32_16x16x32_bf16 v[212:215], a[24:27], a[80:83], v[212:215]
  ds_read_b128 a[24:27], v33 offset:10240
  ds_read_b64_tr_b16 a[68:69], v49 offset:1024
  v_mfma_f32_16x16x32_bf16 v[144:147], a[72:75], a[28:31], v[144:147]
  ds_read_b64_tr_b16 a[70:71], v49 offset:1280
  v_mfma_f32_16x16x32_bf16 v[180:183], a[76:79], a[28:31], v[180:183]
  s_mov_b64 exec, 0xffff
  buffer_load_dword v96, v95, s[60:63], s12 offen
  s_mov_b64 exec, -1
  v_mfma_f32_16x16x32_bf16 v[216:219], a[28:31], a[80:83], v[216:219]
  s_add_u32 m0, s84, 0x5000
  ds_read_b128 a[28:31], v33 offset:12288
  v_mfma_f32_16x16x32_bf16 v[148:151], a[72:75], a[32:35], v[148:151]
  buffer_load_dwordx4 v23, s[36:39], s81 offen lds
  v_mfma_f32_16x16x32_bf16 v[184:187], a[76:79], a[32:35], v[184:187]
  v_mfma_f32_16x16x32_bf16 v[220:223], a[32:35], a[80:83], v[220:223]
  ds_read_b128 a[32:35], v33 offset:14336
  v_mfma_f32_16x16x32_bf16 v[224:227], a[84:87], a[36:39], v[224:227]
  v_mfma_f32_16x16x32_bf16 v[240:243], a[92:95], a[36:39], v[240:243]
  v_mfma_f32_16x16x32_bf16 v[232:235], a[88:91], a[36:39], v[232:235]
  buffer_load_dwordx4 v17, s[40:43], s82 offen offset:2048 lds
  v_mfma_f32_16x16x32_bf16 v[248:251], a[96:99], a[36:39], v[248:251]
  ds_read_b128 a[36:39], v39
  v_mfma_f32_16x16x32_bf16 v[228:231], a[84:87], a[40:43], v[228:231]
  v_mfma_f32_16x16x32_bf16 v[244:247], a[92:95], a[40:43], v[244:247]
  s_add_u32 s31, s31, 1
  s_and_b32 s31, s31, 7
  v_mfma_f32_16x16x32_bf16 v[236:239], a[88:91], a[40:43], v[236:239]
  s_lshl_b32 s80, s31, 7
  s_mul_i32 s81, s31, 0x30000
  v_mfma_f32_16x16x32_bf16 v[252:255], a[96:99], a[40:43], v[252:255]
  s_mul_i32 s82, s31, 0x2b000
  s_add_u32 m0, s83, 0xc800
  s_waitcnt lgkmcnt(2)
  v_mfma_f32_16x16x32_bf16 v[152:155], a[48:51], a[0:3], v[152:155]
  buffer_load_dwordx4 v1, s[32:35], s80 offen lds
  v_mfma_f32_16x16x32_bf16 v[188:191], a[0:3], a[52:55], v[188:191]
  ds_read_b128 a[40:43], v39 offset:2048
  ds_read_b128 a[0:3], v34 offset:16384
  v_mfma_f32_16x16x32_bf16 v[120:123], a[44:47], a[4:7], v[120:123]
  ds_read_b64_tr_b16 a[76:77], v43 offset:18432
  ds_read_b64_tr_b16 a[78:79], v43 offset:18944
  v_mfma_f32_16x16x32_bf16 v[156:159], a[48:51], a[4:7], v[156:159]
  ds_read_b64_tr_b16 a[80:81], v43 offset:20480
  ds_read_b64_tr_b16 a[82:83], v43 offset:20992
  v_mfma_f32_16x16x32_bf16 v[192:195], a[4:7], a[52:55], v[192:195]
  ds_read_b64_tr_b16 a[72:73], v43 offset:16384
  ds_read_b64_tr_b16 a[74:75], v43 offset:16896
  v_mfma_f32_16x16x32_bf16 v[124:127], a[44:47], a[8:11], v[124:127]
  buffer_load_dwordx4 v2, s[32:35], s80 offen offset:1024 lds
  v_mfma_f32_16x16x32_bf16 v[160:163], a[48:51], a[8:11], v[160:163]
  ds_read_b128 a[4:7], v34
  ds_read_b64_tr_b16 a[84:85], v48 offset:16384
  v_mfma_f32_16x16x32_bf16 v[196:199], a[8:11], a[52:55], v[196:199]
  ds_read_b128 a[8:11], v34 offset:2048
  ds_read_b64_tr_b16 a[86:87], v48 offset:16640
  v_mfma_f32_16x16x32_bf16 v[128:131], a[44:47], a[12:15], v[128:131]
  ds_read_b64_tr_b16 a[92:93], v48 offset:17408
  ds_read_b64_tr_b16 a[94:95], v48 offset:17664
  v_mfma_f32_16x16x32_bf16 v[164:167], a[48:51], a[12:15], v[164:167]
  ds_read_b64_tr_b16 a[88:89], v49 offset:16384
  ds_read_b64_tr_b16 a[90:91], v49 offset:16640
  v_mfma_f32_16x16x32_bf16 v[200:203], a[12:15], a[52:55], v[200:203]
  buffer_load_dwordx4 v3, s[32:35], s80 offen offset:2048 lds
  v_mfma_f32_16x16x32_bf16 v[132:135], a[44:47], a[16:19], v[132:135]
  ds_read_b128 a[12:15], v34 offset:4096
  ds_read_b64_tr_b16 a[96:97], v49 offset:17408
  v_mfma_f32_16x16x32_bf16 v[168:171], a[48:51], a[16:19], v[168:171]
  ds_read_b64_tr_b16 a[98:99], v49 offset:17664
  v_mfma_f32_16x16x32_bf16 v[204:207], a[16:19], a[52:55], v[204:207]
  ds_read_b128 a[16:19], v34 offset:6144
  v_mfma_f32_16x16x32_bf16 v[136:139], a[44:47], a[20:23], v[136:139]
  v_mfma_f32_16x16x32_bf16 v[172:175], a[48:51], a[20:23], v[172:175]
  buffer_load_dwordx4 v4, s[32:35], s80 offen offset:3072 lds
  v_mfma_f32_16x16x32_bf16 v[208:211], a[20:23], a[52:55], v[208:211]
  ds_read_b128 a[20:23], v34 offset:8192
  v_mfma_f32_16x16x32_bf16 v[140:143], a[44:47], a[24:27], v[140:143]
  v_mfma_f32_16x16x32_bf16 v[176:179], a[48:51], a[24:27], v[176:179]
  v_mfma_f32_16x16x32_bf16 v[212:215], a[24:27], a[52:55], v[212:215]
  ds_read_b128 a[24:27], v34 offset:10240
  v_mfma_f32_16x16x32_bf16 v[144:147], a[44:47], a[28:31], v[144:147]
  s_add_u32 m0, s85, 0xc800
  s_mov_b64 exec, 0xffffffff
  buffer_load_dwordx4 v7, s[32:35], s80 offen lds
  s_mov_b64 exec, -1
  v_mfma_f32_16x16x32_bf16 v[180:183], a[48:51], a[28:31], v[180:183]
  v_mfma_f32_16x16x32_bf16 v[216:219], a[28:31], a[52:55], v[216:219]
  ds_read_b128 a[28:31], v34 offset:12288
  s_waitcnt lgkmcnt(5)
  v_mfma_f32_16x16x32_bf16 v[148:151], a[44:47], a[32:35], v[148:151]
  v_mfma_f32_16x16x32_bf16 v[184:187], a[48:51], a[32:35], v[184:187]
  v_mfma_f32_16x16x32_bf16 v[220:223], a[32:35], a[52:55], v[220:223]
  s_add_u32 m0, s84, 0xc800
  ds_read_b128 a[32:35], v34 offset:14336
  v_mfma_f32_16x16x32_bf16 v[224:227], a[56:59], a[36:39], v[224:227]
  buffer_load_dwordx4 v18, s[36:39], s81 offen lds
  v_mfma_f32_16x16x32_bf16 v[240:243], a[64:67], a[36:39], v[240:243]
  v_mfma_f32_16x16x32_bf16 v[232:235], a[60:63], a[36:39], v[232:235]
  v_mfma_f32_16x16x32_bf16 v[248:251], a[68:71], a[36:39], v[248:251]
  ds_read_b128 a[36:39], v40
  v_mfma_f32_16x16x32_bf16 v[228:231], a[56:59], a[40:43], v[228:231]
  v_mfma_f32_16x16x32_bf16 v[244:247], a[64:67], a[40:43], v[244:247]
  buffer_load_dwordx4 v19, s[36:39], s81 offen offset:2048 lds
  v_mfma_f32_16x16x32_bf16 v[236:239], a[60:63], a[40:43], v[236:239]
  v_mfma_f32_16x16x32_bf16 v[252:255], a[68:71], a[40:43], v[252:255]
  ds_read_b128 a[40:43], v40 offset:2048
  v_mfma_f32_16x16x32_bf16 v[152:155], a[76:79], a[0:3], v[152:155]
  s_waitcnt vmcnt(12)
  v_xor_b32 v82, s29, v82
  v_xor_b32 v83, s29, v83
  v_xor_b32 v84, s29, v84
  v_xor_b32 v85, s29, v85
  v_or_b32 v82, v82, v83
  v_or3_b32 v82, v82, v84, v85
  v_cmp_ne_u32 vcc, 0, v82
  s_nop 4
  s_cbranch_vccz L_A_poll1_ok
  s_mov_b32 s0, 0
L_A_poll1_spin:
  buffer_load_dwordx4 v[82:85], v86, s[48:51], 0 offen sc0 sc1
  s_add_u32 s0, s0, 1
  s_waitcnt vmcnt(0)
  s_waitcnt vmcnt(0)
  v_xor_b32 v82, s29, v82
  v_xor_b32 v83, s29, v83
  v_xor_b32 v84, s29, v84
  v_xor_b32 v85, s29, v85
  v_or_b32 v82, v82, v83
  v_or3_b32 v82, v82, v84, v85
  v_cmp_ne_u32 vcc, 0, v82
  s_cmp_ge_u32 s0, 0x8000
  s_cbranch_scc1 L_A_poll1_ok
  s_nop 2
  s_cbranch_vccnz L_A_poll1_spin
L_A_poll1_ok:
  buffer_load_dwordx2 v[12:13], v52, s[48:51], 0 offen sc1
  buffer_load_dwordx2 v[14:15], v54, s[48:51], 0 offen sc1
  v_mfma_f32_16x16x32_bf16 v[188:191], a[0:3], a[80:83], v[188:191]
  s_add_u32 m0, s84, 0xd800
  v_mfma_f32_16x16x32_bf16 v[120:123], a[72:75], a[4:7], v[120:123]
  buffer_load_dwordx4 v20, s[36:39], s81 offen lds
  v_mfma_f32_16x16x32_bf16 v[156:159], a[76:79], a[4:7], v[156:159]
  v_mfma_f32_16x16x32_bf16 v[192:195], a[4:7], a[80:83], v[192:195]
  v_mfma_f32_16x16x32_bf16 v[124:127], a[72:75], a[8:11], v[124:127]
  s_waitcnt vmcnt(10)
  s_waitcnt lgkmcnt(0)
  s_barrier
  ds_read_b128 a[0:3], v28 offset:16384
  v_mfma_f32_16x16x32_bf16 v[160:163], a[76:79], a[8:11], v[160:163]
  ds_read_b64_tr_b16 a[48:49], v41 offset:2048
  ds_read_b64_tr_b16 a[50:51], v41 offset:2560
  v_mfma_f32_16x16x32_bf16 v[196:199], a[8:11], a[80:83], v[196:199]
  buffer_load_dwordx4 v16, s[40:43], s82 offen offset:2048 lds
  v_mfma_f32_16x16x32_bf16 v[128:131], a[72:75], a[12:15], v[128:131]
  ds_read_b64_tr_b16 a[52:53], v41 offset:4096
  ds_read_b64_tr_b16 a[54:55], v41 offset:4608
  v_mfma_f32_16x16x32_bf16 v[164:167], a[76:79], a[12:15], v[164:167]
  ds_read_b64_tr_b16 a[44:45], v41
  ds_read_b64_tr_b16 a[46:47], v41 offset:512
  v_mfma_f32_16x16x32_bf16 v[200:203], a[12:15], a[80:83], v[200:203]
  ds_read_b128 a[4:7], v28
  ds_read_b128 a[8:11], v28 offset:2048
  v_mfma_f32_16x16x32_bf16 v[132:135], a[72:75], a[16:19], v[132:135]
  ds_read_b128 a[12:15], v28 offset:4096
  ds_read_b64_tr_b16 a[56:57], v44
  v_mfma_f32_16x16x32_bf16 v[168:171], a[76:79], a[16:19], v[168:171]
  s_add_u32 m0, s84, 0x10800
  ds_read_b64_tr_b16 a[58:59], v44 offset:256
  v_mfma_f32_16x16x32_bf16 v[204:207], a[16:19], a[80:83], v[204:207]
  buffer_load_dwordx4 v21, s[36:39], s81 offen lds
  v_mfma_f32_16x16x32_bf16 v[136:139], a[72:75], a[20:23], v[136:139]
  ds_read_b128 a[16:19], v28 offset:6144
  ds_read_b64_tr_b16 a[64:65], v44 offset:1024
  v_mfma_f32_16x16x32_bf16 v[172:175], a[76:79], a[20:23], v[172:175]
  ds_read_b64_tr_b16 a[66:67], v44 offset:1280
  ds_read_b64_tr_b16 a[60:61], v45
  v_mfma_f32_16x16x32_bf16 v[208:211], a[20:23], a[80:83], v[208:211]
  ds_read_b128 a[20:23], v28 offset:8192
  ds_read_b64_tr_b16 a[62:63], v45 offset:256
  v_mfma_f32_16x16x32_bf16 v[140:143], a[72:75], a[24:27], v[140:143]
  ds_read_b64_tr_b16 a[68:69], v45 offset:1024
  ds_read_b64_tr_b16 a[70:71], v45 offset:1280
  v_mfma_f32_16x16x32_bf16 v[176:179], a[76:79], a[24:27], v[176:179]
  buffer_load_dwordx4 v22, s[36:39], s81 offen offset:2048 lds
  v_mfma_f32_16x16x32_bf16 v[212:215], a[24:27], a[80:83], v[212:215]
  ds_read_b128 a[24:27], v28 offset:10240
  v_mfma_f32_16x16x32_bf16 v[144:147], a[72:75], a[28:31], v[144:147]
  v_mfma_f32_16x16x32_bf16 v[180:183], a[76:79], a[28:31], v[180:183]
  s_add_u32 s90, s12, 0x10000
  s_mov_b64 exec, 0xfffff
  buffer_load_dword v96, v95, s[60:63], s90 offen
  s_mov_b64 exec, -1
  v_mfma_f32_16x16x32_bf16 v[216:219], a[28:31], a[80:83], v[216:219]
  s_add_u32 m0, s84, 0x11800
  ds_read_b128 a[28:31], v28 offset:12288
  v_mfma_f32_16x16x32_bf16 v[148:151], a[72:75], a[32:35], v[148:151]
  buffer_load_dwordx4 v23, s[36:39], s81 offen lds
  v_mfma_f32_16x16x32_bf16 v[184:187], a[76:79], a[32:35], v[184:187]
  v_mfma_f32_16x16x32_bf16 v[220:223], a[32:35], a[80:83], v[220:223]
  ds_read_b128 a[32:35], v28 offset:14336
  v_mfma_f32_16x16x32_bf16 v[224:227], a[84:87], a[36:39], v[224:227]
  v_mfma_f32_16x16x32_bf16 v[240:243], a[92:95], a[36:39], v[240:243]
  v_mfma_f32_16x16x32_bf16 v[232:235], a[88:91], a[36:39], v[232:235]
  buffer_load_dwordx4 v17, s[40:43], s82 offen offset:2048 lds
  v_mfma_f32_16x16x32_bf16 v[248:251], a[96:99], a[36:39], v[248:251]
  ds_read_b128 a[36:39], v35
  v_mfma_f32_16x16x32_bf16 v[228:231], a[84:87], a[40:43], v[228:231]
  v_mfma_f32_16x16x32_bf16 v[244:247], a[92:95], a[40:43], v[244:247]
  v_mfma_f32_16x16x32_bf16 v[236:239], a[88:91], a[40:43], v[236:239]
  s_add_u32 m0, s84, 0x19000
  v_mfma_f32_16x16x32_bf16 v[252:255], a[96:99], a[40:43], v[252:255]
  buffer_load_dwordx4 v18, s[68:71], 0 offen sc1 lds
  s_waitcnt lgkmcnt(3)
  v_mfma_f32_16x16x32_bf16 v[152:155], a[48:51], a[0:3], v[152:155]
  s_branch L_skip3A
.p2align 12
L_pad3A:
  s_setpc_b64 s[20:21]
L_skip3A:
  ds_read_b128 a[40:43], v35 offset:2048
  ds_read_b64_tr_b16 a[76:77], v41 offset:18432
  v_mfma_f32_16x16x32_bf16 v[188:191], a[0:3], a[52:55], v[188:191]
  ds_read_b128 a[0:3], v29 offset:16384
  ds_read_b64_tr_b16 a[78:79], v41 offset:18944
  v_mfma_f32_16x16x32_bf16 v[120:123], a[44:47], a[4:7], v[120:123]
  ds_read_b64_tr_b16 a[80:81], v41 offset:20480
  ds_read_b64_tr_b16 a[82:83], v41 offset:20992
  v_mfma_f32_16x16x32_bf16 v[156:159], a[48:51], a[4:7], v[156:159]
  ds_read_b64_tr_b16 a[72:73], v41 offset:16384
  ds_read_b64_tr_b16 a[74:75], v41 offset:16896
  v_mfma_f32_16x16x32_bf16 v[192:195], a[4:7], a[52:55], v[192:195]
  ds_read_b128 a[4:7], v29
  ds_read_b64_tr_b16 a[84:85], v44 offset:16384
  v_mfma_f32_16x16x32_bf16 v[124:127], a[44:47], a[8:11], v[124:127]
  buffer_load_dwordx4 v19, s[68:71], 0 offen offset:2048 sc1 lds
  v_mfma_f32_16x16x32_bf16 v[160:163], a[48:51], a[8:11], v[160:163]
  ds_read_b64_tr_b16 a[86:87], v44 offset:16640
  ds_read_b64_tr_b16 a[92:93], v44 offset:17408
  v_mfma_f32_16x16x32_bf16 v[196:199], a[8:11], a[52:55], v[196:199]
  ds_read_b128 a[8:11], v29 offset:2048
  ds_read_b64_tr_b16 a[94:95], v44 offset:17664
  v_mfma_f32_16x16x32_bf16 v[128:131], a[44:47], a[12:15], v[128:131]
  ds_read_b64_tr_b16 a[88:89], v45 offset:16384
  ds_read_b64_tr_b16 a[90:91], v45 offset:16640
  v_mfma_f32_16x16x32_bf16 v[164:167], a[48:51], a[12:15], v[164:167]
  s_add_u32 m0, s84, 0x1a000
  ds_read_b64_tr_b16 a[96:97], v45 offset:17408
  v_mfma_f32_16x16x32_bf16 v[200:203], a[12:15], a[52:55], v[200:203]
  buffer_load_dwordx4 v20, s[68:71], 0 offen sc1 lds
  v_mfma_f32_16x16x32_bf16 v[132:135], a[44:47], a[16:19], v[132:135]
  ds_read_b128 a[12:15], v29 offset:4096
  ds_read_b64_tr_b16 a[98:99], v45 offset:17664
  v_mfma_f32_16x16x32_bf16 v[168:171], a[48:51], a[16:19], v[168:171]
  s_waitcnt vmcnt(11)
  v_rsq_f32 v5, v13
  s_waitcnt vmcnt(10)
  v_rsq_f32 v6, v15
  v_mfma_f32_16x16x32_bf16 v[204:207], a[16:19], a[52:55], v[204:207]
  ds_read_b128 a[16:19], v29 offset:6144
  v_mov_b32 v100, v12
  v_mfma_f32_16x16x32_bf16 v[136:139], a[44:47], a[20:23], v[136:139]
  v_mov_b32 v104, v14
  v_mov_b32 v101, v12
  v_mfma_f32_16x16x32_bf16 v[172:175], a[48:51], a[20:23], v[172:175]
  buffer_load_dwordx4 v16, s[72:75], 0 offen offset:2048 sc1 lds
  v_mfma_f32_16x16x32_bf16 v[208:211], a[20:23], a[52:55], v[208:211]
  ds_read_b128 a[20:23], v29 offset:8192
  v_mov_b32 v105, v14
  v_mfma_f32_16x16x32_bf16 v[140:143], a[44:47], a[24:27], v[140:143]
  v_mov_b32 v102, v12
  v_mov_b32 v106, v14
  v_mfma_f32_16x16x32_bf16 v[176:179], a[48:51], a[24:27], v[176:179]
  v_mov_b32 v103, v12
  v_mov_b32 v107, v14
  v_mfma_f32_16x16x32_bf16 v[212:215], a[24:27], a[52:55], v[212:215]
  ds_read_b128 a[24:27], v29 offset:10240
  ds_write_b128 v55, v[100:103]
  s_waitcnt lgkmcnt(7)
  v_mfma_f32_16x16x32_bf16 v[144:147], a[44:47], a[28:31], v[144:147]
  ds_write_b128 v76, v[104:107]
  ds_write_b32 v77, v5
  v_mfma_f32_16x16x32_bf16 v[180:183], a[48:51], a[28:31], v[180:183]
  s_mov_b64 exec, 0xffff
  buffer_load_dword v96, v95, s[56:59], s13 offen
  s_mov_b64 exec, -1
  v_mfma_f32_16x16x32_bf16 v[216:219], a[28:31], a[52:55], v[216:219]
  ds_read_b128 a[28:31], v29 offset:12288
  ds_write_b32 v77, v13 offset:640
  v_mfma_f32_16x16x32_bf16 v[148:151], a[44:47], a[32:35], v[148:151]
  ds_write_b32 v78, v6
  v_mfma_f32_16x16x32_bf16 v[184:187], a[48:51], a[32:35], v[184:187]
  v_mfma_f32_16x16x32_bf16 v[220:223], a[32:35], a[52:55], v[220:223]
  ds_read_b128 a[32:35], v29 offset:14336
  v_mfma_f32_16x16x32_bf16 v[224:227], a[56:59], a[36:39], v[224:227]
  v_mfma_f32_16x16x32_bf16 v[240:243], a[64:67], a[36:39], v[240:243]
  v_mfma_f32_16x16x32_bf16 v[232:235], a[60:63], a[36:39], v[232:235]
  v_mfma_f32_16x16x32_bf16 v[248:251], a[68:71], a[36:39], v[248:251]
  ds_read_b128 a[36:39], v36
  v_mfma_f32_16x16x32_bf16 v[228:231], a[56:59], a[40:43], v[228:231]
  v_mfma_f32_16x16x32_bf16 v[244:247], a[64:67], a[40:43], v[244:247]
  v_mfma_f32_16x16x32_bf16 v[236:239], a[60:63], a[40:43], v[236:239]
  v_mfma_f32_16x16x32_bf16 v[252:255], a[68:71], a[40:43], v[252:255]
  ds_read_b128 a[40:43], v36 offset:2048
  v_mfma_f32_16x16x32_bf16 v[152:155], a[76:79], a[0:3], v[152:155]
  v_mfma_f32_16x16x32_bf16 v[188:191], a[0:3], a[80:83], v[188:191]
  v_mfma_f32_16x16x32_bf16 v[120:123], a[72:75], a[4:7], v[120:123]
  v_mfma_f32_16x16x32_bf16 v[156:159], a[76:79], a[4:7], v[156:159]
  v_mfma_f32_16x16x32_bf16 v[192:195], a[4:7], a[80:83], v[192:195]
  v_mfma_f32_16x16x32_bf16 v[124:127], a[72:75], a[8:11], v[124:127]
  s_waitcnt vmcnt(5)
  s_waitcnt lgkmcnt(0)
  s_barrier
  ds_read_b128 a[0:3], v31 offset:16384
  v_mfma_f32_16x16x32_bf16 v[160:163], a[76:79], a[8:11], v[160:163]
  ds_read_b64_tr_b16 a[48:49], v42 offset:2048
  ds_read_b64_tr_b16 a[50:51], v42 offset:2560
  v_mfma_f32_16x16x32_bf16 v[196:199], a[8:11], a[80:83], v[196:199]
  s_add_u32 s1, s6, 0
  ds_read_b64_tr_b16 a[52:53], v42 offset:4096
  v_mfma_f32_16x16x32_bf16 v[128:131], a[72:75], a[12:15], v[128:131]
  s_add_u32 m0, s3, 0
  ds_read_b64_tr_b16 a[54:55], v42 offset:4608
  v_mfma_f32_16x16x32_bf16 v[164:167], a[76:79], a[12:15], v[164:167]
  buffer_load_dwordx4 v89, s[60:63], s1 offen lds
  v_mfma_f32_16x16x32_bf16 v[200:203], a[12:15], a[80:83], v[200:203]
  ds_read_b64_tr_b16 a[44:45], v42
  ds_read_b64_tr_b16 a[46:47], v42 offset:512
  v_mfma_f32_16x16x32_bf16 v[132:135], a[72:75], a[16:19], v[132:135]
  ds_read_b128 a[4:7], v31
  ds_read_b128 a[8:11], v31 offset:2048
  v_mfma_f32_16x16x32_bf16 v[168:171], a[76:79], a[16:19], v[168:171]
  ds_read_b128 a[12:15], v31 offset:4096
  ds_read_b64_tr_b16 a[56:57], v46
  v_mfma_f32_16x16x32_bf16 v[204:207], a[16:19], a[80:83], v[204:207]
  buffer_load_dwordx4 v90, s[60:63], s1 offen offset:1024 lds
  v_mfma_f32_16x16x32_bf16 v[136:139], a[72:75], a[20:23], v[136:139]
  ds_read_b128 a[16:19], v31 offset:6144
  ds_read_b64_tr_b16 a[58:59], v46 offset:256
  v_mfma_f32_16x16x32_bf16 v[172:175], a[76:79], a[20:23], v[172:175]
  s_add_u32 s1, s6, 0x3800
  ds_read_b64_tr_b16 a[64:65], v46 offset:1024
  v_mfma_f32_16x16x32_bf16 v[208:211], a[20:23], a[80:83], v[208:211]
  ds_read_b128 a[20:23], v31 offset:8192
  ds_read_b64_tr_b16 a[66:67], v46 offset:1280
  v_mfma_f32_16x16x32_bf16 v[140:143], a[72:75], a[24:27], v[140:143]
  buffer_load_dwordx4 v89, s[60:63], s1 offen offset:2048 lds
  v_mfma_f32_16x16x32_bf16 v[176:179], a[76:79], a[24:27], v[176:179]
  ds_read_b64_tr_b16 a[60:61], v47
  ds_read_b64_tr_b16 a[62:63], v47 offset:256
  v_mfma_f32_16x16x32_bf16 v[212:215], a[24:27], a[80:83], v[212:215]
  ds_read_b128 a[24:27], v31 offset:10240
  ds_read_b64_tr_b16 a[68:69], v47 offset:1024
  v_mfma_f32_16x16x32_bf16 v[144:147], a[72:75], a[28:31], v[144:147]
  ds_read_b64_tr_b16 a[70:71], v47 offset:1280
  ds_read_b32 v10, v81 offset:640
  v_mfma_f32_16x16x32_bf16 v[180:183], a[76:79], a[28:31], v[180:183]
  buffer_load_dwordx4 v90, s[60:63], s1 offen offset:3072 lds
  v_mfma_f32_16x16x32_bf16 v[216:219], a[28:31], a[80:83], v[216:219]
  s_add_u32 s90, s13, 0x10000
  s_mov_b64 exec, 0xffff
  buffer_load_dword v96, v95, s[56:59], s90 offen
  s_mov_b64 exec, -1
  v_mfma_f32_16x16x32_bf16 v[148:151], a[72:75], a[32:35], v[148:151]
  ds_read_b128 a[28:31], v31 offset:12288
  ds_read_b32 v50, v81 offset:704
  v_mfma_f32_16x16x32_bf16 v[184:187], a[76:79], a[32:35], v[184:187]
  s_add_u32 s1, s6, 0x8000
  ds_read_b32 v1, v79 offset:512
  v_mfma_f32_16x16x32_bf16 v[220:223], a[32:35], a[80:83], v[220:223]
  s_add_u32 m0, s3, 0x1000
  ds_read_b128 a[32:35], v31 offset:14336
  v_mfma_f32_16x16x32_bf16 v[224:227], a[84:87], a[36:39], v[224:227]
  buffer_load_dwordx4 v89, s[60:63], s1 offen lds
  v_mfma_f32_16x16x32_bf16 v[240:243], a[92:95], a[36:39], v[240:243]
  ds_read_b128 v[12:15], v80 offset:512
  ds_read_b32 v2, v79
  v_mfma_f32_16x16x32_bf16 v[232:235], a[88:91], a[36:39], v[232:235]
  ds_read_b128 v[16:19], v80
  ds_read_b32 v3, v79 offset:64
  v_mfma_f32_16x16x32_bf16 v[248:251], a[96:99], a[36:39], v[248:251]
  ds_read_b128 a[36:39], v37
  ds_read_b128 v[20:23], v80 offset:64
  v_mfma_f32_16x16x32_bf16 v[228:231], a[84:87], a[40:43], v[228:231]
  buffer_load_dwordx4 v90, s[60:63], s1 offen offset:1024 lds
  v_mfma_f32_16x16x32_bf16 v[244:247], a[92:95], a[40:43], v[244:247]
  ds_read_b32 v4, v79 offset:128
  ds_read_b128 v[52:55], v80 offset:128
  v_mfma_f32_16x16x32_bf16 v[236:239], a[88:91], a[40:43], v[236:239]
  s_add_u32 s1, s6, 0xb800
  ds_read_b32 v5, v79 offset:192
  v_mfma_f32_16x16x32_bf16 v[252:255], a[96:99], a[40:43], v[252:255]
  ds_read_b128 a[40:43], v37 offset:2048
  ds_read_b128 v[100:103], v80 offset:192
  s_waitcnt lgkmcnt(14)
  v_mfma_f32_16x16x32_bf16 v[152:155], a[48:51], a[0:3], v[152:155]
  buffer_load_dwordx4 v89, s[60:63], s1 offen offset:2048 lds
  v_mfma_f32_16x16x32_bf16 v[188:191], a[0:3], a[52:55], v[188:191]
  ds_read_b128 a[0:3], v32 offset:16384
  ds_read_b64_tr_b16 a[76:77], v42 offset:18432
  v_mfma_f32_16x16x32_bf16 v[120:123], a[44:47], a[4:7], v[120:123]
  ds_read_b64_tr_b16 a[78:79], v42 offset:18944
  ds_read_b64_tr_b16 a[80:81], v42 offset:20480
  v_mfma_f32_16x16x32_bf16 v[156:159], a[48:51], a[4:7], v[156:159]
  ds_read_b64_tr_b16 a[82:83], v42 offset:20992
  ds_read_b64_tr_b16 a[72:73], v42 offset:16384
  v_mfma_f32_16x16x32_bf16 v[192:195], a[4:7], a[52:55], v[192:195]
  ds_read_b64_tr_b16 a[74:75], v42 offset:16896
  ds_read_b128 a[4:7], v32
  v_mfma_f32_16x16x32_bf16 v[124:127], a[44:47], a[8:11], v[124:127]
  buffer_load_dwordx4 v90, s[60:63], s1 offen offset:3072 lds
  v_mfma_f32_16x16x32_bf16 v[160:163], a[48:51], a[8:11], v[160:163]
  ds_read_b64_tr_b16 a[84:85], v46 offset:16384
  ds_read_b64_tr_b16 a[86:87], v46 offset:16640
  v_mfma_f32_16x16x32_bf16 v[196:199], a[8:11], a[52:55], v[196:199]
  s_add_u32 s1, s7, 0
  ds_read_b128 a[8:11], v32 offset:2048
  v_mfma_f32_16x16x32_bf16 v[128:131], a[44:47], a[12:15], v[128:131]
  s_add_u32 m0, s3, 0x2000
  ds_read_b64_tr_b16 a[92:93], v46 offset:17408
  v_mfma_f32_16x16x32_bf16 v[164:167], a[48:51], a[12:15], v[164:167]
  buffer_load_dwordx4 v89, s[60:63], s1 offen lds
  v_mfma_f32_16x16x32_bf16 v[200:203], a[12:15], a[52:55], v[200:203]
  ds_read_b128 a[12:15], v32 offset:4096
  ds_read_b64_tr_b16 a[94:95], v46 offset:17664
  v_mfma_f32_16x16x32_bf16 v[132:135], a[44:47], a[16:19], v[132:135]
  ds_read_b64_tr_b16 a[88:89], v47 offset:16384
  ds_read_b64_tr_b16 a[90:91], v47 offset:16640
  v_mfma_f32_16x16x32_bf16 v[168:171], a[48:51], a[16:19], v[168:171]
  ds_read_b64_tr_b16 a[96:97], v47 offset:17408
  ds_read_b64_tr_b16 a[98:99], v47 offset:17664
  v_mfma_f32_16x16x32_bf16 v[204:207], a[16:19], a[52:55], v[204:207]
  buffer_load_dwordx4 v90, s[60:63], s1 offen offset:1024 lds
  v_mfma_f32_16x16x32_bf16 v[136:139], a[44:47], a[20:23], v[136:139]
  ds_read_b128 a[16:19], v32 offset:6144
  ds_read_b32 v6, v79 offset:256
  v_mfma_f32_16x16x32_bf16 v[172:175], a[48:51], a[20:23], v[172:175]
  ds_read_b128 v[104:107], v80 offset:256
  ds_read_b32 v7, v79 offset:320
  v_mfma_f32_16x16x32_bf16 v[208:211], a[20:23], a[52:55], v[208:211]
  s_add_u32 s1, s7, 0x3800
  ds_read_b128 a[20:23], v32 offset:8192
  v_mfma_f32_16x16x32_bf16 v[140:143], a[44:47], a[24:27], v[140:143]
  ds_read_b128 v[108:111], v80 offset:320
  ds_read_b32 v8, v79 offset:384
  v_mfma_f32_16x16x32_bf16 v[176:179], a[48:51], a[24:27], v[176:179]
  buffer_load_dwordx4 v89, s[60:63], s1 offen offset:2048 lds
  v_mfma_f32_16x16x32_bf16 v[212:215], a[24:27], a[52:55], v[212:215]
  ds_read_b128 a[24:27], v32 offset:10240
  ds_read_b128 v[112:115], v80 offset:384
  v_mfma_f32_16x16x32_bf16 v[144:147], a[44:47], a[28:31], v[144:147]
  ds_read_b32 v9, v79 offset:448
  ds_read_b128 v[116:119], v80 offset:448
  v_mfma_f32_16x16x32_bf16 v[180:183], a[48:51], a[28:31], v[180:183]
  v_rsq_f32 v76, v10
  s_nop 0
  v_mul_f32 v77, v76, v76
  v_mfma_f32_16x16x32_bf16 v[216:219], a[28:31], a[52:55], v[216:219]
  buffer_load_dwordx4 v90, s[60:63], s1 offen offset:3072 lds
  s_waitcnt lgkmcnt(13)
  v_mfma_f32_16x16x32_bf16 v[148:151], a[44:47], a[32:35], v[148:151]
  ds_read_b128 a[28:31], v32 offset:12288
  v_mul_f32 v77, v77, v76
  v_mfma_f32_16x16x32_bf16 v[184:187], a[48:51], a[32:35], v[184:187]
  v_mul_f32 v76, 0xc0135761, v76
  v_mul_f32 v77, 0xbdd2d3e8, v77
  v_mfma_f32_16x16x32_bf16 v[220:223], a[32:35], a[52:55], v[220:223]
  ds_read_b128 a[32:35], v32 offset:14336
  v_rsq_f32 v82, v50
  v_mfma_f32_16x16x32_bf16 v[224:227], a[56:59], a[36:39], v[224:227]
  v_mul_f32 v83, v82, v82
  v_mul_f32 v83, v83, v82
  v_mfma_f32_16x16x32_bf16 v[240:243], a[64:67], a[36:39], v[240:243]
  v_mul_f32 v82, 0xc0135761, v82
  v_mul_f32 v83, 0xbdd2d3e8, v83
  v_mfma_f32_16x16x32_bf16 v[232:235], a[60:63], a[36:39], v[232:235]
  v_mfma_f32_16x16x32_bf16 v[248:251], a[68:71], a[36:39], v[248:251]
  ds_read_b128 a[36:39], v38
  v_mfma_f32_16x16x32_bf16 v[228:231], a[56:59], a[40:43], v[228:231]
  v_mfma_f32_16x16x32_bf16 v[244:247], a[64:67], a[40:43], v[244:247]
  v_mfma_f32_16x16x32_bf16 v[236:239], a[60:63], a[40:43], v[236:239]
  v_mfma_f32_16x16x32_bf16 v[252:255], a[68:71], a[40:43], v[252:255]
  ds_read_b128 a[40:43], v38 offset:2048
  v_mfma_f32_16x16x32_bf16 v[152:155], a[76:79], a[0:3], v[152:155]
  v_mfma_f32_16x16x32_bf16 v[188:191], a[0:3], a[80:83], v[188:191]
  v_mfma_f32_16x16x32_bf16 v[120:123], a[72:75], a[4:7], v[120:123]
  v_mfma_f32_16x16x32_bf16 v[156:159], a[76:79], a[4:7], v[156:159]
  v_mfma_f32_16x16x32_bf16 v[192:195], a[4:7], a[80:83], v[192:195]
  v_mfma_f32_16x16x32_bf16 v[124:127], a[72:75], a[8:11], v[124:127]
  s_waitcnt vmcnt(14)
  s_waitcnt lgkmcnt(0)
  s_barrier
  ds_read_b128 a[0:3], v87 offset:2048
  v_mfma_f32_16x16x32_bf16 v[160:163], a[76:79], a[8:11], v[160:163]
  s_add_u32 s1, s7, 0x8000
  ds_read_b64_tr_b16 a[48:49], v43 offset:2048
  v_mfma_f32_16x16x32_bf16 v[196:199], a[8:11], a[80:83], v[196:199]
  s_add_u32 m0, s3, 0xc800
  ds_read_b64_tr_b16 a[50:51], v43 offset:2560
  v_mfma_f32_16x16x32_bf16 v[128:131], a[72:75], a[12:15], v[128:131]
  buffer_load_dwordx4 v89, s[60:63], s1 offen lds
  v_mfma_f32_16x16x32_bf16 v[164:167], a[76:79], a[12:15], v[164:167]
  ds_read_b64_tr_b16 a[52:53], v43 offset:4096
  ds_read_b64_tr_b16 a[54:55], v43 offset:4608
  v_mfma_f32_16x16x32_bf16 v[200:203], a[12:15], a[80:83], v[200:203]
  ds_read_b64_tr_b16 a[44:45], v43
  ds_read_b64_tr_b16 a[46:47], v43 offset:512
  v_mfma_f32_16x16x32_bf16 v[132:135], a[72:75], a[16:19], v[132:135]
  ds_read_b128 a[4:7], v87
  ds_read_b128 a[8:11], v87 offset:256
  v_mfma_f32_16x16x32_bf16 v[168:171], a[76:79], a[16:19], v[168:171]
  buffer_load_dwordx4 v90, s[60:63], s1 offen offset:1024 lds
  v_mfma_f32_16x16x32_bf16 v[204:207], a[16:19], a[80:83], v[204:207]
  ds_read_b128 a[12:15], v87 offset:512
  ds_read_b128 a[16:19], v87 offset:768
  v_mfma_f32_16x16x32_bf16 v[136:139], a[72:75], a[20:23], v[136:139]
  s_add_u32 s1, s7, 0xb800
  ds_read_b64_tr_b16 a[56:57], v48
  v_mfma_f32_16x16x32_bf16 v[172:175], a[76:79], a[20:23], v[172:175]
  ds_read_b64_tr_b16 a[58:59], v48 offset:256
  ds_read_b64_tr_b16 a[64:65], v48 offset:1024
  v_mfma_f32_16x16x32_bf16 v[208:211], a[20:23], a[80:83], v[208:211]
  buffer_load_dwordx4 v89, s[60:63], s1 offen offset:2048 lds
  v_mfma_f32_16x16x32_bf16 v[140:143], a[72:75], a[24:27], v[140:143]
  ds_read_b128 a[20:23], v87 offset:1024
  ds_read_b64_tr_b16 a[66:67], v48 offset:1280
  v_mfma_f32_16x16x32_bf16 v[176:179], a[76:79], a[24:27], v[176:179]
  ds_read_b64_tr_b16 a[60:61], v49
  ds_read_b64_tr_b16 a[62:63], v49 offset:256
  v_mfma_f32_16x16x32_bf16 v[212:215], a[24:27], a[80:83], v[212:215]
  ds_read_b128 a[24:27], v87 offset:1280
  ds_read_b64_tr_b16 a[68:69], v49 offset:1024
  v_mfma_f32_16x16x32_bf16 v[144:147], a[72:75], a[28:31], v[144:147]
  ds_read_b64_tr_b16 a[70:71], v49 offset:1280
  v_lshlrev_b32 v27, 4, v0
  v_mfma_f32_16x16x32_bf16 v[180:183], a[76:79], a[28:31], v[180:183]
  s_waitcnt vmcnt(3)
  buffer_load_dwordx4 v90, s[60:63], s1 offen offset:3072 lds
  v_mfma_f32_16x16x32_bf16 v[216:219], a[28:31], a[80:83], v[216:219]
  ds_read_b128 a[28:31], v87 offset:1536
  s_lshl_b32 s86, s24, 1
  v_mfma_f32_16x16x32_bf16 v[148:151], a[72:75], a[32:35], v[148:151]
  s_add_u32 s1, s7, 0x10000
  s_mul_i32 s86, s86, 0x3c000
  v_mfma_f32_16x16x32_bf16 v[184:187], a[76:79], a[32:35], v[184:187]
  s_add_u32 m0, s3, 0xd800
  s_lshr_b32 s87, s25, 1
  v_mfma_f32_16x16x32_bf16 v[220:223], a[32:35], a[80:83], v[220:223]
  buffer_load_dwordx4 v89, s[60:63], s1 offen lds
  v_mfma_f32_16x16x32_bf16 v[224:227], a[84:87], a[36:39], v[224:227]
  ds_read_b128 a[32:35], v87 offset:1792
  s_mul_i32 s87, s87, 0xf000
  v_mfma_f32_16x16x32_bf16 v[240:243], a[92:95], a[36:39], v[240:243]
  s_add_u32 s86, s86, s87
  s_and_b32 s88, s25, 1
  v_mfma_f32_16x16x32_bf16 v[232:235], a[88:91], a[36:39], v[232:235]
  s_lshl2_add_u32 s87, s88, s26
  s_add_u32 s87, s87, 16
  v_mfma_f32_16x16x32_bf16 v[248:251], a[96:99], a[36:39], v[248:251]
  buffer_load_dwordx4 v90, s[60:63], s1 offen offset:1024 lds
  v_mfma_f32_16x16x32_bf16 v[228:231], a[84:87], a[40:43], v[228:231]
  ds_read_b128 a[36:39], v88
  s_lshl_b32 s87, s87, 11
  v_mfma_f32_16x16x32_bf16 v[244:247], a[92:95], a[40:43], v[244:247]
  s_add_u32 s10, s86, s87
  s_add_u32 s11, s10, 0x3c000
  v_mfma_f32_16x16x32_bf16 v[236:239], a[88:91], a[40:43], v[236:239]
  s_add_u32 s1, s7, 0x13800
  s_lshr_b32 s87, s26, 1
  v_mfma_f32_16x16x32_bf16 v[252:255], a[96:99], a[40:43], v[252:255]
  ds_read_b128 a[40:43], v88 offset:256
  s_mul_i32 s87, s87, 0x3c000
  s_waitcnt lgkmcnt(3)
  v_mfma_f32_16x16x32_bf16 v[152:155], a[48:51], a[0:3], v[152:155]
  buffer_load_dwordx4 v89, s[60:63], s1 offen offset:2048 lds
  v_mfma_f32_16x16x32_bf16 v[188:191], a[0:3], a[52:55], v[188:191]
  s_add_u32 s86, s86, s87
  s_lshl_b32 s87, s88, 12
  v_mfma_f32_16x16x32_bf16 v[120:123], a[44:47], a[4:7], v[120:123]
  s_add_u32 s86, s86, s87
  s_and_b32 s87, s26, 1
  v_mfma_f32_16x16x32_bf16 v[156:159], a[48:51], a[4:7], v[156:159]
  s_lshl_b32 s87, s87, 10
  s_add_u32 s90, s86, s87
  v_mfma_f32_16x16x32_bf16 v[192:195], a[4:7], a[52:55], v[192:195]
  buffer_load_dwordx4 v90, s[60:63], s1 offen offset:3072 lds
  v_mfma_f32_16x16x32_bf16 v[124:127], a[44:47], a[8:11], v[124:127]
  s_mov_b32 s87, 0x3f803f80
  v_accvgpr_write_b32 a220, s87
  v_mfma_f32_16x16x32_bf16 v[160:163], a[48:51], a[8:11], v[160:163]
  v_accvgpr_write_b32 a221, s87
  v_accvgpr_write_b32 a222, s87
  v_mfma_f32_16x16x32_bf16 v[196:199], a[8:11], a[52:55], v[196:199]
  s_add_u32 s1, s12, 0
  v_accvgpr_write_b32 a223, s87
  v_mfma_f32_16x16x32_bf16 v[128:131], a[44:47], a[12:15], v[128:131]
  s_add_u32 m0, s3, 0xe800
  ds_read_b64_tr_b16 a[124:125], v91
  v_mfma_f32_16x16x32_bf16 v[164:167], a[48:51], a[12:15], v[164:167]
  buffer_load_dwordx4 v89, s[60:63], s1 offen lds
  v_mfma_f32_16x16x32_bf16 v[200:203], a[12:15], a[52:55], v[200:203]
  ds_read_b64_tr_b16 a[126:127], v91 offset:512
  ds_read_b64_tr_b16 a[128:129], v92
  v_mfma_f32_16x16x32_bf16 v[132:135], a[44:47], a[16:19], v[132:135]
  ds_read_b64_tr_b16 a[130:131], v92 offset:512
  ds_read_b64_tr_b16 a[132:133], v93
  v_mfma_f32_16x16x32_bf16 v[168:171], a[48:51], a[16:19], v[168:171]
  ds_read_b64_tr_b16 a[134:135], v93 offset:512
  ds_read_b64_tr_b16 a[136:137], v94
  v_mfma_f32_16x16x32_bf16 v[204:207], a[16:19], a[52:55], v[204:207]
  buffer_load_dwordx4 v90, s[60:63], s1 offen offset:1024 lds
  v_mfma_f32_16x16x32_bf16 v[136:139], a[44:47], a[20:23], v[136:139]
  ds_read_b64_tr_b16 a[138:139], v94 offset:512
  ds_read_b64_tr_b16 a[140:141], v91 offset:4096
  v_mfma_f32_16x16x32_bf16 v[172:175], a[48:51], a[20:23], v[172:175]
  s_add_u32 s1, s12, 0x3800
  ds_read_b64_tr_b16 a[142:143], v91 offset:4608
  v_mfma_f32_16x16x32_bf16 v[208:211], a[20:23], a[52:55], v[208:211]
  ds_read_b64_tr_b16 a[144:145], v92 offset:4096
  ds_read_b64_tr_b16 a[146:147], v92 offset:4608
  v_mfma_f32_16x16x32_bf16 v[140:143], a[44:47], a[24:27], v[140:143]
  buffer_load_dwordx4 v89, s[60:63], s1 offen offset:2048 lds
  v_mfma_f32_16x16x32_bf16 v[176:179], a[48:51], a[24:27], v[176:179]
  ds_read_b64_tr_b16 a[148:149], v93 offset:4096
  ds_read_b64_tr_b16 a[150:151], v93 offset:4608
  v_mfma_f32_16x16x32_bf16 v[212:215], a[24:27], a[52:55], v[212:215]
  ds_read_b64_tr_b16 a[152:153], v94 offset:4096
  ds_read_b64_tr_b16 a[154:155], v94 offset:4608
  v_mfma_f32_16x16x32_bf16 v[144:147], a[44:47], a[28:31], v[144:147]
  ds_read_b64_tr_b16 a[156:157], v91 offset:8192
  ds_read_b64_tr_b16 a[158:159], v91 offset:8704
  v_mfma_f32_16x16x32_bf16 v[180:183], a[48:51], a[28:31], v[180:183]
  ds_read_b64_tr_b16 a[160:161], v92 offset:8192
  ds_read_b64_tr_b16 a[162:163], v92 offset:8704
  v_mfma_f32_16x16x32_bf16 v[216:219], a[28:31], a[52:55], v[216:219]
  buffer_load_dwordx4 v90, s[60:63], s1 offen offset:3072 lds
  s_waitcnt lgkmcnt(14)
  v_mfma_f32_16x16x32_bf16 v[148:151], a[44:47], a[32:35], v[148:151]
  ds_read_b64_tr_b16 a[164:165], v93 offset:8192
  ds_read_b64_tr_b16 a[166:167], v93 offset:8704
  v_mfma_f32_16x16x32_bf16 v[184:187], a[48:51], a[32:35], v[184:187]
  ds_read_b64_tr_b16 a[168:169], v94 offset:8192
  ds_read_b64_tr_b16 a[170:171], v94 offset:8704
  v_mfma_f32_16x16x32_bf16 v[220:223], a[32:35], a[52:55], v[220:223]
  v_mfma_f32_16x16x32_bf16 v[224:227], a[56:59], a[36:39], v[224:227]
  v_mfma_f32_16x16x32_bf16 v[240:243], a[64:67], a[36:39], v[240:243]
  v_mfma_f32_16x16x32_bf16 v[232:235], a[60:63], a[36:39], v[232:235]
  v_mfma_f32_16x16x32_bf16 v[248:251], a[68:71], a[36:39], v[248:251]
  v_mfma_f32_16x16x32_bf16 v[228:231], a[56:59], a[40:43], v[228:231]
  v_mfma_f32_16x16x32_bf16 v[244:247], a[64:67], a[40:43], v[244:247]
  v_mfma_f32_16x16x32_bf16 v[236:239], a[60:63], a[40:43], v[236:239]
  v_mfma_f32_16x16x32_bf16 v[252:255], a[68:71], a[40:43], v[252:255]
  s_barrier
  s_add_u32 s1, s12, 0x8000
  s_add_u32 m0, s3, 0x19000
  v_pk_mul_f32 v[36:37], v[224:225], v[224:225]
  buffer_load_dwordx4 v89, s[60:63], s1 offen lds
  v_pk_mul_f32 v[42:43], v[226:227], v[226:227]
  v_pk_mul_f32 v[48:49], v[228:229], v[228:229]
  v_pk_mul_f32 v[38:39], v[224:225], v[240:241]
  v_pk_mul_f32 v[44:45], v[226:227], v[242:243]
  v_pk_mul_f32 v[78:79], v[228:229], v[244:245]
  v_pk_fma_f32 v[36:37], v[36:37], v[76:77], v[76:77] op_sel:[0,1,0] op_sel_hi:[1,1,0]
  v_pk_fma_f32 v[42:43], v[42:43], v[76:77], v[76:77] op_sel:[0,1,0] op_sel_hi:[1,1,0]
  v_pk_fma_f32 v[48:49], v[48:49], v[82:83], v[82:83] op_sel:[0,1,0] op_sel_hi:[1,1,0]
  v_pk_mul_f32 v[36:37], v[224:225], v[36:37]
  v_pk_mul_f32 v[42:43], v[226:227], v[42:43]
  v_pk_mul_f32 v[48:49], v[228:229], v[48:49]
  v_exp_f32 v40, v36
  v_exp_f32 v46, v42
  buffer_load_dwordx4 v90, s[60:63], s1 offen offset:1024 lds
  s_add_u32 s1, s12, 0xb800
  v_exp_f32 v80, v48
  v_exp_f32 v41, v37
  v_exp_f32 v47, v43
  v_exp_f32 v81, v49
  v_pk_fma_f32 v[40:41], v[40:41], v[10:11], v[10:11] op_sel_hi:[1,0,0]
  v_pk_fma_f32 v[46:47], v[46:47], v[10:11], v[10:11] op_sel_hi:[1,0,0]
  v_pk_fma_f32 v[80:81], v[80:81], v[50:51], v[50:51] op_sel_hi:[1,0,0]
  v_rcp_f32 v40, v40
  v_rcp_f32 v46, v46
  v_rcp_f32 v80, v80
  v_rcp_f32 v41, v41
  v_rcp_f32 v47, v47
  v_rcp_f32 v81, v81
  buffer_load_dwordx4 v89, s[60:63], s1 offen offset:2048 lds
  v_pk_mul_f32 v[38:39], v[38:39], v[40:41]
  v_pk_mul_f32 v[44:45], v[44:45], v[46:47]
  v_pk_mul_f32 v[78:79], v[78:79], v[80:81]
  v_cvt_pk_bf16_f32 v28, v38, v39
  v_cvt_pk_bf16_f32 v29, v44, v45
  v_cvt_pk_bf16_f32 v30, v78, v79
  v_pk_mul_f32 v[36:37], v[230:231], v[230:231]
  v_pk_mul_f32 v[38:39], v[230:231], v[246:247]
  v_pk_fma_f32 v[36:37], v[36:37], v[82:83], v[82:83] op_sel:[0,1,0] op_sel_hi:[1,1,0]
  v_pk_mul_f32 v[36:37], v[230:231], v[36:37]
  v_exp_f32 v40, v36
  v_exp_f32 v41, v37
  s_nop 0
  v_pk_fma_f32 v[40:41], v[40:41], v[50:51], v[50:51] op_sel_hi:[1,0,0]
  buffer_load_dwordx4 v90, s[60:63], s1 offen offset:3072 lds
  s_add_u32 s1, s12, 0x10000
  s_add_u32 m0, s3, 0x1a000
  v_rcp_f32 v40, v40
  v_rcp_f32 v41, v41
  s_nop 0
  v_pk_mul_f32 v[38:39], v[38:39], v[40:41]
  v_cvt_pk_bf16_f32 v31, v38, v39
  v_permlane16_swap_b32 v28, v30
  s_nop 0
  v_permlane16_swap_b32 v29, v31
  buffer_store_dwordx4 v[28:31], v27, s[48:51], s90 offen sc1
  v_pk_mul_f32 v[36:37], v[232:233], v[232:233]
  v_pk_mul_f32 v[42:43], v[234:235], v[234:235]
  v_pk_mul_f32 v[48:49], v[236:237], v[236:237]
  v_pk_mul_f32 v[38:39], v[232:233], v[248:249]
  v_pk_mul_f32 v[44:45], v[234:235], v[250:251]
  v_pk_mul_f32 v[78:79], v[236:237], v[252:253]
  v_pk_fma_f32 v[36:37], v[36:37], v[76:77], v[76:77] op_sel:[0,1,0] op_sel_hi:[1,1,0]
  v_pk_fma_f32 v[42:43], v[42:43], v[76:77], v[76:77] op_sel:[0,1,0] op_sel_hi:[1,1,0]
  v_pk_fma_f32 v[48:49], v[48:49], v[82:83], v[82:83] op_sel:[0,1,0] op_sel_hi:[1,1,0]
  v_pk_mul_f32 v[36:37], v[232:233], v[36:37]
  v_pk_mul_f32 v[42:43], v[234:235], v[42:43]
  v_pk_mul_f32 v[48:49], v[236:237], v[48:49]
  v_exp_f32 v40, v36
  buffer_load_dwordx4 v89, s[60:63], s1 offen lds
  v_exp_f32 v46, v42
  v_exp_f32 v80, v48
  v_exp_f32 v41, v37
  v_exp_f32 v47, v43
  v_exp_f32 v81, v49
  v_pk_fma_f32 v[40:41], v[40:41], v[10:11], v[10:11] op_sel_hi:[1,0,0]
  v_pk_fma_f32 v[46:47], v[46:47], v[10:11], v[10:11] op_sel_hi:[1,0,0]
  v_pk_fma_f32 v[80:81], v[80:81], v[50:51], v[50:51] op_sel_hi:[1,0,0]
  v_rcp_f32 v40, v40
  v_rcp_f32 v46, v46
  v_rcp_f32 v80, v80
  v_rcp_f32 v41, v41
  v_rcp_f32 v47, v47
  buffer_load_dwordx4 v90, s[60:63], s1 offen offset:1024 lds
  s_add_u32 s1, s12, 0x13800
  v_rcp_f32 v81, v81
  v_pk_mul_f32 v[38:39], v[38:39], v[40:41]
  v_pk_mul_f32 v[44:45], v[44:45], v[46:47]
  v_pk_mul_f32 v[78:79], v[78:79], v[80:81]
  v_cvt_pk_bf16_f32 v32, v38, v39
  v_cvt_pk_bf16_f32 v33, v44, v45
  v_cvt_pk_bf16_f32 v34, v78, v79
  v_pk_mul_f32 v[36:37], v[238:239], v[238:239]
  v_pk_mul_f32 v[38:39], v[238:239], v[254:255]
  v_pk_fma_f32 v[36:37], v[36:37], v[82:83], v[82:83] op_sel:[0,1,0] op_sel_hi:[1,1,0]
  v_pk_mul_f32 v[36:37], v[238:239], v[36:37]
  v_exp_f32 v40, v36
  v_exp_f32 v41, v37
  buffer_load_dwordx4 v89, s[60:63], s1 offen offset:2048 lds
  v_pk_fma_f32 v[40:41], v[40:41], v[50:51], v[50:51] op_sel_hi:[1,0,0]
  v_rcp_f32 v40, v40
  v_rcp_f32 v41, v41
  s_nop 0
  v_pk_mul_f32 v[38:39], v[38:39], v[40:41]
  v_cvt_pk_bf16_f32 v35, v38, v39
  v_permlane16_swap_b32 v32, v34
  s_nop 0
  v_permlane16_swap_b32 v33, v35
  buffer_store_dwordx4 v[32:35], v27, s[48:51], s90 offen offset:2048 sc1
  v_pk_mul_f32 v[152:153], v[152:153], v[0:1] op_sel:[0,1] op_sel_hi:[1,1]
  v_pk_mul_f32 v[188:189], v[188:189], v[12:13]
  v_pk_mul_f32 v[154:155], v[154:155], v[0:1] op_sel:[0,1] op_sel_hi:[1,1]
  v_pk_mul_f32 v[190:191], v[190:191], v[14:15]
  v_cvt_pk_bf16_f32 v152, v152, v153
  v_cvt_pk_bf16_f32 v36, v188, v189
  v_mov_b32 v76, v36
  v_cvt_pk_bf16_f32 v153, v154, v155
  v_cvt_pk_bf16_f32 v37, v190, v191
  v_mov_b32 v77, v37
  v_pk_mul_f32 v[156:157], v[156:157], v[2:3] op_sel_hi:[1,0]
  v_pk_mul_f32 v[192:193], v[192:193], v[16:17]
  v_pk_mul_f32 v[158:159], v[158:159], v[2:3] op_sel_hi:[1,0]
  buffer_load_dwordx4 v90, s[60:63], s1 offen offset:3072 lds
  s_add_u32 s1, s13, 0
  s_branch L_skip4A
.p2align 12
L_pad4A:
  s_setpc_b64 s[20:21]
L_skip4A:
  s_add_u32 m0, s3, 0x1b000
  v_pk_mul_f32 v[194:195], v[194:195], v[18:19]
  v_mul_f32 v10, 0x3eb8aa3b, v2
  v_pk_mul_f32 v[120:121], v[120:121], v[10:11] op_sel_hi:[1,0]
  v_pk_mul_f32 v[122:123], v[122:123], v[10:11] op_sel_hi:[1,0]
  v_cvt_pk_bf16_f32 v156, v156, v157
  v_cvt_pk_bf16_f32 v38, v192, v193
  v_cvt_pk_bf16_f32 v120, v120, v121
  v_cvt_pk_bf16_f32 v157, v158, v159
  v_cvt_pk_bf16_f32 v39, v194, v195
  v_cvt_pk_bf16_f32 v121, v122, v123
  v_pk_mul_f32 v[160:161], v[160:161], v[2:3] op_sel:[0,1] op_sel_hi:[1,1]
  v_pk_mul_f32 v[196:197], v[196:197], v[20:21]
  v_pk_mul_f32 v[162:163], v[162:163], v[2:3] op_sel:[0,1] op_sel_hi:[1,1]
  buffer_load_dwordx4 v89, s[56:59], s1 offen lds
  v_pk_mul_f32 v[198:199], v[198:199], v[22:23]
  v_mul_f32 v10, 0x3eb8aa3b, v3
  v_pk_mul_f32 v[124:125], v[124:125], v[10:11] op_sel_hi:[1,0]
  v_pk_mul_f32 v[126:127], v[126:127], v[10:11] op_sel_hi:[1,0]
  v_cvt_pk_bf16_f32 v160, v160, v161
  v_cvt_pk_bf16_f32 v78, v196, v197
  v_cvt_pk_bf16_f32 v124, v124, v125
  v_cvt_pk_bf16_f32 v161, v162, v163
  v_cvt_pk_bf16_f32 v79, v198, v199
  v_cvt_pk_bf16_f32 v125, v126, v127
  v_pk_mul_f32 v[164:165], v[164:165], v[4:5] op_sel_hi:[1,0]
  v_pk_mul_f32 v[200:201], v[200:201], v[52:53]
  v_pk_mul_f32 v[166:167], v[166:167], v[4:5] op_sel_hi:[1,0]
  buffer_load_dwordx4 v90, s[56:59], s1 offen offset:1024 lds
  s_add_u32 s1, s13, 0x3800
  v_pk_mul_f32 v[202:203], v[202:203], v[54:55]
  v_mul_f32 v10, 0x3eb8aa3b, v4
  v_pk_mul_f32 v[128:129], v[128:129], v[10:11] op_sel_hi:[1,0]
  v_pk_mul_f32 v[130:131], v[130:131], v[10:11] op_sel_hi:[1,0]
  v_cvt_pk_bf16_f32 v164, v164, v165
  v_cvt_pk_bf16_f32 v40, v200, v201
  v_cvt_pk_bf16_f32 v128, v128, v129
  v_cvt_pk_bf16_f32 v165, v166, v167
  v_cvt_pk_bf16_f32 v41, v202, v203
  v_cvt_pk_bf16_f32 v129, v130, v131
  v_pk_mul_f32 v[168:169], v[168:169], v[4:5] op_sel:[0,1] op_sel_hi:[1,1]
  v_pk_mul_f32 v[204:205], v[204:205], v[100:101]
  v_pk_mul_f32 v[170:171], v[170:171], v[4:5] op_sel:[0,1] op_sel_hi:[1,1]
  buffer_load_dwordx4 v89, s[56:59], s1 offen offset:2048 lds
  v_pk_mul_f32 v[206:207], v[206:207], v[102:103]
  v_mul_f32 v10, 0x3eb8aa3b, v5
  v_pk_mul_f32 v[132:133], v[132:133], v[10:11] op_sel_hi:[1,0]
  v_pk_mul_f32 v[134:135], v[134:135], v[10:11] op_sel_hi:[1,0]
  v_cvt_pk_bf16_f32 v168, v168, v169
  v_cvt_pk_bf16_f32 v80, v204, v205
  v_cvt_pk_bf16_f32 v132, v132, v133
  v_cvt_pk_bf16_f32 v169, v170, v171
  v_cvt_pk_bf16_f32 v81, v206, v207
  v_cvt_pk_bf16_f32 v133, v134, v135
  v_pk_mul_f32 v[172:173], v[172:173], v[6:7] op_sel_hi:[1,0]
  v_pk_mul_f32 v[208:209], v[208:209], v[104:105]
  v_pk_mul_f32 v[174:175], v[174:175], v[6:7] op_sel_hi:[1,0]
  buffer_load_dwordx4 v90, s[56:59], s1 offen offset:3072 lds
  s_waitcnt lgkmcnt(0)
  s_add_u32 s1, s13, 0x8000
  s_add_u32 m0, s3, 0
  v_pk_mul_f32 v[210:211], v[210:211], v[106:107]
  v_mul_f32 v10, 0x3eb8aa3b, v6
  v_pk_mul_f32 v[136:137], v[136:137], v[10:11] op_sel_hi:[1,0]
  v_pk_mul_f32 v[138:139], v[138:139], v[10:11] op_sel_hi:[1,0]
  v_cvt_pk_bf16_f32 v172, v172, v173
  v_cvt_pk_bf16_f32 v42, v208, v209
  v_cvt_pk_bf16_f32 v136, v136, v137
  v_cvt_pk_bf16_f32 v173, v174, v175
  v_cvt_pk_bf16_f32 v43, v210, v211
  v_cvt_pk_bf16_f32 v137, v138, v139
  v_pk_mul_f32 v[176:177], v[176:177], v[6:7] op_sel:[0,1] op_sel_hi:[1,1]
  v_pk_mul_f32 v[212:213], v[212:213], v[108:109]
  v_pk_mul_f32 v[178:179], v[178:179], v[6:7] op_sel:[0,1] op_sel_hi:[1,1]
  buffer_load_dwordx4 v89, s[56:59], s1 offen lds
  v_pk_mul_f32 v[214:215], v[214:215], v[110:111]
  v_mul_f32 v10, 0x3eb8aa3b, v7
  v_pk_mul_f32 v[140:141], v[140:141], v[10:11] op_sel_hi:[1,0]
  v_pk_mul_f32 v[142:143], v[142:143], v[10:11] op_sel_hi:[1,0]
  v_cvt_pk_bf16_f32 v176, v176, v177
  v_cvt_pk_bf16_f32 v82, v212, v213
  v_cvt_pk_bf16_f32 v140, v140, v141
  v_cvt_pk_bf16_f32 v177, v178, v179
  v_cvt_pk_bf16_f32 v83, v214, v215
  v_cvt_pk_bf16_f32 v141, v142, v143
  v_pk_mul_f32 v[180:181], v[180:181], v[8:9] op_sel_hi:[1,0]
  v_pk_mul_f32 v[216:217], v[216:217], v[112:113]
  v_pk_mul_f32 v[182:183], v[182:183], v[8:9] op_sel_hi:[1,0]
  buffer_load_dwordx4 v90, s[56:59], s1 offen offset:1024 lds
  s_add_u32 s1, s13, 0xb800
  v_pk_mul_f32 v[218:219], v[218:219], v[114:115]
  v_mul_f32 v10, 0x3eb8aa3b, v8
  v_pk_mul_f32 v[144:145], v[144:145], v[10:11] op_sel_hi:[1,0]
  v_pk_mul_f32 v[146:147], v[146:147], v[10:11] op_sel_hi:[1,0]
  v_cvt_pk_bf16_f32 v180, v180, v181
  v_cvt_pk_bf16_f32 v44, v216, v217
  v_cvt_pk_bf16_f32 v144, v144, v145
  v_cvt_pk_bf16_f32 v181, v182, v183
  v_cvt_pk_bf16_f32 v45, v218, v219
  v_cvt_pk_bf16_f32 v145, v146, v147
  v_pk_mul_f32 v[184:185], v[184:185], v[8:9] op_sel:[0,1] op_sel_hi:[1,1]
  v_pk_mul_f32 v[220:221], v[220:221], v[116:117]
  v_pk_mul_f32 v[186:187], v[186:187], v[8:9] op_sel:[0,1] op_sel_hi:[1,1]
  buffer_load_dwordx4 v89, s[56:59], s1 offen offset:2048 lds
  v_pk_mul_f32 v[222:223], v[222:223], v[118:119]
  v_mul_f32 v10, 0x3eb8aa3b, v9
  v_pk_mul_f32 v[148:149], v[148:149], v[10:11] op_sel_hi:[1,0]
  v_pk_mul_f32 v[150:151], v[150:151], v[10:11] op_sel_hi:[1,0]
  v_cvt_pk_bf16_f32 v184, v184, v185
  v_cvt_pk_bf16_f32 v84, v220, v221
  v_cvt_pk_bf16_f32 v148, v148, v149
  v_cvt_pk_bf16_f32 v185, v186, v187
  v_cvt_pk_bf16_f32 v85, v222, v223
  v_cvt_pk_bf16_f32 v149, v150, v151
  s_waitcnt vmcnt(8)
  s_barrier
  s_cmp_lg_u32 s26, 0
  s_cbranch_scc1 L_A_pub2a
  s_lshl_b32 s86, s24, 8
  s_lshl2_add_u32 s86, s30, s86
  s_add_u32 s86, s86, 0x872000
  v_mov_b32 v46, s86
  v_mov_b32 v47, s29
  s_mov_b64 exec, 1
  buffer_store_dword v47, v46, s[48:51], 0 offen sc0 sc1
  s_mov_b64 exec, -1
L_A_pub2a:
  v_mfma_f32_16x16x16_bf16 v[4:7], v[156:157], v[120:121], v[56:59]
  v_mfma_f32_16x16x16_bf16 v[48:51], v[160:161], v[124:125], v[56:59]
  v_mfma_f32_16x16x16_bf16 v[108:111], v[164:165], v[128:129], v[56:59]
  v_mfma_f32_16x16x16_bf16 v[196:199], v[168:169], v[132:133], v[56:59]
  v_mfma_f32_16x16x16_bf16 v[8:11], v[152:153], v[120:121], v[64:67]
  v_mfma_f32_16x16x16_bf16 v[52:55], v[152:153], v[124:125], v[68:71]
  v_mfma_f32_16x16x16_bf16 v[112:115], v[156:157], v[128:129], v[60:63]
  v_mfma_f32_16x16x16_bf16 v[200:203], v[160:161], v[132:133], v[60:63]
  s_nop 4
  v_max_f32 v4, v4, v8
  v_max_f32 v48, v48, v52
  v_max_f32 v108, v108, v112
  v_max_f32 v196, v196, v200
  v_max_f32 v5, v5, v9
  buffer_load_dwordx4 v90, s[56:59], s1 offen offset:3072 lds
  s_add_u32 s1, s13, 0x10000
  s_add_u32 m0, s3, 0x1000
  v_max_f32 v49, v49, v53
  v_max_f32 v109, v109, v113
  v_max_f32 v197, v197, v201
  v_max_f32 v6, v6, v10
  v_max_f32 v50, v50, v54
  v_max_f32 v110, v110, v114
  v_max_f32 v198, v198, v202
  v_max_f32 v7, v7, v11
  v_max_f32 v51, v51, v55
  v_max_f32 v111, v111, v115
  v_max_f32 v199, v199, v203
  v_max3_f32 v21, v4, v5, v6
  v_max3_f32 v105, v48, v49, v50
  buffer_load_dwordx4 v89, s[56:59], s1 offen lds
  v_max3_f32 v193, v108, v109, v110
  v_max3_f32 v213, v196, v197, v198
  v_max_f32 v21, v21, v7
  v_max_f32 v105, v105, v51
  v_max_f32 v193, v193, v111
  v_max_f32 v213, v213, v199
  v_mov_b32 v22, v21
  v_mov_b32 v106, v105
  v_mov_b32 v194, v193
  v_mov_b32 v214, v213
  v_permlane16_swap_b32 v21, v22
  v_permlane16_swap_b32 v105, v106
  v_permlane16_swap_b32 v193, v194
  buffer_load_dwordx4 v90, s[56:59], s1 offen offset:1024 lds
  s_add_u32 s1, s13, 0x13800
  v_permlane16_swap_b32 v213, v214
  v_max_f32 v21, v21, v22
  v_max_f32 v105, v105, v106
  v_max_f32 v193, v193, v194
  v_max_f32 v213, v213, v214
  v_mov_b32 v22, v21
  v_mov_b32 v106, v105
  v_mov_b32 v194, v193
  v_mov_b32 v214, v213
  v_permlane32_swap_b32 v21, v22
  v_permlane32_swap_b32 v105, v106
  v_permlane32_swap_b32 v193, v194
  v_permlane32_swap_b32 v213, v214
  buffer_load_dwordx4 v89, s[56:59], s1 offen offset:2048 lds
  v_max_f32 v21, v21, v22
  v_max_f32 v105, v105, v106
  v_max_f32 v193, v193, v194
  v_max_f32 v213, v213, v214
  v_pk_add_f32 v[4:5], v[4:5], v[20:21] op_sel:[0,1] op_sel_hi:[1,1] neg_lo:[0,1] neg_hi:[0,1]
  v_pk_add_f32 v[48:49], v[48:49], v[104:105] op_sel:[0,1] op_sel_hi:[1,1] neg_lo:[0,1] neg_hi:[0,1]
  v_pk_add_f32 v[108:109], v[108:109], v[192:193] op_sel:[0,1] op_sel_hi:[1,1] neg_lo:[0,1] neg_hi:[0,1]
  v_pk_add_f32 v[196:197], v[196:197], v[212:213] op_sel:[0,1] op_sel_hi:[1,1] neg_lo:[0,1] neg_hi:[0,1]
  v_pk_add_f32 v[6:7], v[6:7], v[20:21] op_sel:[0,1] op_sel_hi:[1,1] neg_lo:[0,1] neg_hi:[0,1]
  v_pk_add_f32 v[50:51], v[50:51], v[104:105] op_sel:[0,1] op_sel_hi:[1,1] neg_lo:[0,1] neg_hi:[0,1]
  v_pk_add_f32 v[110:111], v[110:111], v[192:193] op_sel:[0,1] op_sel_hi:[1,1] neg_lo:[0,1] neg_hi:[0,1]
  v_pk_add_f32 v[198:199], v[198:199], v[212:213] op_sel:[0,1] op_sel_hi:[1,1] neg_lo:[0,1] neg_hi:[0,1]
  v_exp_f32 v4, v4
  buffer_load_dwordx4 v90, s[56:59], s1 offen offset:3072 lds
  s_add_u32 s1, s13, 0x18000
  s_add_u32 m0, s3, 0x2000
  v_exp_f32 v48, v48
  v_exp_f32 v108, v108
  v_exp_f32 v196, v196
  v_exp_f32 v5, v5
  v_exp_f32 v49, v49
  v_exp_f32 v109, v109
  v_exp_f32 v197, v197
  v_exp_f32 v6, v6
  v_exp_f32 v50, v50
  v_exp_f32 v110, v110
  v_exp_f32 v198, v198
  v_exp_f32 v7, v7
  v_exp_f32 v51, v51
  buffer_load_dwordx4 v89, s[56:59], s1 offen lds
  v_exp_f32 v111, v111
  v_exp_f32 v199, v199
  v_cvt_pk_bf16_f32 v8, v4, v5
  v_cvt_pk_bf16_f32 v52, v48, v49
  v_cvt_pk_bf16_f32 v112, v108, v109
  v_cvt_pk_bf16_f32 v200, v196, v197
  v_cvt_pk_bf16_f32 v9, v6, v7
  v_cvt_pk_bf16_f32 v53, v50, v51
  v_cvt_pk_bf16_f32 v113, v110, v111
  v_cvt_pk_bf16_f32 v201, v198, v199
  v_and_b32 v12, v8, v72
  v_and_b32 v96, v52, v72
  v_and_b32 v116, v112, v72
  buffer_load_dwordx4 v90, s[56:59], s1 offen offset:1024 lds
  s_add_u32 s1, s13, 0x1b800
  v_and_b32 v204, v200, v72
  v_and_b32 v13, v9, v73
  v_and_b32 v97, v53, v73
  v_and_b32 v117, v113, v73
  v_and_b32 v205, v201, v73
  v_and_b32 v14, v8, v74
  v_and_b32 v98, v52, v74
  v_and_b32 v118, v112, v74
  v_and_b32 v206, v200, v74
  v_and_b32 v15, v9, v75
  v_and_b32 v99, v53, v75
  v_and_b32 v119, v113, v75
  v_and_b32 v207, v201, v75
  buffer_load_dwordx4 v89, s[56:59], s1 offen offset:2048 lds
  v_mfma_f32_16x16x32_bf16 v[20:23], a[220:223], v[12:15], 0
  v_mfma_f32_16x16x32_bf16 v[104:107], a[220:223], v[96:99], 0
  v_mfma_f32_16x16x32_bf16 v[192:195], a[220:223], v[116:119], 0
  v_mfma_f32_16x16x32_bf16 v[212:215], a[220:223], v[204:207], 0
  v_mfma_f32_16x16x32_bf16 v[16:19], v[36:39], v[12:15], 0
  v_mfma_f32_16x16x32_bf16 v[100:103], v[76:79], v[96:99], 0
  v_mfma_f32_16x16x32_bf16 v[188:191], v[38:41], v[116:119], 0
  v_mfma_f32_16x16x32_bf16 v[208:211], v[78:81], v[204:207], 0
  s_nop 0
  v_rcp_f32 v20, v20
  v_rcp_f32 v104, v104
  v_rcp_f32 v192, v192
  v_rcp_f32 v212, v212
  v_pk_mul_f32 v[16:17], v[16:17], v[20:21] op_sel_hi:[1,0]
  buffer_load_dwordx4 v90, s[56:59], s1 offen offset:3072 lds
  v_pk_mul_f32 v[100:101], v[100:101], v[104:105] op_sel_hi:[1,0]
  v_pk_mul_f32 v[188:189], v[188:189], v[192:193] op_sel_hi:[1,0]
  v_pk_mul_f32 v[208:209], v[208:209], v[212:213] op_sel_hi:[1,0]
  v_pk_mul_f32 v[18:19], v[18:19], v[20:21] op_sel_hi:[1,0]
  v_pk_mul_f32 v[102:103], v[102:103], v[104:105] op_sel_hi:[1,0]
  v_pk_mul_f32 v[190:191], v[190:191], v[192:193] op_sel_hi:[1,0]
  v_pk_mul_f32 v[210:211], v[210:211], v[212:213] op_sel_hi:[1,0]
  v_cvt_pk_bf16_f32 v28, v16, v17
  v_cvt_pk_bf16_f32 v30, v100, v101
  v_cvt_pk_bf16_f32 v32, v188, v189
  v_cvt_pk_bf16_f32 v34, v208, v209
  v_cvt_pk_bf16_f32 v29, v18, v19
  v_cvt_pk_bf16_f32 v31, v102, v103
  v_cvt_pk_bf16_f32 v33, v190, v191
  v_cvt_pk_bf16_f32 v35, v210, v211
  v_permlane16_swap_b32 v28, v30
  v_permlane16_swap_b32 v29, v31
  buffer_store_dwordx4 v[28:31], v27, s[48:51], s10 offen sc1
  v_permlane16_swap_b32 v32, v34
  v_permlane16_swap_b32 v33, v35
  buffer_store_dwordx4 v[32:35], v27, s[48:51], s10 offen offset:1024 sc1
  v_mfma_f32_16x16x16_bf16 v[4:7], v[172:173], v[136:137], v[56:59]
  v_mfma_f32_16x16x16_bf16 v[48:51], v[176:177], v[140:141], v[56:59]
  v_mfma_f32_16x16x16_bf16 v[108:111], v[180:181], v[144:145], v[56:59]
  v_mfma_f32_16x16x16_bf16 v[196:199], v[184:185], v[148:149], v[56:59]
  v_mfma_f32_16x16x16_bf16 v[8:11], v[164:165], v[136:137], v[60:63]
  v_mfma_f32_16x16x16_bf16 v[52:55], v[168:169], v[140:141], v[60:63]
  v_mfma_f32_16x16x16_bf16 v[112:115], v[172:173], v[144:145], v[60:63]
  v_mfma_f32_16x16x16_bf16 v[200:203], v[176:177], v[148:149], v[60:63]
  s_nop 4
  v_max_f32 v4, v4, v8
  v_max_f32 v48, v48, v52
  v_max_f32 v108, v108, v112
  v_max_f32 v196, v196, v200
  v_max_f32 v5, v5, v9
  v_max_f32 v49, v49, v53
  v_max_f32 v109, v109, v113
  v_max_f32 v197, v197, v201
  v_max_f32 v6, v6, v10
  v_max_f32 v50, v50, v54
  v_max_f32 v110, v110, v114
  v_max_f32 v198, v198, v202
  v_max_f32 v7, v7, v11
  v_max_f32 v51, v51, v55
  v_max_f32 v111, v111, v115
  v_max_f32 v199, v199, v203
  v_max3_f32 v21, v4, v5, v6
  v_max3_f32 v105, v48, v49, v50
  v_max3_f32 v193, v108, v109, v110
  v_max3_f32 v213, v196, v197, v198
  v_max_f32 v21, v21, v7
  v_max_f32 v105, v105, v51
  v_max_f32 v193, v193, v111
  v_max_f32 v213, v213, v199
  v_mov_b32 v22, v21
  v_mov_b32 v106, v105
  v_mov_b32 v194, v193
  v_mov_b32 v214, v213
  v_permlane16_swap_b32 v21, v22
  v_permlane16_swap_b32 v105, v106
  v_permlane16_swap_b32 v193, v194
  v_permlane16_swap_b32 v213, v214
  v_max_f32 v21, v21, v22
  v_max_f32 v105, v105, v106
  v_max_f32 v193, v193, v194
  v_max_f32 v213, v213, v214
  v_mov_b32 v22, v21
  v_mov_b32 v106, v105
  v_mov_b32 v194, v193
  v_mov_b32 v214, v213
  v_permlane32_swap_b32 v21, v22
  v_permlane32_swap_b32 v105, v106
  v_permlane32_swap_b32 v193, v194
  v_permlane32_swap_b32 v213, v214
  v_max_f32 v21, v21, v22
  v_max_f32 v105, v105, v106
  v_max_f32 v193, v193, v194
  v_max_f32 v213, v213, v214
  v_pk_add_f32 v[4:5], v[4:5], v[20:21] op_sel:[0,1] op_sel_hi:[1,1] neg_lo:[0,1] neg_hi:[0,1]
  v_pk_add_f32 v[48:49], v[48:49], v[104:105] op_sel:[0,1] op_sel_hi:[1,1] neg_lo:[0,1] neg_hi:[0,1]
  v_pk_add_f32 v[108:109], v[108:109], v[192:193] op_sel:[0,1] op_sel_hi:[1,1] neg_lo:[0,1] neg_hi:[0,1]
  v_pk_add_f32 v[196:197], v[196:197], v[212:213] op_sel:[0,1] op_sel_hi:[1,1] neg_lo:[0,1] neg_hi:[0,1]
  v_pk_add_f32 v[6:7], v[6:7], v[20:21] op_sel:[0,1] op_sel_hi:[1,1] neg_lo:[0,1] neg_hi:[0,1]
  v_pk_add_f32 v[50:51], v[50:51], v[104:105] op_sel:[0,1] op_sel_hi:[1,1] neg_lo:[0,1] neg_hi:[0,1]
  v_pk_add_f32 v[110:111], v[110:111], v[192:193] op_sel:[0,1] op_sel_hi:[1,1] neg_lo:[0,1] neg_hi:[0,1]
  v_pk_add_f32 v[198:199], v[198:199], v[212:213] op_sel:[0,1] op_sel_hi:[1,1] neg_lo:[0,1] neg_hi:[0,1]
  v_exp_f32 v4, v4
  v_exp_f32 v48, v48
  v_exp_f32 v108, v108
  v_exp_f32 v196, v196
  v_exp_f32 v5, v5
  v_exp_f32 v49, v49
  v_exp_f32 v109, v109
  v_exp_f32 v197, v197
  v_exp_f32 v6, v6
  v_exp_f32 v50, v50
  v_exp_f32 v110, v110
  v_exp_f32 v198, v198
  v_exp_f32 v7, v7
  v_exp_f32 v51, v51
  v_exp_f32 v111, v111
  v_exp_f32 v199, v199
  v_cvt_pk_bf16_f32 v8, v4, v5
  v_cvt_pk_bf16_f32 v52, v48, v49
  v_cvt_pk_bf16_f32 v112, v108, v109
  v_cvt_pk_bf16_f32 v200, v196, v197
  v_cvt_pk_bf16_f32 v9, v6, v7
  v_cvt_pk_bf16_f32 v53, v50, v51
  v_cvt_pk_bf16_f32 v113, v110, v111
  v_cvt_pk_bf16_f32 v201, v198, v199
  v_and_b32 v12, v8, v72
  v_and_b32 v96, v52, v72
  v_and_b32 v116, v112, v72
  v_and_b32 v204, v200, v72
  v_and_b32 v13, v9, v73
  v_and_b32 v97, v53, v73
  v_and_b32 v117, v113, v73
  v_and_b32 v205, v201, v73
  v_and_b32 v14, v8, v74
  v_and_b32 v98, v52, v74
  v_and_b32 v118, v112, v74
  v_and_b32 v206, v200, v74
  v_and_b32 v15, v9, v75
  v_and_b32 v99, v53, v75
  v_and_b32 v119, v113, v75
  v_and_b32 v207, v201, v75
  v_mfma_f32_16x16x32_bf16 v[20:23], a[220:223], v[12:15], 0
  v_mfma_f32_16x16x32_bf16 v[104:107], a[220:223], v[96:99], 0
  v_mfma_f32_16x16x32_bf16 v[192:195], a[220:223], v[116:119], 0
  v_mfma_f32_16x16x32_bf16 v[212:215], a[220:223], v[204:207], 0
  v_mfma_f32_16x16x32_bf16 v[16:19], v[40:43], v[12:15], 0
  v_mfma_f32_16x16x32_bf16 v[100:103], v[80:83], v[96:99], 0
  v_mfma_f32_16x16x32_bf16 v[188:191], v[42:45], v[116:119], 0
  v_mfma_f32_16x16x32_bf16 v[208:211], v[82:85], v[204:207], 0
  s_nop 0
  v_rcp_f32 v20, v20
  v_rcp_f32 v104, v104
  v_rcp_f32 v192, v192
  v_rcp_f32 v212, v212
  v_pk_mul_f32 v[16:17], v[16:17], v[20:21] op_sel_hi:[1,0]
  v_pk_mul_f32 v[100:101], v[100:101], v[104:105] op_sel_hi:[1,0]
  v_pk_mul_f32 v[188:189], v[188:189], v[192:193] op_sel_hi:[1,0]
  v_pk_mul_f32 v[208:209], v[208:209], v[212:213] op_sel_hi:[1,0]
  v_pk_mul_f32 v[18:19], v[18:19], v[20:21] op_sel_hi:[1,0]
  v_pk_mul_f32 v[102:103], v[102:103], v[104:105] op_sel_hi:[1,0]
  v_pk_mul_f32 v[190:191], v[190:191], v[192:193] op_sel_hi:[1,0]
  v_pk_mul_f32 v[210:211], v[210:211], v[212:213] op_sel_hi:[1,0]
  v_cvt_pk_bf16_f32 v28, v16, v17
  v_cvt_pk_bf16_f32 v30, v100, v101
  v_cvt_pk_bf16_f32 v32, v188, v189
  v_cvt_pk_bf16_f32 v34, v208, v209
  v_cvt_pk_bf16_f32 v29, v18, v19
  v_cvt_pk_bf16_f32 v31, v102, v103
  v_cvt_pk_bf16_f32 v33, v190, v191
  v_cvt_pk_bf16_f32 v35, v210, v211
  v_permlane16_swap_b32 v28, v30
  v_permlane16_swap_b32 v29, v31
  buffer_store_dwordx4 v[28:31], v27, s[48:51], s11 offen sc1
  v_permlane16_swap_b32 v32, v34
  v_permlane16_swap_b32 v33, v35
  buffer_store_dwordx4 v[32:35], v27, s[48:51], s11 offen offset:1024 sc1
  ds_read_b64_tr_b16 a[172:173], v91 offset:51200
  s_mul_i32 s86, s27, 0x3c000
  ds_read_b64_tr_b16 a[174:175], v91 offset:51712
  s_add_u32 s52, s22, s86
  s_addc_u32 s53, s23, 0
  ds_read_b64_tr_b16 a[176:177], v92 offset:51200
  s_mov_b32 s54, 0x3c000
  ds_read_b64_tr_b16 a[178:179], v92 offset:51712
  s_mov_b32 s55, 0x20000
  ds_read_b64_tr_b16 a[180:181], v93 offset:51200
  s_mov_b32 s64, s18
  ds_read_b64_tr_b16 a[182:183], v93 offset:51712
  s_mov_b32 s65, s19
  ds_read_b64_tr_b16 a[184:185], v94 offset:51200
  s_mov_b32 s66, 0x200000
  ds_read_b64_tr_b16 a[186:187], v94 offset:51712
  s_mov_b32 s67, 0x20000
  ds_read_b64_tr_b16 a[188:189], v91 offset:55296
  v_add_u32 v1, 0x19000, v91
  ds_read_b64_tr_b16 a[190:191], v91 offset:55808
  v_add_u32 v2, 0x19000, v92
  ds_read_b64_tr_b16 a[192:193], v92 offset:55296
  v_add_u32 v3, 0x19000, v93
  ds_read_b64_tr_b16 a[194:195], v92 offset:55808
  v_add_u32 v76, 0x19000, v94
  ds_read_b64_tr_b16 a[196:197], v93 offset:55296
  v_and_b32 v81, 15, v0
  ds_read_b64_tr_b16 a[198:199], v93 offset:55808
  v_lshrrev_b32 v82, 5, v0
  ds_read_b64_tr_b16 a[200:201], v94 offset:55296
  v_lshlrev_b32 v82, 11, v82
  ds_read_b64_tr_b16 a[202:203], v94 offset:55808
  v_lshl_add_u32 v82, v81, 4, v82
  ds_read_b64_tr_b16 a[204:205], v91 offset:59392
  v_bfe_u32 v78, v0, 4, 1
  ds_read_b64_tr_b16 a[206:207], v91 offset:59904
  v_lshl_add_u32 v82, v78, 9, v82
  ds_read_b64_tr_b16 a[208:209], v92 offset:59392
  s_and_b32 s86, s26, 1
  ds_read_b64_tr_b16 a[210:211], v92 offset:59904
  s_lshl_b32 s86, s86, 8
  ds_read_b64_tr_b16 a[212:213], v93 offset:59392
  s_mul_i32 s87, s26, 0xf000
  ds_read_b64_tr_b16 a[214:215], v93 offset:59904
  s_add_u32 s86, s86, s87
  ds_read_b64_tr_b16 a[216:217], v94 offset:59392
  v_add_u32 v77, s86, v82
  ds_read_b64_tr_b16 a[218:219], v94 offset:59904
  s_waitcnt lgkmcnt(0)
  s_add_u32 s1, s7, 0x18000
  s_add_u32 m0, s3, 0xc800
  v_xor_b32 v78, 0x100, v77
  buffer_load_dwordx4 v89, s[60:63], s1 offen lds
  s_lshr_b32 s86, s27, 1
  s_lshl_b32 s86, s86, 8
  buffer_load_dwordx4 v90, s[60:63], s1 offen offset:1024 lds
  s_add_u32 s1, s7, 0x1b800
  s_add_u32 s86, s86, 0x872000
  v_lshl_add_u32 v84, v81, 2, s86
  buffer_load_dwordx4 v89, s[60:63], s1 offen offset:2048 lds
  s_and_b32 s86, s26, 1
  s_lshl_b32 s87, s27, 6
  buffer_load_dwordx4 v90, s[60:63], s1 offen offset:3072 lds
  s_add_u32 s1, s7, 0x20000
  s_add_u32 m0, s3, 0xd800
  s_add_u32 s86, s86, s87
  s_lshl_b32 s86, s86, 10
  buffer_load_dwordx4 v89, s[60:63], s1 offen lds
  s_mov_b32 s82, 0x8000
  s_lshl_b32 s87, s28, 7
  buffer_load_dwordx4 v90, s[60:63], s1 offen offset:1024 lds
  s_add_u32 s1, s12, 0x17800
  s_add_u32 s86, s86, s87
  s_and_b32 s87, s26, 2
  buffer_load_dwordx4 v89, s[60:63], s1 offen offset:2048 lds
  s_lshl_b32 s87, s87, 5
  s_add_u32 s86, s86, s87
  buffer_load_dwordx4 v90, s[60:63], s1 offen offset:3072 lds
  s_add_u32 s1, s12, 0x1c000
  s_add_u32 m0, s3, 0xe800
  v_lshlrev_b32 v81, 11, v81
  v_add_u32 v81, s86, v81
  buffer_load_dwordx4 v89, s[60:63], s1 offen lds
  v_lshrrev_b32 v82, 4, v0
  v_lshl_add_u32 v79, v82, 3, v81
  buffer_load_dwordx4 v90, s[60:63], s1 offen offset:1024 lds
  s_add_u32 s1, s12, 0x1f800
  v_add_u32 v79, 0x1000, v79
  v_bfe_u32 v82, v0, 4, 1
  buffer_load_dwordx4 v89, s[60:63], s1 offen offset:2048 lds
  v_lshl_add_u32 v81, v82, 5, v81
  v_lshrrev_b32 v82, 5, v0
  buffer_load_dwordx4 v90, s[60:63], s1 offen offset:3072 lds
  v_lshl_add_u32 v80, v82, 4, v81
  s_cmp_lg_u32 s26, 0
  s_cbranch_scc1 L_A_rq1
  buffer_load_dword v83, v84, s[48:51], 0 offen sc0 sc1
L_A_rq1:
  s_waitcnt vmcnt(12)
  s_barrier
  s_cmp_lg_u32 s26, 0
  s_cbranch_scc1 L_A_pub2
  s_lshl_b32 s86, s24, 8
  s_lshl2_add_u32 s86, s30, s86
  s_add_u32 s86, s86, 0x873000
  v_mov_b32 v88, s86
  v_mov_b32 v95, s29
  s_mov_b64 exec, 1
  buffer_store_dword v95, v88, s[48:51], 0 offen sc0 sc1
  s_mov_b64 exec, -1
L_A_pub2:
  s_cmp_lg_u32 s26, 0
  s_cbranch_scc1 L_A_ck1
  s_waitcnt vmcnt(1)
  v_cmp_ne_u32 vcc, s29, v83
  s_nop 4
  s_cbranch_vccz L_A_ck1_ok
  s_mov_b32 s0, 0
L_A_ck1_spin:
  buffer_load_dword v83, v84, s[48:51], 0 offen sc0 sc1
  s_add_u32 s0, s0, 1
  s_waitcnt vmcnt(0)
  s_waitcnt vmcnt(0)
  v_cmp_ne_u32 vcc, s29, v83
  s_cmp_ge_u32 s0, 0x8000
  s_cbranch_scc1 L_A_ck1_ok
  s_nop 2
  s_cbranch_vccnz L_A_ck1_spin
L_A_ck1_ok:
L_A_ck1:
  s_barrier
  v_add_u32 v84, 0x1000, v84
  s_mov_b32 s81, 0
  buffer_load_dwordx4 a[48:51], v77, s[52:55], s81 offen sc1
  buffer_load_dwordx4 a[52:55], v78, s[52:55], s81 offen sc1
  buffer_load_dwordx4 a[56:59], v77, s[52:55], s81 offen offset:1024 sc1
  buffer_load_dwordx4 a[60:63], v78, s[52:55], s81 offen offset:1024 sc1
  s_mov_b32 s81, 0x1000
  buffer_load_dwordx4 a[64:67], v77, s[52:55], s81 offen sc1
  buffer_load_dwordx4 a[68:71], v78, s[52:55], s81 offen sc1
  buffer_load_dwordx4 a[72:75], v77, s[52:55], s81 offen offset:1024 sc1
  buffer_load_dwordx4 a[76:79], v78, s[52:55], s81 offen offset:1024 sc1
  s_mov_b32 s81, 0x2000
  buffer_load_dwordx4 a[80:83], v77, s[52:55], s81 offen sc1
  buffer_load_dwordx4 a[84:87], v78, s[52:55], s81 offen sc1
  s_waitcnt vmcnt(9)
  v_mfma_f32_16x16x32_bf16 v[4:7], a[124:127], a[48:51], 0
  v_mfma_f32_16x16x32_bf16 v[8:11], a[128:131], a[48:51], 0
  buffer_load_dwordx4 a[88:91], v77, s[52:55], s81 offen offset:1024 sc1
  v_mfma_f32_16x16x32_bf16 v[20:23], a[132:135], a[48:51], 0
  v_mfma_f32_16x16x32_bf16 v[24:27], a[136:139], a[48:51], 0
  s_waitcnt vmcnt(9)
  v_mfma_f32_16x16x32_bf16 v[12:15], a[124:127], a[52:55], 0
  v_mfma_f32_16x16x32_bf16 v[16:19], a[128:131], a[52:55], 0
  buffer_load_dwordx4 a[92:95], v78, s[52:55], s81 offen offset:1024 sc1
  v_mfma_f32_16x16x32_bf16 v[28:31], a[132:135], a[52:55], 0
  v_mfma_f32_16x16x32_bf16 v[32:35], a[136:139], a[52:55], 0
  s_waitcnt vmcnt(9)
  v_mfma_f32_16x16x32_bf16 v[36:39], a[124:127], a[56:59], 0
  v_mfma_f32_16x16x32_bf16 v[40:43], a[128:131], a[56:59], 0
  s_mov_b32 s81, 0x3000
  buffer_load_dwordx4 a[96:99], v77, s[52:55], s81 offen sc1
  v_mfma_f32_16x16x32_bf16 v[52:55], a[132:135], a[56:59], 0
  v_mfma_f32_16x16x32_bf16 v[56:59], a[136:139], a[56:59], 0
  s_waitcnt vmcnt(9)
  v_mfma_f32_16x16x32_bf16 v[44:47], a[124:127], a[60:63], 0
  v_mfma_f32_16x16x32_bf16 v[48:51], a[128:131], a[60:63], 0
  buffer_load_dwordx4 a[100:103], v78, s[52:55], s81 offen sc1
  v_mfma_f32_16x16x32_bf16 v[60:63], a[132:135], a[60:63], 0
  v_mfma_f32_16x16x32_bf16 v[64:67], a[136:139], a[60:63], 0
  s_waitcnt vmcnt(9)
  v_mfma_f32_16x16x32_bf16 v[4:7], a[140:143], a[64:67], v[4:7]
  v_mfma_f32_16x16x32_bf16 v[8:11], a[144:147], a[64:67], v[8:11]
  buffer_load_dwordx4 a[104:107], v77, s[52:55], s81 offen offset:1024 sc1
  v_mfma_f32_16x16x32_bf16 v[20:23], a[148:151], a[64:67], v[20:23]
  v_mfma_f32_16x16x32_bf16 v[24:27], a[152:155], a[64:67], v[24:27]
  s_waitcnt vmcnt(9)
  v_mfma_f32_16x16x32_bf16 v[12:15], a[140:143], a[68:71], v[12:15]
  v_mfma_f32_16x16x32_bf16 v[16:19], a[144:147], a[68:71], v[16:19]
  buffer_load_dwordx4 a[108:111], v78, s[52:55], s81 offen offset:1024 sc1
  v_mfma_f32_16x16x32_bf16 v[28:31], a[148:151], a[68:71], v[28:31]
  v_mfma_f32_16x16x32_bf16 v[32:35], a[152:155], a[68:71], v[32:35]
  s_waitcnt vmcnt(9)
  v_mfma_f32_16x16x32_bf16 v[36:39], a[140:143], a[72:75], v[36:39]
  v_mfma_f32_16x16x32_bf16 v[40:43], a[144:147], a[72:75], v[40:43]
  s_mov_b32 s81, 0x4000
  buffer_load_dwordx4 a[112:115], v77, s[52:55], s81 offen sc1
  v_mfma_f32_16x16x32_bf16 v[52:55], a[148:151], a[72:75], v[52:55]
  v_mfma_f32_16x16x32_bf16 v[56:59], a[152:155], a[72:75], v[56:59]
  s_waitcnt vmcnt(9)
  v_mfma_f32_16x16x32_bf16 v[44:47], a[140:143], a[76:79], v[44:47]
  v_mfma_f32_16x16x32_bf16 v[48:51], a[144:147], a[76:79], v[48:51]
  buffer_load_dwordx4 a[116:119], v78, s[52:55], s81 offen sc1
  v_mfma_f32_16x16x32_bf16 v[60:63], a[148:151], a[76:79], v[60:63]
  v_mfma_f32_16x16x32_bf16 v[64:67], a[152:155], a[76:79], v[64:67]
  s_waitcnt vmcnt(9)
  v_mfma_f32_16x16x32_bf16 v[4:7], a[156:159], a[80:83], v[4:7]
  v_mfma_f32_16x16x32_bf16 v[8:11], a[160:163], a[80:83], v[8:11]
  buffer_load_dwordx4 a[120:123], v77, s[52:55], s81 offen offset:1024 sc1
  v_mfma_f32_16x16x32_bf16 v[20:23], a[164:167], a[80:83], v[20:23]
  v_mfma_f32_16x16x32_bf16 v[24:27], a[168:171], a[80:83], v[24:27]
  s_waitcnt vmcnt(9)
  v_mfma_f32_16x16x32_bf16 v[12:15], a[156:159], a[84:87], v[12:15]
  v_mfma_f32_16x16x32_bf16 v[16:19], a[160:163], a[84:87], v[16:19]
  buffer_load_dwordx4 a[220:223], v78, s[52:55], s81 offen offset:1024 sc1
  v_mfma_f32_16x16x32_bf16 v[28:31], a[164:167], a[84:87], v[28:31]
  v_mfma_f32_16x16x32_bf16 v[32:35], a[168:171], a[84:87], v[32:35]
  s_cmp_lg_u32 s26, 0
  s_cbranch_scc1 L_A_rq2
  buffer_load_dword v83, v84, s[48:51], 0 offen sc0 sc1
L_A_rq2:
  s_waitcnt vmcnt(9)
  v_mfma_f32_16x16x32_bf16 v[36:39], a[156:159], a[88:91], v[36:39]
  v_mfma_f32_16x16x32_bf16 v[40:43], a[160:163], a[88:91], v[40:43]
  s_mov_b32 s81, 0x5000
  buffer_load_dwordx4 a[224:227], v77, s[52:55], s81 offen sc1
  v_mfma_f32_16x16x32_bf16 v[52:55], a[164:167], a[88:91], v[52:55]
  v_mfma_f32_16x16x32_bf16 v[56:59], a[168:171], a[88:91], v[56:59]
  s_waitcnt vmcnt(9)
  v_mfma_f32_16x16x32_bf16 v[44:47], a[156:159], a[92:95], v[44:47]
  v_mfma_f32_16x16x32_bf16 v[48:51], a[160:163], a[92:95], v[48:51]
  s_branch L_skip5A
.p2align 12
L_pad5A:
  s_setpc_b64 s[20:21]
L_skip5A:
  buffer_load_dwordx4 a[228:231], v78, s[52:55], s81 offen sc1
  v_mfma_f32_16x16x32_bf16 v[60:63], a[164:167], a[92:95], v[60:63]
  v_mfma_f32_16x16x32_bf16 v[64:67], a[168:171], a[92:95], v[64:67]
  s_waitcnt vmcnt(9)
  v_mfma_f32_16x16x32_bf16 v[4:7], a[172:175], a[96:99], v[4:7]
  v_mfma_f32_16x16x32_bf16 v[8:11], a[176:179], a[96:99], v[8:11]
  buffer_load_dwordx4 a[232:235], v77, s[52:55], s81 offen offset:1024 sc1
  v_mfma_f32_16x16x32_bf16 v[20:23], a[180:183], a[96:99], v[20:23]
  v_mfma_f32_16x16x32_bf16 v[24:27], a[184:187], a[96:99], v[24:27]
  s_waitcnt vmcnt(9)
  v_mfma_f32_16x16x32_bf16 v[12:15], a[172:175], a[100:103], v[12:15]
  v_mfma_f32_16x16x32_bf16 v[16:19], a[176:179], a[100:103], v[16:19]
  buffer_load_dwordx4 a[236:239], v78, s[52:55], s81 offen offset:1024 sc1
  v_mfma_f32_16x16x32_bf16 v[28:31], a[180:183], a[100:103], v[28:31]
  v_mfma_f32_16x16x32_bf16 v[32:35], a[184:187], a[100:103], v[32:35]
  s_waitcnt vmcnt(9)
  v_mfma_f32_16x16x32_bf16 v[36:39], a[172:175], a[104:107], v[36:39]
  v_mfma_f32_16x16x32_bf16 v[40:43], a[176:179], a[104:107], v[40:43]
  s_mov_b32 s81, 0x6000
  buffer_load_dwordx4 a[48:51], v77, s[52:55], s81 offen sc1
  v_mfma_f32_16x16x32_bf16 v[52:55], a[180:183], a[104:107], v[52:55]
  v_mfma_f32_16x16x32_bf16 v[56:59], a[184:187], a[104:107], v[56:59]
  s_waitcnt vmcnt(9)
  v_mfma_f32_16x16x32_bf16 v[44:47], a[172:175], a[108:111], v[44:47]
  v_mfma_f32_16x16x32_bf16 v[48:51], a[176:179], a[108:111], v[48:51]
  buffer_load_dwordx4 a[52:55], v78, s[52:55], s81 offen sc1
  v_mfma_f32_16x16x32_bf16 v[60:63], a[180:183], a[108:111], v[60:63]
  v_mfma_f32_16x16x32_bf16 v[64:67], a[184:187], a[108:111], v[64:67]
  s_waitcnt vmcnt(9)
  v_mfma_f32_16x16x32_bf16 v[4:7], a[188:191], a[112:115], v[4:7]
  ds_read_b64_tr_b16 a[0:1], v1
  ds_read_b64_tr_b16 a[2:3], v1 offset:512
  v_mfma_f32_16x16x32_bf16 v[8:11], a[192:195], a[112:115], v[8:11]
  buffer_load_dwordx4 a[56:59], v77, s[52:55], s81 offen offset:1024 sc1
  v_mfma_f32_16x16x32_bf16 v[20:23], a[196:199], a[112:115], v[20:23]
  ds_read_b64_tr_b16 a[4:5], v2
  ds_read_b64_tr_b16 a[6:7], v2 offset:512
  v_mfma_f32_16x16x32_bf16 v[24:27], a[200:203], a[112:115], v[24:27]
  ds_read_b64_tr_b16 a[8:9], v3
  ds_read_b64_tr_b16 a[10:11], v3 offset:512
  s_waitcnt vmcnt(9)
  v_mfma_f32_16x16x32_bf16 v[12:15], a[188:191], a[116:119], v[12:15]
  ds_read_b64_tr_b16 a[12:13], v76
  ds_read_b64_tr_b16 a[14:15], v76 offset:512
  v_mfma_f32_16x16x32_bf16 v[16:19], a[192:195], a[116:119], v[16:19]
  buffer_load_dwordx4 a[60:63], v78, s[52:55], s81 offen offset:1024 sc1
  v_mfma_f32_16x16x32_bf16 v[28:31], a[196:199], a[116:119], v[28:31]
  v_mfma_f32_16x16x32_bf16 v[32:35], a[200:203], a[116:119], v[32:35]
  s_waitcnt vmcnt(9)
  v_mfma_f32_16x16x32_bf16 v[36:39], a[188:191], a[120:123], v[36:39]
  v_mfma_f32_16x16x32_bf16 v[40:43], a[192:195], a[120:123], v[40:43]
  s_mov_b32 s81, 0x7000
  buffer_load_dwordx4 a[64:67], v77, s[52:55], s81 offen sc1
  v_mfma_f32_16x16x32_bf16 v[52:55], a[196:199], a[120:123], v[52:55]
  v_mfma_f32_16x16x32_bf16 v[56:59], a[200:203], a[120:123], v[56:59]
  s_waitcnt vmcnt(9)
  v_mfma_f32_16x16x32_bf16 v[44:47], a[188:191], a[220:223], v[44:47]
  v_mfma_f32_16x16x32_bf16 v[48:51], a[192:195], a[220:223], v[48:51]
  buffer_load_dwordx4 a[68:71], v78, s[52:55], s81 offen sc1
  v_mfma_f32_16x16x32_bf16 v[60:63], a[196:199], a[220:223], v[60:63]
  v_mfma_f32_16x16x32_bf16 v[64:67], a[200:203], a[220:223], v[64:67]
  s_waitcnt vmcnt(9)
  v_mfma_f32_16x16x32_bf16 v[4:7], a[204:207], a[224:227], v[4:7]
  ds_read_b64_tr_b16 a[16:17], v1 offset:4096
  ds_read_b64_tr_b16 a[18:19], v1 offset:4608
  v_mfma_f32_16x16x32_bf16 v[8:11], a[208:211], a[224:227], v[8:11]
  buffer_load_dwordx4 a[72:75], v77, s[52:55], s81 offen offset:1024 sc1
  v_mfma_f32_16x16x32_bf16 v[20:23], a[212:215], a[224:227], v[20:23]
  ds_read_b64_tr_b16 a[20:21], v2 offset:4096
  ds_read_b64_tr_b16 a[22:23], v2 offset:4608
  v_mfma_f32_16x16x32_bf16 v[24:27], a[216:219], a[224:227], v[24:27]
  ds_read_b64_tr_b16 a[24:25], v3 offset:4096
  ds_read_b64_tr_b16 a[26:27], v3 offset:4608
  s_waitcnt vmcnt(9)
  v_mfma_f32_16x16x32_bf16 v[12:15], a[204:207], a[228:231], v[12:15]
  ds_read_b64_tr_b16 a[28:29], v76 offset:4096
  ds_read_b64_tr_b16 a[30:31], v76 offset:4608
  v_mfma_f32_16x16x32_bf16 v[16:19], a[208:211], a[228:231], v[16:19]
  buffer_load_dwordx4 a[76:79], v78, s[52:55], s81 offen offset:1024 sc1
  v_mfma_f32_16x16x32_bf16 v[28:31], a[212:215], a[228:231], v[28:31]
  v_mfma_f32_16x16x32_bf16 v[32:35], a[216:219], a[228:231], v[32:35]
  s_cmp_lg_u32 s26, 0
  s_cbranch_scc1 L_A_ck2
  v_cmp_ne_u32 vcc, s29, v83
  s_nop 4
  s_cbranch_vccz L_A_ck2_ok
  s_mov_b32 s0, 0
L_A_ck2_spin:
  buffer_load_dword v83, v84, s[48:51], 0 offen sc0 sc1
  s_add_u32 s0, s0, 1
  s_waitcnt vmcnt(0)
  s_waitcnt vmcnt(0)
  v_cmp_ne_u32 vcc, s29, v83
  s_cmp_ge_u32 s0, 0x8000
  s_cbranch_scc1 L_A_ck2_ok
  s_nop 2
  s_cbranch_vccnz L_A_ck2_spin
L_A_ck2_ok:
L_A_ck2:
  s_barrier
  s_waitcnt vmcnt(9)
  v_mfma_f32_16x16x32_bf16 v[36:39], a[204:207], a[232:235], v[36:39]
  v_mfma_f32_16x16x32_bf16 v[40:43], a[208:211], a[232:235], v[40:43]
  s_mov_b32 s81, 0x8000
  buffer_load_dwordx4 a[80:83], v77, s[52:55], s81 offen sc1
  v_mfma_f32_16x16x32_bf16 v[52:55], a[212:215], a[232:235], v[52:55]
  v_mfma_f32_16x16x32_bf16 v[56:59], a[216:219], a[232:235], v[56:59]
  buffer_load_dwordx2 v[68:69], v79, s[32:35], 0 offen
  s_waitcnt vmcnt(10)
  v_mfma_f32_16x16x32_bf16 v[44:47], a[204:207], a[236:239], v[44:47]
  v_mfma_f32_16x16x32_bf16 v[48:51], a[208:211], a[236:239], v[48:51]
  buffer_load_dwordx4 a[84:87], v78, s[52:55], s81 offen sc1
  v_mfma_f32_16x16x32_bf16 v[60:63], a[212:215], a[236:239], v[60:63]
  v_mfma_f32_16x16x32_bf16 v[64:67], a[216:219], a[236:239], v[64:67]
  s_waitcnt vmcnt(10) lgkmcnt(0)
  v_mfma_f32_16x16x32_bf16 v[4:7], a[0:3], a[48:51], v[4:7]
  ds_read_b64_tr_b16 a[32:33], v1 offset:8192
  ds_read_b64_tr_b16 a[34:35], v1 offset:8704
  v_mfma_f32_16x16x32_bf16 v[8:11], a[4:7], a[48:51], v[8:11]
  buffer_load_dwordx4 a[88:91], v77, s[52:55], s81 offen offset:1024 sc1
  v_mfma_f32_16x16x32_bf16 v[20:23], a[8:11], a[48:51], v[20:23]
  ds_read_b64_tr_b16 a[36:37], v2 offset:8192
  ds_read_b64_tr_b16 a[38:39], v2 offset:8704
  v_mfma_f32_16x16x32_bf16 v[24:27], a[12:15], a[48:51], v[24:27]
  buffer_load_dwordx2 v[70:71], v79, s[32:35], 0 offen offset:32
  s_waitcnt vmcnt(11)
  v_mfma_f32_16x16x32_bf16 v[12:15], a[0:3], a[52:55], v[12:15]
  ds_read_b64_tr_b16 a[40:41], v3 offset:8192
  ds_read_b64_tr_b16 a[42:43], v3 offset:8704
  v_mfma_f32_16x16x32_bf16 v[16:19], a[4:7], a[52:55], v[16:19]
  buffer_load_dwordx4 a[92:95], v78, s[52:55], s81 offen offset:1024 sc1
  v_mfma_f32_16x16x32_bf16 v[28:31], a[8:11], a[52:55], v[28:31]
  ds_read_b64_tr_b16 a[44:45], v76 offset:8192
  ds_read_b64_tr_b16 a[46:47], v76 offset:8704
  v_mfma_f32_16x16x32_bf16 v[32:35], a[12:15], a[52:55], v[32:35]
  ds_read_b64_tr_b16 a[124:125], v91 offset:8192
  ds_read_b64_tr_b16 a[126:127], v91 offset:8704
  s_waitcnt vmcnt(11)
  v_mfma_f32_16x16x32_bf16 v[36:39], a[0:3], a[56:59], v[36:39]
  ds_read_b64_tr_b16 a[128:129], v92 offset:8192
  ds_read_b64_tr_b16 a[130:131], v92 offset:8704
  v_mfma_f32_16x16x32_bf16 v[40:43], a[4:7], a[56:59], v[40:43]
  s_mov_b32 s81, 0x9000
  buffer_load_dwordx4 a[96:99], v77, s[52:55], s81 offen sc1
  v_mfma_f32_16x16x32_bf16 v[52:55], a[8:11], a[56:59], v[52:55]
  ds_read_b64_tr_b16 a[132:133], v93 offset:8192
  ds_read_b64_tr_b16 a[134:135], v93 offset:8704
  v_mfma_f32_16x16x32_bf16 v[56:59], a[12:15], a[56:59], v[56:59]
  buffer_load_dwordx2 v[72:73], v79, s[32:35], s82 offen
  s_waitcnt vmcnt(12)
  v_mfma_f32_16x16x32_bf16 v[44:47], a[0:3], a[60:63], v[44:47]
  ds_read_b64_tr_b16 a[136:137], v94 offset:8192
  ds_read_b64_tr_b16 a[138:139], v94 offset:8704
  v_mfma_f32_16x16x32_bf16 v[48:51], a[4:7], a[60:63], v[48:51]
  buffer_load_dwordx4 a[100:103], v78, s[52:55], s81 offen sc1
  v_mfma_f32_16x16x32_bf16 v[60:63], a[8:11], a[60:63], v[60:63]
  ds_read_b64_tr_b16 a[140:141], v91 offset:51200
  ds_read_b64_tr_b16 a[142:143], v91 offset:51712
  v_mfma_f32_16x16x32_bf16 v[64:67], a[12:15], a[60:63], v[64:67]
  ds_read_b64_tr_b16 a[144:145], v92 offset:51200
  ds_read_b64_tr_b16 a[146:147], v92 offset:51712
  s_waitcnt vmcnt(12)
  v_mfma_f32_16x16x32_bf16 v[4:7], a[16:19], a[64:67], v[4:7]
  ds_read_b64_tr_b16 a[0:1], v91
  ds_read_b64_tr_b16 a[2:3], v91 offset:512
  v_mfma_f32_16x16x32_bf16 v[8:11], a[20:23], a[64:67], v[8:11]
  buffer_load_dwordx4 a[104:107], v77, s[52:55], s81 offen offset:1024 sc1
  v_mfma_f32_16x16x32_bf16 v[20:23], a[24:27], a[64:67], v[20:23]
  ds_read_b64_tr_b16 a[4:5], v92
  ds_read_b64_tr_b16 a[6:7], v92 offset:512
  v_mfma_f32_16x16x32_bf16 v[24:27], a[28:31], a[64:67], v[24:27]
  buffer_load_dwordx2 v[74:75], v79, s[32:35], s82 offen offset:32
  s_waitcnt vmcnt(13)
  v_mfma_f32_16x16x32_bf16 v[12:15], a[16:19], a[68:71], v[12:15]
  ds_read_b64_tr_b16 a[8:9], v93
  ds_read_b64_tr_b16 a[10:11], v93 offset:512
  v_mfma_f32_16x16x32_bf16 v[16:19], a[20:23], a[68:71], v[16:19]
  buffer_load_dwordx4 a[108:111], v78, s[52:55], s81 offen offset:1024 sc1
  v_mfma_f32_16x16x32_bf16 v[28:31], a[24:27], a[68:71], v[28:31]
  ds_read_b64_tr_b16 a[12:13], v94
  ds_read_b64_tr_b16 a[14:15], v94 offset:512
  v_mfma_f32_16x16x32_bf16 v[32:35], a[28:31], a[68:71], v[32:35]
  ds_read_b64_tr_b16 a[148:149], v93 offset:51200
  ds_read_b64_tr_b16 a[150:151], v93 offset:51712
  s_waitcnt vmcnt(13)
  v_mfma_f32_16x16x32_bf16 v[36:39], a[16:19], a[72:75], v[36:39]
  ds_read_b64_tr_b16 a[152:153], v94 offset:51200
  ds_read_b64_tr_b16 a[154:155], v94 offset:51712
  v_mfma_f32_16x16x32_bf16 v[40:43], a[20:23], a[72:75], v[40:43]
  s_mov_b32 s81, 0xa000
  buffer_load_dwordx4 a[112:115], v77, s[52:55], s81 offen sc1
  v_mfma_f32_16x16x32_bf16 v[52:55], a[24:27], a[72:75], v[52:55]
  ds_read_b64_tr_b16 a[156:157], v91 offset:55296
  ds_read_b64_tr_b16 a[158:159], v91 offset:55808
  v_mfma_f32_16x16x32_bf16 v[56:59], a[28:31], a[72:75], v[56:59]
  ds_read_b64_tr_b16 a[160:161], v92 offset:55296
  ds_read_b64_tr_b16 a[162:163], v92 offset:55808
  s_waitcnt vmcnt(13)
  v_mfma_f32_16x16x32_bf16 v[44:47], a[16:19], a[76:79], v[44:47]
  ds_read_b64_tr_b16 a[164:165], v93 offset:55296
  ds_read_b64_tr_b16 a[166:167], v93 offset:55808
  v_mfma_f32_16x16x32_bf16 v[48:51], a[20:23], a[76:79], v[48:51]
  buffer_load_dwordx4 a[116:119], v78, s[52:55], s81 offen sc1
  v_mfma_f32_16x16x32_bf16 v[60:63], a[24:27], a[76:79], v[60:63]
  ds_read_b64_tr_b16 a[168:169], v94 offset:55296
  ds_read_b64_tr_b16 a[170:171], v94 offset:55808
  v_mfma_f32_16x16x32_bf16 v[64:67], a[28:31], a[76:79], v[64:67]
  s_waitcnt vmcnt(13) lgkmcnt(14)
  v_mfma_f32_16x16x32_bf16 v[4:7], a[32:35], a[80:83], v[4:7]
  ds_read_b64_tr_b16 a[16:17], v91 offset:4096
  ds_read_b64_tr_b16 a[18:19], v91 offset:4608
  v_mfma_f32_16x16x32_bf16 v[8:11], a[36:39], a[80:83], v[8:11]
  buffer_load_dwordx4 a[120:123], v77, s[52:55], s81 offen offset:1024 sc1
  v_mfma_f32_16x16x32_bf16 v[20:23], a[40:43], a[80:83], v[20:23]
  ds_read_b64_tr_b16 a[20:21], v92 offset:4096
  ds_read_b64_tr_b16 a[22:23], v92 offset:4608
  v_mfma_f32_16x16x32_bf16 v[24:27], a[44:47], a[80:83], v[24:27]
  ds_read_b64_tr_b16 a[24:25], v93 offset:4096
  ds_read_b64_tr_b16 a[26:27], v93 offset:4608
  s_waitcnt vmcnt(12)
  v_mfma_f32_16x16x32_bf16 v[12:15], a[32:35], a[84:87], v[12:15]
  ds_read_b64_tr_b16 a[28:29], v94 offset:4096
  ds_read_b64_tr_b16 a[30:31], v94 offset:4608
  v_mfma_f32_16x16x32_bf16 v[16:19], a[36:39], a[84:87], v[16:19]
  buffer_load_dwordx4 a[220:223], v78, s[52:55], s81 offen offset:1024 sc1
  v_mfma_f32_16x16x32_bf16 v[28:31], a[40:43], a[84:87], v[28:31]
  ds_read_b64_tr_b16 a[172:173], v91 offset:59392
  ds_read_b64_tr_b16 a[174:175], v91 offset:59904
  v_mfma_f32_16x16x32_bf16 v[32:35], a[44:47], a[84:87], v[32:35]
  ds_read_b64_tr_b16 a[176:177], v92 offset:59392
  ds_read_b64_tr_b16 a[178:179], v92 offset:59904
  s_waitcnt vmcnt(12)
  v_mfma_f32_16x16x32_bf16 v[36:39], a[32:35], a[88:91], v[36:39]
  ds_read_b64_tr_b16 a[180:181], v93 offset:59392
  ds_read_b64_tr_b16 a[182:183], v93 offset:59904
  v_mfma_f32_16x16x32_bf16 v[40:43], a[36:39], a[88:91], v[40:43]
  s_mov_b32 s81, 0xb000
  buffer_load_dwordx4 a[224:227], v77, s[52:55], s81 offen sc1
  v_mfma_f32_16x16x32_bf16 v[52:55], a[40:43], a[88:91], v[52:55]
  v_lshlrev_b32 v81, 4, v0
  v_add_u32 v97, s3, v81
  v_mfma_f32_16x16x32_bf16 v[56:59], a[44:47], a[88:91], v[56:59]
  s_xor_b32 s86, s26, 1
  s_mul_i32 s86, s86, 0x3000
  s_waitcnt vmcnt(11)
  v_mfma_f32_16x16x32_bf16 v[44:47], a[32:35], a[92:95], v[44:47]
  v_add_u32 v88, s86, v81
  s_xor_b32 s86, s26, 2
  v_mfma_f32_16x16x32_bf16 v[48:51], a[36:39], a[92:95], v[48:51]
  buffer_load_dwordx4 a[228:231], v78, s[52:55], s81 offen sc1
  v_mfma_f32_16x16x32_bf16 v[60:63], a[40:43], a[92:95], v[60:63]
  s_mul_i32 s86, s86, 0x3000
  v_add_u32 v95, s86, v81
  v_mfma_f32_16x16x32_bf16 v[64:67], a[44:47], a[92:95], v[64:67]
  s_xor_b32 s86, s26, 3
  s_mul_i32 s86, s86, 0x3000
  s_waitcnt vmcnt(11)
  v_mfma_f32_16x16x32_bf16 v[4:7], a[0:3], a[96:99], v[4:7]
  v_add_u32 v96, s86, v81
  v_lshrrev_b32 v98, 2, v0
  v_mfma_f32_16x16x32_bf16 v[8:11], a[4:7], a[96:99], v[8:11]
  s_mov_b32 s81, 0xc000
  buffer_load_dwordx4 a[232:235], v77, s[52:55], s81 offen sc1
  v_mfma_f32_16x16x32_bf16 v[20:23], a[8:11], a[96:99], v[20:23]
  v_lshlrev_b32 v98, 8, v98
  v_and_b32 v82, 3, v0
  s_waitcnt lgkmcnt(2)
  v_mfma_f32_16x16x32_bf16 v[24:27], a[12:15], a[96:99], v[24:27]
  v_lshl_add_u32 v98, v82, 4, v98
  v_add_u32 v98, 0x873000, v98
  s_waitcnt vmcnt(10)
  v_mfma_f32_16x16x32_bf16 v[12:15], a[0:3], a[100:103], v[12:15]
  ds_read_b64_tr_b16 a[184:185], v94 offset:59392
  ds_read_b64_tr_b16 a[186:187], v94 offset:59904
  v_mfma_f32_16x16x32_bf16 v[16:19], a[4:7], a[100:103], v[16:19]
  buffer_load_dwordx4 a[236:239], v78, s[52:55], s81 offen sc1
  v_mfma_f32_16x16x32_bf16 v[28:31], a[8:11], a[100:103], v[28:31]
  v_mfma_f32_16x16x32_bf16 v[32:35], a[12:15], a[100:103], v[32:35]
  s_waitcnt vmcnt(10)
  v_mfma_f32_16x16x32_bf16 v[36:39], a[0:3], a[104:107], v[36:39]
  v_mfma_f32_16x16x32_bf16 v[40:43], a[4:7], a[104:107], v[40:43]
  s_mov_b32 s81, 0xd000
  buffer_load_dwordx4 a[48:51], v77, s[52:55], s81 offen sc1
  v_mfma_f32_16x16x32_bf16 v[52:55], a[8:11], a[104:107], v[52:55]
  v_mfma_f32_16x16x32_bf16 v[56:59], a[12:15], a[104:107], v[56:59]
  s_waitcnt vmcnt(9)
  v_mfma_f32_16x16x32_bf16 v[44:47], a[0:3], a[108:111], v[44:47]
  v_mfma_f32_16x16x32_bf16 v[48:51], a[4:7], a[108:111], v[48:51]
  buffer_load_dwordx4 a[52:55], v78, s[52:55], s81 offen sc1
  v_mfma_f32_16x16x32_bf16 v[60:63], a[8:11], a[108:111], v[60:63]
  v_mfma_f32_16x16x32_bf16 v[64:67], a[12:15], a[108:111], v[64:67]
  s_waitcnt vmcnt(9)
  v_mfma_f32_16x16x32_bf16 v[4:7], a[16:19], a[112:115], v[4:7]
  v_mfma_f32_16x16x32_bf16 v[8:11], a[20:23], a[112:115], v[8:11]
  s_mov_b32 s81, 0xe000
  buffer_load_dwordx4 a[56:59], v78, s[52:55], s81 offen sc1
  v_mfma_f32_16x16x32_bf16 v[20:23], a[24:27], a[112:115], v[20:23]
  v_lshlrev_b32 v100, 16, v68
  v_and_b32 v101, 0xffff0000, v68
  v_mfma_f32_16x16x32_bf16 v[24:27], a[28:31], a[112:115], v[24:27]
  v_lshlrev_b32 v102, 16, v69
  v_and_b32 v103, 0xffff0000, v69
  s_waitcnt vmcnt(9)
  v_mfma_f32_16x16x32_bf16 v[12:15], a[16:19], a[116:119], v[12:15]
  v_lshlrev_b32 v104, 16, v70
  v_and_b32 v105, 0xffff0000, v70
  v_mfma_f32_16x16x32_bf16 v[16:19], a[20:23], a[116:119], v[16:19]
  buffer_load_dwordx4 a[60:63], v77, s[52:55], s81 offen sc1
  v_mfma_f32_16x16x32_bf16 v[28:31], a[24:27], a[116:119], v[28:31]
  v_lshlrev_b32 v106, 16, v71
  v_and_b32 v107, 0xffff0000, v71
  v_mfma_f32_16x16x32_bf16 v[32:35], a[28:31], a[116:119], v[32:35]
  v_lshlrev_b32 v108, 16, v72
  v_and_b32 v109, 0xffff0000, v72
  s_waitcnt vmcnt(9)
  v_mfma_f32_16x16x32_bf16 v[36:39], a[16:19], a[120:123], v[36:39]
  v_lshlrev_b32 v110, 16, v73
  v_and_b32 v111, 0xffff0000, v73
  v_mfma_f32_16x16x32_bf16 v[40:43], a[20:23], a[120:123], v[40:43]
  s_mov_b32 s81, 0xb000
  buffer_load_dwordx4 a[64:67], v77, s[52:55], s81 offen offset:1024 sc1
  v_mfma_f32_16x16x32_bf16 v[52:55], a[24:27], a[120:123], v[52:55]
  v_lshlrev_b32 v112, 16, v74
  v_and_b32 v113, 0xffff0000, v74
  v_mfma_f32_16x16x32_bf16 v[56:59], a[28:31], a[120:123], v[56:59]
  v_lshlrev_b32 v114, 16, v75
  v_and_b32 v115, 0xffff0000, v75
  s_waitcnt vmcnt(9)
  v_mfma_f32_16x16x32_bf16 v[44:47], a[16:19], a[220:223], v[44:47]
  v_mfma_f32_16x16x32_bf16 v[48:51], a[20:23], a[220:223], v[48:51]
  buffer_load_dwordx4 a[68:71], v78, s[52:55], s81 offen offset:1024 sc1
  v_mfma_f32_16x16x32_bf16 v[60:63], a[24:27], a[220:223], v[60:63]
  v_mfma_f32_16x16x32_bf16 v[64:67], a[28:31], a[220:223], v[64:67]
  s_waitcnt vmcnt(9)
  v_mfma_f32_16x16x32_bf16 v[4:7], a[124:127], a[224:227], v[4:7]
  v_mfma_f32_16x16x32_bf16 v[8:11], a[128:131], a[224:227], v[8:11]
  s_mov_b32 s81, 0xc000
  buffer_load_dwordx4 a[72:75], v77, s[52:55], s81 offen offset:1024 sc1
  v_mfma_f32_16x16x32_bf16 v[20:23], a[132:135], a[224:227], v[20:23]
  v_mfma_f32_16x16x32_bf16 v[24:27], a[136:139], a[224:227], v[24:27]
  s_waitcnt vmcnt(9)
  v_mfma_f32_16x16x32_bf16 v[12:15], a[124:127], a[228:231], v[12:15]
  v_mfma_f32_16x16x32_bf16 v[16:19], a[128:131], a[228:231], v[16:19]
  buffer_load_dwordx4 a[76:79], v78, s[52:55], s81 offen offset:1024 sc1
  v_mfma_f32_16x16x32_bf16 v[28:31], a[132:135], a[228:231], v[28:31]
  v_mfma_f32_16x16x32_bf16 v[32:35], a[136:139], a[228:231], v[32:35]
  s_waitcnt vmcnt(9)
  v_mfma_f32_16x16x32_bf16 v[4:7], a[140:143], a[232:235], v[4:7]
  v_mfma_f32_16x16x32_bf16 v[8:11], a[144:147], a[232:235], v[8:11]
  s_mov_b32 s81, 0xd000
  buffer_load_dwordx4 a[80:83], v77, s[52:55], s81 offen offset:1024 sc1
  v_mfma_f32_16x16x32_bf16 v[20:23], a[148:151], a[232:235], v[20:23]
  v_mfma_f32_16x16x32_bf16 v[24:27], a[152:155], a[232:235], v[24:27]
  s_waitcnt vmcnt(9)
  v_mfma_f32_16x16x32_bf16 v[12:15], a[140:143], a[236:239], v[12:15]
  v_mfma_f32_16x16x32_bf16 v[16:19], a[144:147], a[236:239], v[16:19]
  buffer_load_dwordx4 a[84:87], v78, s[52:55], s81 offen offset:1024 sc1
  v_mfma_f32_16x16x32_bf16 v[28:31], a[148:151], a[236:239], v[28:31]
  v_mfma_f32_16x16x32_bf16 v[32:35], a[152:155], a[236:239], v[32:35]
  s_waitcnt vmcnt(9)
  v_mfma_f32_16x16x32_bf16 v[4:7], a[156:159], a[48:51], v[4:7]
  v_mfma_f32_16x16x32_bf16 v[8:11], a[160:163], a[48:51], v[8:11]
  s_mov_b32 s81, 0xe000
  buffer_load_dwordx4 a[88:91], v78, s[52:55], s81 offen offset:1024 sc1
  v_mfma_f32_16x16x32_bf16 v[20:23], a[164:167], a[48:51], v[20:23]
  v_mfma_f32_16x16x32_bf16 v[24:27], a[168:171], a[48:51], v[24:27]
  s_waitcnt vmcnt(9)
  v_mfma_f32_16x16x32_bf16 v[12:15], a[156:159], a[52:55], v[12:15]
  v_mfma_f32_16x16x32_bf16 v[16:19], a[160:163], a[52:55], v[16:19]
  buffer_load_dwordx4 a[92:95], v77, s[52:55], s81 offen offset:1024 sc1
  v_mfma_f32_16x16x32_bf16 v[28:31], a[164:167], a[52:55], v[28:31]
  v_mfma_f32_16x16x32_bf16 v[32:35], a[168:171], a[52:55], v[32:35]
  s_waitcnt vmcnt(9) lgkmcnt(0)
  v_mfma_f32_16x16x32_bf16 v[28:31], a[180:183], a[56:59], v[28:31]
  v_mfma_f32_16x16x32_bf16 v[32:35], a[184:187], a[56:59], v[32:35]
  v_mfma_f32_16x16x32_bf16 v[12:15], a[172:175], a[56:59], v[12:15]
  v_mfma_f32_16x16x32_bf16 v[16:19], a[176:179], a[56:59], v[16:19]
  s_waitcnt vmcnt(8)
  v_mfma_f32_16x16x32_bf16 v[20:23], a[180:183], a[60:63], v[20:23]
  v_mfma_f32_16x16x32_bf16 v[24:27], a[184:187], a[60:63], v[24:27]
  v_mfma_f32_16x16x32_bf16 v[4:7], a[172:175], a[60:63], v[4:7]
  v_mfma_f32_16x16x32_bf16 v[8:11], a[176:179], a[60:63], v[8:11]
  s_waitcnt vmcnt(7)
  v_mfma_f32_16x16x32_bf16 v[36:39], a[124:127], a[64:67], v[36:39]
  v_mfma_f32_16x16x32_bf16 v[40:43], a[128:131], a[64:67], v[40:43]
  ds_write_b128 v97, v[12:15]
  ds_write_b128 v97, v[16:19] offset:1024
  v_mfma_f32_16x16x32_bf16 v[52:55], a[132:135], a[64:67], v[52:55]
  ds_write_b128 v97, v[28:31] offset:4096
  ds_write_b128 v97, v[32:35] offset:5120
  v_mfma_f32_16x16x32_bf16 v[56:59], a[136:139], a[64:67], v[56:59]
  ds_write_b128 v97, v[20:23] offset:2048
  ds_write_b128 v97, v[24:27] offset:3072
  s_waitcnt vmcnt(6)
  v_mfma_f32_16x16x32_bf16 v[44:47], a[124:127], a[68:71], v[44:47]
  v_add_f32 v4, v4, v100
  v_add_f32 v5, v5, v101
  v_mfma_f32_16x16x32_bf16 v[48:51], a[128:131], a[68:71], v[48:51]
  v_add_f32 v6, v6, v102
  v_add_f32 v7, v7, v103
  v_mfma_f32_16x16x32_bf16 v[60:63], a[132:135], a[68:71], v[60:63]
  v_add_f32 v8, v8, v104
  v_add_f32 v9, v9, v105
  v_mfma_f32_16x16x32_bf16 v[64:67], a[136:139], a[68:71], v[64:67]
  s_waitcnt lgkmcnt(0)
  s_barrier
  v_add_f32 v10, v10, v106
  s_waitcnt vmcnt(5)
  v_mfma_f32_16x16x32_bf16 v[36:39], a[140:143], a[72:75], v[36:39]
  v_add_f32 v11, v11, v107
  ds_read_b128 v[12:15], v88
  v_mfma_f32_16x16x32_bf16 v[40:43], a[144:147], a[72:75], v[40:43]
  ds_read_b128 v[16:19], v88 offset:1024
  ds_read_b128 v[20:23], v95 offset:2048
  v_mfma_f32_16x16x32_bf16 v[52:55], a[148:151], a[72:75], v[52:55]
  ds_read_b128 v[24:27], v95 offset:3072
  ds_read_b128 v[28:31], v96 offset:4096
  ds_read_b128 v[32:35], v96 offset:5120
  v_mfma_f32_16x16x32_bf16 v[56:59], a[152:155], a[72:75], v[56:59]
  s_waitcnt lgkmcnt(5)
  v_add_f32 v4, v4, v12
  v_add_f32 v5, v5, v13
  s_waitcnt vmcnt(4)
  v_mfma_f32_16x16x32_bf16 v[44:47], a[140:143], a[76:79], v[44:47]
  v_add_f32 v6, v6, v14
  v_add_f32 v7, v7, v15
  v_mfma_f32_16x16x32_bf16 v[48:51], a[144:147], a[76:79], v[48:51]
  s_waitcnt lgkmcnt(4)
  v_add_f32 v8, v8, v16
  v_add_f32 v9, v9, v17
  v_mfma_f32_16x16x32_bf16 v[60:63], a[148:151], a[76:79], v[60:63]
  v_add_f32 v10, v10, v18
  v_add_f32 v11, v11, v19
  v_mfma_f32_16x16x32_bf16 v[64:67], a[152:155], a[76:79], v[64:67]
  s_waitcnt lgkmcnt(3)
  v_add_f32 v4, v4, v20
  v_add_f32 v5, v5, v21
  s_waitcnt vmcnt(3)
  v_mfma_f32_16x16x32_bf16 v[36:39], a[156:159], a[80:83], v[36:39]
  v_add_f32 v6, v6, v22
  v_add_f32 v7, v7, v23
  v_mfma_f32_16x16x32_bf16 v[40:43], a[160:163], a[80:83], v[40:43]
  s_waitcnt lgkmcnt(2)
  v_add_f32 v8, v8, v24
  v_add_f32 v9, v9, v25
  v_mfma_f32_16x16x32_bf16 v[52:55], a[164:167], a[80:83], v[52:55]
  v_add_f32 v10, v10, v26
  v_add_f32 v11, v11, v27
  v_mfma_f32_16x16x32_bf16 v[56:59], a[168:171], a[80:83], v[56:59]
  s_waitcnt lgkmcnt(1)
  v_add_f32 v4, v4, v28
  v_add_f32 v5, v5, v29
  s_waitcnt vmcnt(2)
  v_mfma_f32_16x16x32_bf16 v[44:47], a[156:159], a[84:87], v[44:47]
  v_add_f32 v6, v6, v30
  v_add_f32 v7, v7, v31
  v_mfma_f32_16x16x32_bf16 v[48:51], a[160:163], a[84:87], v[48:51]
  s_waitcnt lgkmcnt(0)
  v_add_f32 v8, v8, v32
  v_add_f32 v9, v9, v33
  v_mfma_f32_16x16x32_bf16 v[60:63], a[164:167], a[84:87], v[60:63]
  v_add_f32 v10, v10, v34
  v_add_f32 v11, v11, v35
  v_mfma_f32_16x16x32_bf16 v[64:67], a[168:171], a[84:87], v[64:67]
  v_cvt_pk_bf16_f32 v68, v4, v5
  v_cvt_pk_bf16_f32 v69, v6, v7
  s_waitcnt vmcnt(1)
  v_mfma_f32_16x16x32_bf16 v[60:63], a[180:183], a[88:91], v[60:63]
  v_cvt_pk_bf16_f32 v70, v8, v9
  v_cvt_pk_bf16_f32 v71, v10, v11
  v_mfma_f32_16x16x32_bf16 v[64:67], a[184:187], a[88:91], v[64:67]
  v_permlane16_swap_b32 v68, v70
  v_permlane16_swap_b32 v69, v71
  v_mfma_f32_16x16x32_bf16 v[44:47], a[172:175], a[88:91], v[44:47]
  buffer_store_dwordx4 v[68:71], v80, s[64:67], 0 offen sc1
  v_mfma_f32_16x16x32_bf16 v[48:51], a[176:179], a[88:91], v[48:51]
  s_waitcnt vmcnt(1)
  v_mfma_f32_16x16x32_bf16 v[52:55], a[180:183], a[92:95], v[52:55]
  v_mfma_f32_16x16x32_bf16 v[56:59], a[184:187], a[92:95], v[56:59]
  v_mfma_f32_16x16x32_bf16 v[36:39], a[172:175], a[92:95], v[36:39]
  v_mfma_f32_16x16x32_bf16 v[40:43], a[176:179], a[92:95], v[40:43]
  s_or_b32 s87, s2, s26
  s_cmp_lg_u32 s87, 0
  s_cbranch_scc1 L_A_ep0
  buffer_load_dwordx4 v[116:119], v98, s[48:51], 0 offen sc0 sc1
L_A_ep0:
  ds_write_b128 v97, v[44:47] offset:6144
  ds_write_b128 v97, v[48:51] offset:7168
  ds_write_b128 v97, v[60:63] offset:10240
  ds_write_b128 v97, v[64:67] offset:11264
  ds_write_b128 v97, v[52:55] offset:8192
  ds_write_b128 v97, v[56:59] offset:9216
  v_pk_add_f32 v[36:37], v[36:37], v[108:109]
  v_pk_add_f32 v[38:39], v[38:39], v[110:111]
  v_pk_add_f32 v[40:41], v[40:41], v[112:113]
  v_pk_add_f32 v[42:43], v[42:43], v[114:115]
  s_waitcnt lgkmcnt(0)
  s_barrier
  ds_read_b128 v[44:47], v88 offset:6144
  ds_read_b128 v[48:51], v88 offset:7168
  ds_read_b128 v[52:55], v95 offset:8192
  ds_read_b128 v[56:59], v95 offset:9216
  ds_read_b128 v[60:63], v96 offset:10240
  ds_read_b128 v[64:67], v96 offset:11264
  s_waitcnt lgkmcnt(5)
  v_pk_add_f32 v[36:37], v[36:37], v[44:45]
  v_pk_add_f32 v[38:39], v[38:39], v[46:47]
  s_waitcnt lgkmcnt(4)
  v_pk_add_f32 v[40:41], v[40:41], v[48:49]
  v_pk_add_f32 v[42:43], v[42:43], v[50:51]
  s_waitcnt lgkmcnt(3)
  v_pk_add_f32 v[36:37], v[36:37], v[52:53]
  v_pk_add_f32 v[38:39], v[38:39], v[54:55]
  s_waitcnt lgkmcnt(2)
  v_pk_add_f32 v[40:41], v[40:41], v[56:57]
  v_pk_add_f32 v[42:43], v[42:43], v[58:59]
  s_waitcnt lgkmcnt(1)
  v_pk_add_f32 v[36:37], v[36:37], v[60:61]
  v_pk_add_f32 v[38:39], v[38:39], v[62:63]
  s_waitcnt lgkmcnt(0)
  v_pk_add_f32 v[40:41], v[40:41], v[64:65]
  v_pk_add_f32 v[42:43], v[42:43], v[66:67]
  v_cvt_pk_bf16_f32 v72, v36, v37
  v_cvt_pk_bf16_f32 v73, v38, v39
  v_cvt_pk_bf16_f32 v74, v40, v41
  v_cvt_pk_bf16_f32 v75, v42, v43
  s_nop 0
  v_permlane16_swap_b32 v72, v74
  v_permlane16_swap_b32 v73, v75
  buffer_store_dwordx4 v[72:75], v80, s[64:67], s82 offen sc1
  s_cmp_lg_u32 s87, 0
  s_cbranch_scc1 L_A_ep
  s_mov_b32 s0, 0
  s_waitcnt vmcnt(1)
  s_branch L_A_ep_chk
L_A_ep_spin:
  buffer_load_dwordx4 v[116:119], v98, s[48:51], 0 offen sc0 sc1
  s_add_u32 s0, s0, 1
  s_waitcnt vmcnt(0)
L_A_ep_chk:
  v_xor_b32 v116, s29, v116
  v_xor_b32 v117, s29, v117
  v_xor_b32 v118, s29, v118
  v_xor_b32 v119, s29, v119
  v_or_b32 v116, v116, v117
  v_or3_b32 v116, v116, v118, v119
  v_cmp_ne_u32 vcc, 0, v116
  s_cmp_ge_u32 s0, 0x8000
  s_cbranch_scc1 L_A_ep_go
  s_nop 2
  s_cbranch_vccnz L_A_ep_spin
L_A_ep_go:
  v_mov_b32 v81, 0x874000
  v_mov_b32 v82, s29
  s_mov_b64 exec, 1
  buffer_store_dword v82, v81, s[48:51], 0 offen sc0 sc1
  s_mov_b64 exec, -1
L_A_ep:
  s_branch L_end
.p2align 12
L_pathB:
  v_and_b32 v5, 7, v0
  v_lshrrev_b32 v6, 4, v0
  v_xor_b32 v5, v5, v6
  v_lshlrev_b32 v5, 4, v5
  v_lshrrev_b32 v6, 3, v0
  v_lshlrev_b32 v6, 11, v6
  s_lshl_b32 s86, s24, 17
  s_lshl_b32 s87, s26, 15
  s_add_u32 s86, s86, s87
  s_add_u32 s86, s86, 0x1000
  v_add_u32 v6, s86, v6
  v_add_u32 v1, v6, v5
  v_xor_b32 v5, 64, v5
  v_add_u32 v5, v6, v5
  v_add_u32 v2, 0x3c00, v5
  v_add_u32 v3, 0xfffffc00, v1
  v_add_u32 v4, 0x3800, v5
  v_lshrrev_b32 v6, 5, v0
  s_lshl_b32 s86, s24, 7
  s_lshl3_add_u32 s86, s30, s86
  s_lshl1_add_u32 s86, s26, s86
  v_add_u32 v6, s86, v6
  v_and_b32 v5, 31, v0
  v_lshlrev_b32 v5, 5, v5
  v_lshl_add_u32 v5, v6, 10, v5
  v_add_u32 v5, 0x1000, v5
  s_mul_i32 s86, s25, 9
  s_add_u32 s86, s86, 16
  s_min_u32 s91, s86, 0x4d
  s_and_b32 s87, s26, 1
  s_lshl_b32 s88, s91, 5
  v_lshlrev_b32 v25, 4, v0
  v_add_u32 v25, s88, v25
  v_mul_u32_u24 v24, 0xe39, v0
  s_movk_i32 s88, 0x9a0
  s_mul_i32 s89, s87, 0x200040
  v_add_u32 v26, s89, v24
  v_add_u32 v26, 0xe3900, v26
  v_lshrrev_b32 v26, 16, v26
  s_mul_i32 s89, s87, 0x2400
  s_add_u32 s89, s89, 0x1000
  v_add_u32 v27, s89, v25
  v_mad_u32_u24 v19, v26, s88, v27
  s_mul_i32 s90, s87, 0x11c740
  v_add_u32 v24, s90, v24
  s_mul_i32 s90, s87, 0x1400
  v_add_u32 v25, s90, v25
  v_add_u32 v26, 0, v24
  v_lshrrev_b32 v26, 16, v26
  v_mad_u32_u24 v7, v26, s88, v25
  v_add_u32 v26, 0x38e40, v24
  v_lshrrev_b32 v26, 16, v26
  v_mad_u32_u24 v16, v26, s88, v25
  v_add_u32 v26, 0x71c80, v24
  v_lshrrev_b32 v26, 16, v26
  v_mad_u32_u24 v17, v26, s88, v25
  v_add_u32 v26, 0xaaac0, v24
  v_lshrrev_b32 v26, 16, v26
  v_mad_u32_u24 v18, v26, s88, v25
  v_add_u32 v25, 0x2400, v25
  v_add_u32 v26, 0x200040, v24
  v_lshrrev_b32 v26, 16, v26
  v_mad_u32_u24 v20, v26, s88, v25
  v_add_u32 v26, 0x238e80, v24
  v_lshrrev_b32 v26, 16, v26
  v_mad_u32_u24 v21, v26, s88, v25
  v_add_u32 v26, 0x271cc0, v24
  v_lshrrev_b32 v26, 16, v26
  v_mad_u32_u24 v22, v26, s88, v25
  v_add_u32 v26, 0x2aab00, v24
  v_lshrrev_b32 v26, 16, v26
  v_mad_u32_u24 v23, v26, s88, v25
  s_lshl_b32 s83, s26, 12
  s_lshr_b32 s86, s26, 1
  s_mul_i32 s86, s86, 0x4810
  s_add_u32 s86, s86, 0x4000
  s_add_u32 s84, s86, s90
  s_add_u32 s85, s86, s89
  s_lshl_b32 s80, s31, 7
  s_mul_i32 s81, s31, 0x2b000
  s_waitcnt lgkmcnt(0)
  s_sub_u32 s32, s4, 0x1000
  s_subb_u32 s33, s5, 0
  s_mov_b32 s34, 0x201000
  s_mov_b32 s35, 0x20000
  s_cmp_ge_u32 s26, 2
  s_cselect_b32 s36, s14, s12
  s_cselect_b32 s37, s15, s13
  s_mov_b32 s38, 0x158000
  s_mov_b32 s39, 0x20000
  buffer_load_dwordx4 v[8:11], v5, s[32:35], 0 offen
  buffer_load_dwordx4 v[12:15], v5, s[32:35], 0 offen offset:16
  s_add_u32 m0, s83, 0
  s_mov_b32 s48, s22
  buffer_load_dwordx4 v1, s[32:35], s80 offen lds
  s_mov_b32 s49, s23
  s_mov_b32 s50, 0x890000
  s_mov_b32 s51, 0x20000
  v_mov_b32 v29, 0x874000
  buffer_load_dword v28, v29, s[48:51], 0 offen sc1
  s_getpc_b64 s[86:87]
L_pcB:
  s_sub_u32 s86, s86, L_pcB-parallel_sum__sliding_local_dilated__geglu_ffn__prompt_kernel
  s_subb_u32 s87, s87, 0
  s_lshr_b32 s88, s2, 3
  s_lshl2_add_u32 s88, s88, s26
  s_lshl_b32 s88, s88, 9
  v_and_b32 v30, 3, v0
  v_lshl_add_u32 v30, v30, 7, s88
  v_min_u32 v30, L_end-parallel_sum__sliding_local_dilated__geglu_ffn__prompt_kernel, v30
  v_mov_b32 v31, s87
  buffer_load_dwordx4 v2, s[32:35], s80 offen offset:1024 lds
  v_add_co_u32 v30, vcc, s86, v30
  s_nop 1
  v_addc_co_u32 v31, vcc, 0, v31, vcc
  global_load_dword v29, v[30:31], off
  v_and_b32 v26, 15, v0
  v_lshrrev_b32 v27, 1, v26
  v_lshrrev_b32 v24, 5, v0
  v_xor_b32 v27, v27, v24
  v_lshlrev_b32 v27, 4, v27
  v_lshl_add_u32 v26, v26, 7, v27
  v_bfe_u32 v27, v0, 4, 1
  v_lshl_add_u32 v26, v27, 3, v26
  s_and_b32 s86, s26, 1
  s_lshl_b32 s86, s86, 13
  buffer_load_dwordx4 v3, s[32:35], s80 offen offset:2048 lds
  v_add_u32 v30, s86, v26
  v_add_u32 v34, 0xd080, v30
  v_add_u32 v38, 0x1a100, v30
  v_xor_b32 v31, 32, v30
  v_add_u32 v35, 0xd080, v31
  v_add_u32 v39, 0x1a100, v31
  v_xor_b32 v32, 64, v30
  v_add_u32 v36, 0xd080, v32
  v_add_u32 v40, 0x1a100, v32
  v_xor_b32 v33, 0x60, v30
  buffer_load_dwordx4 v4, s[32:35], s80 offen offset:3072 lds
  s_add_u32 m0, s84, 0
  v_add_u32 v37, 0xd080, v33
  v_add_u32 v41, 0x1a100, v33
  v_lshrrev_b32 v26, 2, v0
  v_mul_u32_u24 v26, 0x120, v26
  v_add_u32 v26, 0x4000, v26
  v_and_b32 v27, 3, v0
  v_lshl_add_u32 v24, v27, 3, v26
  s_lshr_b32 s87, s26, 1
  s_lshl_b32 s86, s87, 5
  v_add_u32 v42, s86, v24
  buffer_load_dwordx4 v7, s[36:39], s81 offen lds
  v_and_b32 v27, 1, v0
  v_lshl_add_u32 v26, v27, 3, v26
  v_bfe_u32 v27, v0, 1, 1
  v_mul_u32_u24 v27, 0x4810, v27
  v_add_u32 v26, v26, v27
  s_lshl_b32 s86, s87, 4
  s_add_u32 s86, s86, 0xc0
  v_add_u32 v45, s86, v26
  v_add_u32 v43, 0xd080, v42
  v_add_u32 v46, 0xd080, v45
  buffer_load_dwordx4 v16, s[36:39], s81 offen offset:1024 lds
  v_add_u32 v44, 0x1a100, v42
  v_add_u32 v47, 0x1a100, v45
  s_cmp_lg_u32 s26, 0
  s_cbranch_scc1 L_nt1B
  s_call_b64 s[20:21], L_pad1B
L_nt1B:
  s_cmp_lg_u32 s26, 1
  s_cbranch_scc1 L_nt2B
  s_call_b64 s[20:21], L_pad2B
L_nt2B:
  buffer_load_dwordx4 v17, s[36:39], s81 offen offset:2048 lds
  s_cmp_lg_u32 s26, 2
  s_cbranch_scc1 L_nt3B
  s_call_b64 s[20:21], L_pad3B
L_nt3B:
  s_cmp_lg_u32 s26, 3
  s_cbranch_scc1 L_nt4B
  s_call_b64 s[20:21], L_pad4B
L_nt4B:
  v_bfe_u32 v26, v0, 2, 2
  v_mov_b32 v24, 0x3f803f80
  buffer_load_dwordx4 v18, s[36:39], s81 offen offset:3072 lds
  s_add_u32 m0, s85, 0
  v_cmp_eq_u32 vcc, 0, v26
  s_nop 1
  v_cndmask_b32 v25, 0, v24, vcc
  v_accvgpr_write_b32 a108, v25
  v_accvgpr_write_b32 a109, v25
  v_accvgpr_write_b32 a110, v25
  v_accvgpr_write_b32 a111, v25
  v_cmp_eq_u32 vcc, 1, v26
  s_nop 1
  v_cndmask_b32 v25, 0, v24, vcc
  v_accvgpr_write_b32 a112, v25
  v_accvgpr_write_b32 a113, v25
  buffer_load_dwordx4 v19, s[36:39], s81 offen lds
  s_add_u32 m0, s84, 0x2400
  v_accvgpr_write_b32 a114, v25
  v_accvgpr_write_b32 a115, v25
  v_cmp_eq_u32 vcc, 2, v26
  s_nop 1
  v_cndmask_b32 v25, 0, v24, vcc
  v_accvgpr_write_b32 a116, v25
  v_accvgpr_write_b32 a117, v25
  v_accvgpr_write_b32 a118, v25
  v_accvgpr_write_b32 a119, v25
  v_cmp_eq_u32 vcc, 3, v26
  s_nop 1
  v_cndmask_b32 v25, 0, v24, vcc
  buffer_load_dwordx4 v20, s[36:39], s81 offen lds
  v_accvgpr_write_b32 a120, v25
  v_accvgpr_write_b32 a121, v25
  v_accvgpr_write_b32 a122, v25
  v_accvgpr_write_b32 a123, v25
  s_and_b32 s88, s26, 1
  s_mul_i32 s86, s88, 0x4810
  v_add_u32 v48, s86, v43
  s_add_u32 s86, s24, 1
  s_and_b32 s86, s86, 7
  s_mul_i32 s86, s86, 0xac0
  buffer_load_dwordx4 v21, s[36:39], s81 offen offset:1024 lds
  s_lshl_b32 s89, s91, 5
  s_add_u32 s86, s86, s89
  s_add_u32 s86, s86, 0x810000
  s_lshl_b32 s89, s88, 17
  s_add_u32 s89, s89, s86
  s_lshl_b32 s90, s87, 5
  s_add_u32 s89, s89, s90
  v_and_b32 v26, 15, v0
  v_lshlrev_b32 v26, 1, v26
  v_lshrrev_b32 v27, 4, v0
  buffer_load_dwordx4 v22, s[36:39], s81 offen offset:2048 lds
  v_lshl_add_u32 v26, v27, 6, v26
  v_cmp_eq_u32 vcc, 3, v27
  v_add_u32 v27, 32, v26
  s_nop 0
  v_cndmask_b32 v26, v26, v27, vcc
  v_add_u32 v49, s89, v26
  v_and_b32 v26, 7, v0
  v_lshlrev_b32 v26, 1, v26
  v_bfe_u32 v27, v0, 3, 1
  v_lshl_add_u32 v26, v27, 17, v26
  s_lshl_b32 s90, s87, 4
  buffer_load_dwordx4 v23, s[36:39], s81 offen offset:3072 lds
  s_add_u32 s31, s31, 1
  s_and_b32 s31, s31, 7
  s_lshl_b32 s80, s31, 7
  s_mul_i32 s81, s31, 0x2b000
  s_add_u32 m0, s83, 0xd080
  s_add_u32 s86, s86, s90
  s_add_u32 s86, s86, 0xc0
  v_add_u32 v26, s86, v26
  s_cmp_eq_u32 s88, 0
  s_cselect_b32 s86, 16, 0
  v_cmp_gt_u32 vcc, s86, v0
  v_mov_b32 v27, 0x7ffffff0
  s_nop 0
  v_cndmask_b32 v50, v27, v26, vcc
  v_lshrrev_b32 v56, 2, v0
  v_lshlrev_b32 v56, 8, v56
  buffer_load_dwordx4 v1, s[32:35], s80 offen lds
  v_and_b32 v27, 3, v0
  v_lshl_add_u32 v56, v27, 4, v56
  v_add_u32 v56, 0x870000, v56
  v_and_b32 v26, 15, v0
  s_lshl_b32 s86, s24, 10
  s_lshl_b32 s87, s88, 9
  s_add_u32 s86, s86, s87
  s_add_u32 s86, s86, 0x800000
  v_lshl_add_u32 v51, v26, 4, s86
  s_lshr_b32 s86, s26, 1
  buffer_load_dwordx4 v2, s[32:35], s80 offen offset:1024 lds
  s_lshl_b32 s86, s86, 17
  s_add_u32 s86, s86, 0x810000
  s_add_u32 s68, s22, s86
  s_addc_u32 s69, s23, 0
  s_mov_b32 s70, 0xac00
  s_mov_b32 s71, 0x20000
  s_mov_b32 s56, s8
  s_mov_b32 s57, s9
  s_mov_b32 s58, 0x80000
  s_mov_b32 s59, 0x20000
  buffer_load_dwordx4 v3, s[32:35], s80 offen offset:2048 lds
  s_mov_b32 s60, s16
  s_mov_b32 s61, s17
  s_mov_b32 s62, 0x158000
  s_mov_b32 s63, 0x20000
  s_lshl_b32 s6, s26, 16
  s_cmp_lg_u32 s26, 0
  s_cbranch_scc1 L_nt5B
  s_call_b64 s[20:21], L_pad5B
L_nt5B:
  s_lshl_b32 s13, s26, 17
  buffer_load_dwordx4 v4, s[32:35], s80 offen offset:3072 lds
  s_add_u32 m0, s84, 0xd080
  s_mul_i32 s86, s26, 18
  s_add_u32 s86, s86, 16
  s_lshl_b32 s7, s86, 14
  s_add_u32 s86, s86, 9
  s_min_u32 s86, s86, 0x4d
  s_lshl_b32 s12, s86, 14
  s_mul_i32 s3, s26, 0x3000
  v_bfe_u32 v63, v0, 4, 1
  v_lshlrev_b32 v63, 1, v63
  v_xor_b32 v63, v63, v0
  buffer_load_dwordx4 v7, s[36:39], s81 offen lds
  v_and_b32 v63, 7, v63
  v_lshlrev_b32 v63, 4, v63
  v_lshrrev_b32 v64, 3, v0
  v_lshl_add_u32 v63, v64, 10, v63
  s_lshl_b32 s86, s28, 7
  v_add_u32 v24, s86, v63
  v_xor_b32 v25, 64, v24
  v_add_u32 v25, 0x1c00, v25
  v_lshrrev_b32 v63, 5, v0
  v_lshlrev_b32 v63, 4, v63
  buffer_load_dwordx4 v16, s[36:39], s81 offen offset:1024 lds
  v_bfe_u32 v64, v0, 4, 1
  v_lshl_add_u32 v63, v64, 3, v63
  v_bfe_u32 v58, v0, 2, 2
  v_add_u32 v63, v63, v58
  v_lshlrev_b32 v63, 7, v63
  v_and_b32 v58, 3, v0
  v_lshl_add_u32 v63, v58, 3, v63
  v_add_u32 v63, s3, v63
  v_lshlrev_b32 v64, 1, v64
  v_bfe_u32 v58, v0, 3, 1
  buffer_load_dwordx4 v17, s[36:39], s81 offen offset:2048 lds
  v_or_b32 v64, v64, v58
  s_and_b32 s86, s26, 2
  v_xor_b32 v64, s86, v64
  v_lshl_add_u32 v57, v64, 5, v63
  v_xor_b32 v58, 32, v57
  v_xor_b32 v59, 64, v57
  v_xor_b32 v60, 0x60, v57
  s_lshr_b32 s86, s2, 3
  s_lshl_b32 s86, s86, 9
  v_and_b32 v63, 3, v0
  buffer_load_dwordx4 v18, s[36:39], s81 offen offset:3072 lds
  s_add_u32 m0, s85, 0xd080
  v_lshl_add_u32 v63, v63, 7, s86
  v_lshrrev_b32 v64, 2, v0
  v_lshl_add_u32 v61, v64, 14, v63
  v_lshlrev_b32 v65, 7, v0
  s_lshl2_add_u32 s86, s2, s26
  s_lshl_b32 s14, s86, 9
  s_mul_i32 s15, s86, 0x580
  v_mov_b32 v66, 0x3f803f80
  v_mov_b32 v63, 0
  v_mov_b32 v64, 0
  buffer_load_dwordx4 v19, s[36:39], s81 offen lds
  s_add_u32 m0, s84, 0xf480
  s_waitcnt vmcnt(25)
  v_dot2_f32_bf16 v63, v8, v66, v63
  v_dot2_f32_bf16 v64, v8, v8, v64
  v_dot2_f32_bf16 v63, v9, v66, v63
  v_dot2_f32_bf16 v64, v9, v9, v64
  v_dot2_f32_bf16 v63, v10, v66, v63
  v_dot2_f32_bf16 v64, v10, v10, v64
  v_dot2_f32_bf16 v63, v11, v66, v63
  v_dot2_f32_bf16 v64, v11, v11, v64
  s_waitcnt vmcnt(24)
  v_dot2_f32_bf16 v63, v12, v66, v63
  v_dot2_f32_bf16 v64, v12, v12, v64
  buffer_load_dwordx4 v20, s[36:39], s81 offen lds
  v_dot2_f32_bf16 v63, v13, v66, v63
  v_dot2_f32_bf16 v64, v13, v13, v64
  v_dot2_f32_bf16 v63, v14, v66, v63
  v_dot2_f32_bf16 v64, v14, v14, v64
  v_dot2_f32_bf16 v63, v15, v66, v63
  v_dot2_f32_bf16 v64, v15, v15, v64
  s_nop 1
  v_add_f32_dpp v63, v63, v63 row_ror:8 row_mask:0xf bank_mask:0xf
  v_add_f32_dpp v64, v64, v64 row_ror:8 row_mask:0xf bank_mask:0xf
  s_nop 0
  v_add_f32_dpp v63, v63, v63 row_ror:4 row_mask:0xf bank_mask:0xf
  v_add_f32_dpp v64, v64, v64 row_ror:4 row_mask:0xf bank_mask:0xf
  buffer_load_dwordx4 v21, s[36:39], s81 offen offset:1024 lds
  v_add_f32_dpp v63, v63, v63 row_ror:2 row_mask:0xf bank_mask:0xf
  v_add_f32_dpp v64, v64, v64 row_ror:2 row_mask:0xf bank_mask:0xf
  s_nop 0
  v_add_f32_dpp v63, v63, v63 row_ror:1 row_mask:0xf bank_mask:0xf
  v_add_f32_dpp v64, v64, v64 row_ror:1 row_mask:0xf bank_mask:0xf
  v_mov_b32 v67, v63
  v_mov_b32 v66, v64
  s_nop 0
  v_permlane16_swap_b32 v63, v67
  v_permlane16_swap_b32 v64, v66
  v_add_f32 v63, v63, v67
  v_add_f32 v64, v64, v66
  buffer_load_dwordx4 v22, s[36:39], s81 offen offset:2048 lds
  v_mul_f32 v63, 0x3b000000, v63
  v_mul_f32 v64, 0x3b000000, v64
  v_fma_f32 v64, -v63, v63, v64
  v_max_f32 v64, 0, v64
  v_add_f32 v69, 0x3727c5ac, v64
  v_cvt_pk_bf16_f32 v68, -v63, -v63
  v_lshlrev_b32 v6, 3, v6
  v_add_u32 v6, 0x800000, v6
  v_and_b32 v67, 31, v0
  v_cmp_eq_u32 vcc, 0, v67
  buffer_load_dwordx4 v23, s[36:39], s81 offen offset:3072 lds
  v_mov_b32 v67, 0x7ffffff0
  v_cndmask_b32 v6, v67, v6, vcc
  buffer_store_dwordx2 v[68:69], v6, s[48:51], 0 offen sc1
  s_waitcnt vmcnt(27)
  v_readfirstlane_b32 s29, v28
  s_nop 0
  s_mul_i32 s29, s29, 0x9e3779b1
  s_add_u32 s29, s29, 0x7f4a7c15
  s_waitcnt vmcnt(14)
  s_barrier
  ds_read_b64_tr_b16 a[0:1], v42
  ds_read_b64_tr_b16 a[2:3], v42 offset:4608
  ds_read_b64 a[36:37], v30
  ds_read_b64 a[38:39], v31
  ds_read_b64 a[40:41], v30 offset:2048
  ds_read_b64 a[42:43], v31 offset:2048
  ds_read_b64 a[44:45], v30 offset:4096
  ds_read_b64 a[46:47], v31 offset:4096
  ds_read_b64 a[48:49], v30 offset:6144
  ds_read_b64 a[50:51], v31 offset:6144
  ds_read_b64_tr_b16 a[4:5], v42 offset:18448
  ds_read_b64_tr_b16 a[6:7], v42 offset:23056
  ds_read_b64_tr_b16 a[8:9], v42 offset:64
  ds_read_b64_tr_b16 a[10:11], v42 offset:4672
  s_waitcnt lgkmcnt(10)
  v_mfma_f32_16x16x32_bf16 v[112:115], a[0:3], a[36:39], 0
  s_add_u32 s31, s31, 1
  s_and_b32 s31, s31, 7
  s_lshl_b32 s80, s31, 7
  s_mul_i32 s81, s31, 0x2b000
  s_add_u32 m0, s83, 0x1a100
  s_waitcnt lgkmcnt(8)
  v_mfma_f32_16x16x32_bf16 v[116:119], a[0:3], a[40:43], 0
  buffer_load_dwordx4 v1, s[32:35], s80 offen lds
  s_waitcnt lgkmcnt(6)
  v_mfma_f32_16x16x32_bf16 v[120:123], a[0:3], a[44:47], 0
  ds_read_b64_tr_b16 a[12:13], v42 offset:18512
  ds_read_b64_tr_b16 a[14:15], v42 offset:23120
  s_waitcnt lgkmcnt(6)
  v_mfma_f32_16x16x32_bf16 v[124:127], a[0:3], a[48:51], 0
  ds_read_b64_tr_b16 a[16:17], v42 offset:128
  ds_read_b64_tr_b16 a[18:19], v42 offset:4736
  s_waitcnt lgkmcnt(6)
  v_mfma_f32_16x16x32_bf16 v[128:131], a[4:7], a[36:39], 0
  ds_read_b64_tr_b16 a[20:21], v42 offset:18576
  ds_read_b64_tr_b16 a[22:23], v42 offset:23184
  v_mfma_f32_16x16x32_bf16 v[132:135], a[4:7], a[40:43], 0
  buffer_load_dwordx4 v2, s[32:35], s80 offen offset:1024 lds
  v_mfma_f32_16x16x32_bf16 v[136:139], a[4:7], a[44:47], 0
  ds_read_b64_tr_b16 a[24:25], v45
  ds_read_b64_tr_b16 a[26:27], v45 offset:4608
  v_mfma_f32_16x16x32_bf16 v[140:143], a[4:7], a[48:51], 0
  ds_read_b64_tr_b16 a[28:29], v42 offset:224
  ds_read_b64_tr_b16 a[30:31], v42 offset:4832
  s_waitcnt lgkmcnt(10)
  v_mfma_f32_16x16x32_bf16 v[144:147], a[8:11], a[36:39], 0
  ds_read_b64_tr_b16 a[32:33], v42 offset:18672
  ds_read_b64_tr_b16 a[34:35], v42 offset:23280
  v_mfma_f32_16x16x32_bf16 v[148:151], a[8:11], a[40:43], 0
  ds_read_b64_tr_b16 a[0:1], v42 offset:9216
  ds_read_b64_tr_b16 a[2:3], v42 offset:13824
  v_mfma_f32_16x16x32_bf16 v[152:155], a[8:11], a[44:47], 0
  ds_read_b64 a[52:53], v32
  ds_read_b64 a[54:55], v33
  v_mfma_f32_16x16x32_bf16 v[156:159], a[8:11], a[48:51], 0
  buffer_load_dwordx4 v3, s[32:35], s80 offen offset:2048 lds
  s_waitcnt lgkmcnt(14)
  v_mfma_f32_16x16x32_bf16 v[160:163], a[12:15], a[36:39], 0
  ds_read_b64 a[56:57], v32 offset:2048
  ds_read_b64 a[58:59], v33 offset:2048
  v_mfma_f32_16x16x32_bf16 v[164:167], a[12:15], a[40:43], 0
  ds_read_b64 a[60:61], v32 offset:4096
  ds_read_b64 a[62:63], v33 offset:4096
  v_mfma_f32_16x16x32_bf16 v[168:171], a[12:15], a[44:47], 0
  ds_read_b64 a[64:65], v32 offset:6144
  ds_read_b64 a[66:67], v33 offset:6144
  v_mfma_f32_16x16x32_bf16 v[172:175], a[12:15], a[48:51], 0
  ds_read_b64_tr_b16 a[4:5], v42 offset:27664
  ds_read_b64_tr_b16 a[6:7], v42 offset:32272
  s_waitcnt lgkmcnt(14)
  v_mfma_f32_16x16x32_bf16 v[176:179], a[16:19], a[36:39], 0
  buffer_load_dwordx4 v4, s[32:35], s80 offen offset:3072 lds
  v_mfma_f32_16x16x32_bf16 v[180:183], a[16:19], a[40:43], 0
  ds_read_b64_tr_b16 a[8:9], v42 offset:9280
  ds_read_b64_tr_b16 a[10:11], v42 offset:13888
  v_mfma_f32_16x16x32_bf16 v[184:187], a[16:19], a[44:47], 0
  ds_read_b64_tr_b16 a[12:13], v42 offset:27728
  ds_read_b64_tr_b16 a[14:15], v42 offset:32336
  v_mfma_f32_16x16x32_bf16 v[188:191], a[16:19], a[48:51], 0
  ds_read_b64_tr_b16 a[16:17], v42 offset:9344
  ds_read_b64_tr_b16 a[18:19], v42 offset:13952
  v_mfma_f32_16x16x32_bf16 v[192:195], a[20:23], a[36:39], 0
  v_mfma_f32_16x16x32_bf16 v[196:199], a[20:23], a[40:43], 0
  s_add_u32 m0, s84, 0x1a100
  v_mfma_f32_16x16x32_bf16 v[200:203], a[20:23], a[44:47], 0
  buffer_load_dwordx4 v7, s[36:39], s81 offen lds
  v_mfma_f32_16x16x32_bf16 v[204:207], a[20:23], a[48:51], 0
  ds_read_b64_tr_b16 a[20:21], v42 offset:27792
  ds_read_b64_tr_b16 a[22:23], v42 offset:32400
  v_mfma_f32_16x16x32_bf16 v[208:211], a[24:27], a[36:39], 0
  v_mfma_f32_16x16x32_bf16 v[212:215], a[24:27], a[40:43], 0
  v_mfma_f32_16x16x32_bf16 v[216:219], a[24:27], a[44:47], 0
  v_mfma_f32_16x16x32_bf16 v[220:223], a[24:27], a[48:51], 0
  buffer_load_dwordx4 v16, s[36:39], s81 offen offset:1024 lds
  v_mfma_f32_16x16x32_bf16 v[224:227], a[28:31], a[36:39], 0
  ds_read_b64_tr_b16 a[24:25], v45 offset:9216
  ds_read_b64_tr_b16 a[26:27], v45 offset:13824
  v_mfma_f32_16x16x32_bf16 v[228:231], a[28:31], a[40:43], 0
  v_mfma_f32_16x16x32_bf16 v[232:235], a[28:31], a[44:47], 0
  v_mfma_f32_16x16x32_bf16 v[236:239], a[28:31], a[48:51], 0
  ds_read_b64_tr_b16 a[28:29], v42 offset:9440
  ds_read_b64_tr_b16 a[30:31], v42 offset:14048
  s_waitcnt lgkmcnt(6)
  v_mfma_f32_16x16x32_bf16 v[240:243], a[32:35], a[36:39], 0
  v_mfma_f32_16x16x32_bf16 v[244:247], a[32:35], a[40:43], 0
  buffer_load_dwordx4 v17, s[36:39], s81 offen offset:2048 lds
  v_mfma_f32_16x16x32_bf16 v[248:251], a[32:35], a[44:47], 0
  v_mfma_f32_16x16x32_bf16 v[252:255], a[32:35], a[48:51], 0
  ds_read_b64_tr_b16 a[32:33], v42 offset:27888
  ds_read_b64_tr_b16 a[34:35], v42 offset:32496
  v_mfma_f32_16x16x32_bf16 v[112:115], a[0:3], a[52:55], v[112:115]
  v_mfma_f32_16x16x32_bf16 v[116:119], a[0:3], a[56:59], v[116:119]
  v_mfma_f32_16x16x32_bf16 v[120:123], a[0:3], a[60:63], v[120:123]
  buffer_load_dwordx4 v18, s[36:39], s81 offen offset:3072 lds
  v_mfma_f32_16x16x32_bf16 v[124:127], a[0:3], a[64:67], v[124:127]
  v_mfma_f32_16x16x32_bf16 v[128:131], a[4:7], a[52:55], v[128:131]
  v_mfma_f32_16x16x32_bf16 v[132:135], a[4:7], a[56:59], v[132:135]
  s_waitcnt vmcnt(9)
  s_waitcnt lgkmcnt(0)
  s_barrier
  ds_read_b64_tr_b16 a[0:1], v43
  v_mfma_f32_16x16x32_bf16 v[136:139], a[4:7], a[60:63], v[136:139]
  ds_read_b64_tr_b16 a[2:3], v43 offset:4608
  ds_read_b64 a[36:37], v34
  v_mfma_f32_16x16x32_bf16 v[140:143], a[4:7], a[64:67], v[140:143]
  s_add_u32 m0, s85, 0x1a100
  ds_read_b64 a[38:39], v35
  v_mfma_f32_16x16x32_bf16 v[144:147], a[8:11], a[52:55], v[144:147]
  buffer_load_dwordx4 v19, s[36:39], s81 offen lds
  v_mfma_f32_16x16x32_bf16 v[148:151], a[8:11], a[56:59], v[148:151]
  ds_read_b64 a[40:41], v34 offset:2048
  ds_read_b64 a[42:43], v35 offset:2048
  v_mfma_f32_16x16x32_bf16 v[152:155], a[8:11], a[60:63], v[152:155]
  ds_read_b64 a[44:45], v34 offset:4096
  ds_read_b64 a[46:47], v35 offset:4096
  v_mfma_f32_16x16x32_bf16 v[156:159], a[8:11], a[64:67], v[156:159]
  ds_read_b64 a[48:49], v34 offset:6144
  ds_read_b64 a[50:51], v35 offset:6144
  v_mfma_f32_16x16x32_bf16 v[160:163], a[12:15], a[52:55], v[160:163]
  s_add_u32 m0, s84, 0x1c500
  ds_read_b64_tr_b16 a[4:5], v43 offset:18448
  v_mfma_f32_16x16x32_bf16 v[164:167], a[12:15], a[56:59], v[164:167]
  buffer_load_dwordx4 v20, s[36:39], s81 offen lds
  v_mfma_f32_16x16x32_bf16 v[168:171], a[12:15], a[60:63], v[168:171]
  ds_read_b64_tr_b16 a[6:7], v43 offset:23056
  ds_read_b64_tr_b16 a[8:9], v43 offset:64
  v_mfma_f32_16x16x32_bf16 v[172:175], a[12:15], a[64:67], v[172:175]
  ds_read_b64_tr_b16 a[10:11], v43 offset:4672
  ds_read_b64_tr_b16 a[12:13], v43 offset:18512
  v_mfma_f32_16x16x32_bf16 v[176:179], a[16:19], a[52:55], v[176:179]
  ds_read_b64_tr_b16 a[14:15], v43 offset:23120
  v_mfma_f32_16x16x32_bf16 v[180:183], a[16:19], a[56:59], v[180:183]
  v_mfma_f32_16x16x32_bf16 v[184:187], a[16:19], a[60:63], v[184:187]
  v_mfma_f32_16x16x32_bf16 v[188:191], a[16:19], a[64:67], v[188:191]
  buffer_load_dwordx4 v21, s[36:39], s81 offen offset:1024 lds
  v_mfma_f32_16x16x32_bf16 v[192:195], a[20:23], a[52:55], v[192:195]
  ds_read_b64_tr_b16 a[16:17], v43 offset:128
  ds_read_b64_tr_b16 a[18:19], v43 offset:4736
  v_mfma_f32_16x16x32_bf16 v[196:199], a[20:23], a[56:59], v[196:199]
  s_mov_b64 exec, 15
  buffer_load_dword v62, v65, s[56:59], s14 offen
  s_mov_b64 exec, -1
  v_mfma_f32_16x16x32_bf16 v[200:203], a[20:23], a[60:63], v[200:203]
  v_mfma_f32_16x16x32_bf16 v[204:207], a[20:23], a[64:67], v[204:207]
  s_mov_b64 exec, 0x7ff
  buffer_load_dword v62, v65, s[60:63], s15 offen
  s_mov_b64 exec, -1
  v_mfma_f32_16x16x32_bf16 v[208:211], a[24:27], a[52:55], v[208:211]
  buffer_load_dwordx4 v22, s[36:39], s81 offen offset:2048 lds
  v_mfma_f32_16x16x32_bf16 v[212:215], a[24:27], a[56:59], v[212:215]
  ds_read_b64_tr_b16 a[20:21], v43 offset:18576
  ds_read_b64_tr_b16 a[22:23], v43 offset:23184
  v_mfma_f32_16x16x32_bf16 v[216:219], a[24:27], a[60:63], v[216:219]
  v_mfma_f32_16x16x32_bf16 v[220:223], a[24:27], a[64:67], v[220:223]
  ds_read_b64_tr_b16 a[24:25], v46
  ds_read_b64_tr_b16 a[26:27], v46 offset:4608
  v_mfma_f32_16x16x32_bf16 v[224:227], a[28:31], a[52:55], v[224:227]
  v_mfma_f32_16x16x32_bf16 v[228:231], a[28:31], a[56:59], v[228:231]
  v_mfma_f32_16x16x32_bf16 v[232:235], a[28:31], a[60:63], v[232:235]
  buffer_load_dwordx4 v23, s[36:39], s81 offen offset:3072 lds
  v_mfma_f32_16x16x32_bf16 v[236:239], a[28:31], a[64:67], v[236:239]
  ds_read_b64_tr_b16 a[68:69], v48
  ds_read_b64_tr_b16 a[70:71], v48 offset:4608
  v_mfma_f32_16x16x32_bf16 v[240:243], a[32:35], a[52:55], v[240:243]
  ds_read_b64_tr_b16 a[72:73], v48 offset:64
  ds_read_b64_tr_b16 a[74:75], v48 offset:4672
  v_mfma_f32_16x16x32_bf16 v[244:247], a[32:35], a[56:59], v[244:247]
  ds_read_b64_tr_b16 a[28:29], v43 offset:224
  ds_read_b64_tr_b16 a[30:31], v43 offset:4832
  v_mfma_f32_16x16x32_bf16 v[248:251], a[32:35], a[60:63], v[248:251]
  s_add_u32 s31, s31, 1
  s_and_b32 s31, s31, 7
  v_mfma_f32_16x16x32_bf16 v[252:255], a[32:35], a[64:67], v[252:255]
  s_lshl_b32 s80, s31, 7
  s_mul_i32 s81, s31, 0x2b000
  s_waitcnt lgkmcnt(10)
  v_mfma_f32_16x16x32_bf16 v[112:115], a[0:3], a[36:39], v[112:115]
  s_add_u32 m0, s83, 0
  ds_read_b64_tr_b16 a[76:77], v48 offset:128
  v_mfma_f32_16x16x32_bf16 v[116:119], a[0:3], a[40:43], v[116:119]
  buffer_load_dwordx4 v1, s[32:35], s80 offen lds
  v_mfma_f32_16x16x32_bf16 v[120:123], a[0:3], a[44:47], v[120:123]
  ds_read_b64_tr_b16 a[78:79], v48 offset:4736
  ds_read_b64_tr_b16 a[80:81], v48 offset:224
  v_mfma_f32_16x16x32_bf16 v[124:127], a[0:3], a[48:51], v[124:127]
  ds_read_b64_tr_b16 a[82:83], v48 offset:4832
  ds_read_b64_tr_b16 a[84:85], v46
  v_mfma_f32_16x16x32_bf16 v[128:131], a[4:7], a[36:39], v[128:131]
  ds_read_b64_tr_b16 a[86:87], v46 offset:4608
  ds_read_b64_tr_b16 a[88:89], v48 offset:9216
  v_mfma_f32_16x16x32_bf16 v[132:135], a[4:7], a[40:43], v[132:135]
  buffer_load_dwordx4 v2, s[32:35], s80 offen offset:1024 lds
  v_mfma_f32_16x16x32_bf16 v[136:139], a[4:7], a[44:47], v[136:139]
  ds_read_b64_tr_b16 a[90:91], v48 offset:13824
  ds_read_b64_tr_b16 a[92:93], v48 offset:9280
  v_mfma_f32_16x16x32_bf16 v[140:143], a[4:7], a[48:51], v[140:143]
  ds_read_b64_tr_b16 a[94:95], v48 offset:13888
  ds_read_b64_tr_b16 a[32:33], v43 offset:18672
  v_mfma_f32_16x16x32_bf16 v[144:147], a[8:11], a[36:39], v[144:147]
  ds_read_b64_tr_b16 a[96:97], v48 offset:9344
  ds_read_b64_tr_b16 a[98:99], v48 offset:13952
  v_mfma_f32_16x16x32_bf16 v[148:151], a[8:11], a[40:43], v[148:151]
  s_branch L_skip1B
.p2align 12
L_pad1B:
  s_setpc_b64 s[20:21]
L_skip1B:
  ds_read_b64_tr_b16 a[34:35], v43 offset:23280
  ds_read_b64_tr_b16 a[0:1], v43 offset:9216
  v_mfma_f32_16x16x32_bf16 v[152:155], a[8:11], a[44:47], v[152:155]
  ds_read_b64_tr_b16 a[100:101], v48 offset:9440
  ds_read_b64_tr_b16 a[102:103], v48 offset:14048
  v_mfma_f32_16x16x32_bf16 v[156:159], a[8:11], a[48:51], v[156:159]
  buffer_load_dwordx4 v3, s[32:35], s80 offen offset:2048 lds
  v_mfma_f32_16x16x32_bf16 v[160:163], a[12:15], a[36:39], v[160:163]
  ds_read_b64_tr_b16 a[104:105], v46 offset:9216
  ds_read_b64_tr_b16 a[106:107], v46 offset:13824
  v_mfma_f32_16x16x32_bf16 v[164:167], a[12:15], a[40:43], v[164:167]
  ds_read_b64_tr_b16 a[2:3], v43 offset:13824
  ds_read_b64 a[52:53], v36
  v_mfma_f32_16x16x32_bf16 v[168:171], a[12:15], a[44:47], v[168:171]
  ds_read_b64 a[54:55], v37
  ds_read_b64 a[56:57], v36 offset:2048
  v_mfma_f32_16x16x32_bf16 v[172:175], a[12:15], a[48:51], v[172:175]
  ds_read_b64 a[58:59], v37 offset:2048
  ds_read_b64 a[60:61], v36 offset:4096
  v_mfma_f32_16x16x32_bf16 v[176:179], a[16:19], a[36:39], v[176:179]
  buffer_load_dwordx4 v4, s[32:35], s80 offen offset:3072 lds
  v_mfma_f32_16x16x32_bf16 v[180:183], a[16:19], a[40:43], v[180:183]
  ds_read_b64 a[62:63], v37 offset:4096
  ds_read_b64 a[64:65], v36 offset:6144
  v_mfma_f32_16x16x32_bf16 v[184:187], a[16:19], a[44:47], v[184:187]
  ds_read_b64 a[66:67], v37 offset:6144
  ds_read_b64_tr_b16 a[4:5], v43 offset:27664
  v_mfma_f32_16x16x32_bf16 v[188:191], a[16:19], a[48:51], v[188:191]
  ds_read_b64_tr_b16 a[6:7], v43 offset:32272
  ds_read_b64_tr_b16 a[8:9], v43 offset:9280
  s_waitcnt lgkmcnt(14)
  v_mfma_f32_16x16x32_bf16 v[192:195], a[20:23], a[36:39], v[192:195]
  ds_read_b64_tr_b16 a[10:11], v43 offset:13888
  ds_read_b64_tr_b16 a[12:13], v43 offset:27728
  v_mfma_f32_16x16x32_bf16 v[196:199], a[20:23], a[40:43], v[196:199]
  s_add_u32 m0, s84, 0
  ds_read_b64_tr_b16 a[14:15], v43 offset:32336
  v_mfma_f32_16x16x32_bf16 v[200:203], a[20:23], a[44:47], v[200:203]
  buffer_load_dwordx4 v7, s[36:39], s81 offen lds
  v_mfma_f32_16x16x32_bf16 v[204:207], a[20:23], a[48:51], v[204:207]
  ds_read_b64_tr_b16 a[16:17], v43 offset:9344
  ds_read_b64_tr_b16 a[18:19], v43 offset:13952
  v_mfma_f32_16x16x32_bf16 v[208:211], a[24:27], a[36:39], v[208:211]
  ds_read_b64_tr_b16 a[20:21], v43 offset:27792
  ds_read_b64_tr_b16 a[22:23], v43 offset:32400
  v_mfma_f32_16x16x32_bf16 v[212:215], a[24:27], a[40:43], v[212:215]
  v_mfma_f32_16x16x32_bf16 v[216:219], a[24:27], a[44:47], v[216:219]
  v_mfma_f32_16x16x32_bf16 v[8:11], a[108:111], a[68:71], 0
  v_mfma_f32_16x16x32_bf16 v[220:223], a[24:27], a[48:51], v[220:223]
  buffer_load_dwordx4 v16, s[36:39], s81 offen offset:1024 lds
  v_mfma_f32_16x16x32_bf16 v[224:227], a[28:31], a[36:39], v[224:227]
  v_mfma_f32_16x16x32_bf16 v[8:11], a[112:115], a[72:75], v[8:11]
  ds_read_b64_tr_b16 a[24:25], v46 offset:9216
  v_mfma_f32_16x16x32_bf16 v[228:231], a[28:31], a[40:43], v[228:231]
  ds_read_b64_tr_b16 a[26:27], v46 offset:13824
  v_mfma_f32_16x16x32_bf16 v[232:235], a[28:31], a[44:47], v[232:235]
  v_mfma_f32_16x16x32_bf16 v[8:11], a[116:119], a[76:79], v[8:11]
  v_mfma_f32_16x16x32_bf16 v[236:239], a[28:31], a[48:51], v[236:239]
  ds_read_b64_tr_b16 a[28:29], v43 offset:9440
  ds_read_b64_tr_b16 a[30:31], v43 offset:14048
  v_mfma_f32_16x16x32_bf16 v[240:243], a[32:35], a[36:39], v[240:243]
  v_mfma_f32_16x16x32_bf16 v[8:11], a[120:123], a[80:83], v[8:11]
  v_mfma_f32_16x16x32_bf16 v[244:247], a[32:35], a[40:43], v[244:247]
  buffer_load_dwordx4 v17, s[36:39], s81 offen offset:2048 lds
  v_mfma_f32_16x16x32_bf16 v[248:251], a[32:35], a[44:47], v[248:251]
  v_mfma_f32_16x16x32_bf16 v[12:15], a[108:111], a[84:87], 0
  v_mfma_f32_16x16x32_bf16 v[252:255], a[32:35], a[48:51], v[252:255]
  ds_read_b64_tr_b16 a[32:33], v43 offset:27888
  ds_read_b64_tr_b16 a[34:35], v43 offset:32496
  s_waitcnt lgkmcnt(6)
  v_mfma_f32_16x16x32_bf16 v[112:115], a[0:3], a[52:55], v[112:115]
  v_mfma_f32_16x16x32_bf16 v[8:11], a[108:111], a[88:91], v[8:11]
  v_mfma_f32_16x16x32_bf16 v[116:119], a[0:3], a[56:59], v[116:119]
  v_mfma_f32_16x16x32_bf16 v[120:123], a[0:3], a[60:63], v[120:123]
  v_mfma_f32_16x16x32_bf16 v[8:11], a[112:115], a[92:95], v[8:11]
  v_mfma_f32_16x16x32_bf16 v[124:127], a[0:3], a[64:67], v[124:127]
  buffer_load_dwordx4 v18, s[36:39], s81 offen offset:3072 lds
  v_mfma_f32_16x16x32_bf16 v[128:131], a[4:7], a[52:55], v[128:131]
  v_mfma_f32_16x16x32_bf16 v[8:11], a[116:119], a[96:99], v[8:11]
  s_mov_b32 s89, 0x5600
  v_mfma_f32_16x16x32_bf16 v[132:135], a[4:7], a[56:59], v[132:135]
  s_waitcnt vmcnt(8)
  s_waitcnt lgkmcnt(0)
  s_barrier
  ds_read_b64_tr_b16 a[0:1], v44
  v_mfma_f32_16x16x32_bf16 v[136:139], a[4:7], a[60:63], v[136:139]
  v_mfma_f32_16x16x32_bf16 v[8:11], a[120:123], a[100:103], v[8:11]
  ds_read_b64_tr_b16 a[2:3], v44 offset:4608
  v_mfma_f32_16x16x32_bf16 v[140:143], a[4:7], a[64:67], v[140:143]
  s_add_u32 m0, s85, 0
  ds_read_b64 a[36:37], v38
  v_mfma_f32_16x16x32_bf16 v[144:147], a[8:11], a[52:55], v[144:147]
  v_mfma_f32_16x16x32_bf16 v[12:15], a[108:111], a[104:107], v[12:15]
  ds_read_b64 a[38:39], v39
  v_mfma_f32_16x16x32_bf16 v[148:151], a[8:11], a[56:59], v[148:151]
  buffer_load_dwordx4 v19, s[36:39], s81 offen lds
  v_mfma_f32_16x16x32_bf16 v[152:155], a[8:11], a[60:63], v[152:155]
  ds_read_b64 a[40:41], v38 offset:2048
  ds_read_b64 a[42:43], v39 offset:2048
  v_mfma_f32_16x16x32_bf16 v[156:159], a[8:11], a[64:67], v[156:159]
  ds_read_b64 a[44:45], v38 offset:4096
  ds_read_b64 a[46:47], v39 offset:4096
  v_mfma_f32_16x16x32_bf16 v[160:163], a[12:15], a[52:55], v[160:163]
  s_add_u32 m0, s84, 0x2400
  ds_read_b64 a[48:49], v38 offset:6144
  v_mfma_f32_16x16x32_bf16 v[164:167], a[12:15], a[56:59], v[164:167]
  buffer_load_dwordx4 v20, s[36:39], s81 offen lds
  v_mfma_f32_16x16x32_bf16 v[168:171], a[12:15], a[60:63], v[168:171]
  v_cvt_pk_bf16_f32 v9, v8, v8
  v_and_b32 v10, 0xffff0000, v9
  v_mfma_f32_16x16x32_bf16 v[172:175], a[12:15], a[64:67], v[172:175]
  v_sub_f32 v10, v8, v10
  v_cvt_pk_bf16_f32 v11, v10, v10
  v_mfma_f32_16x16x32_bf16 v[176:179], a[16:19], a[52:55], v[176:179]
  buffer_store_short v9, v49, s[48:51], 0 offen sc1
  v_mfma_f32_16x16x32_bf16 v[180:183], a[16:19], a[56:59], v[180:183]
  ds_read_b64 a[50:51], v39 offset:6144
  ds_read_b64_tr_b16 a[4:5], v44 offset:18448
  v_mfma_f32_16x16x32_bf16 v[184:187], a[16:19], a[60:63], v[184:187]
  buffer_store_short v11, v49, s[48:51], s89 offen sc1
  v_mfma_f32_16x16x32_bf16 v[188:191], a[16:19], a[64:67], v[188:191]
  buffer_load_dwordx4 v21, s[36:39], s81 offen offset:1024 lds
  v_mfma_f32_16x16x32_bf16 v[192:195], a[20:23], a[52:55], v[192:195]
  ds_read_b64_tr_b16 a[6:7], v44 offset:23056
  ds_read_b64_tr_b16 a[8:9], v44 offset:64
  v_mfma_f32_16x16x32_bf16 v[196:199], a[20:23], a[56:59], v[196:199]
  s_mov_b64 exec, 0xffff
  buffer_load_dword v62, v61, s[60:63], s6 offen
  s_mov_b64 exec, -1
  v_mfma_f32_16x16x32_bf16 v[200:203], a[20:23], a[60:63], v[200:203]
  v_cvt_pk_bf16_f32 v13, v12, v12
  v_and_b32 v14, 0xffff0000, v13
  v_mfma_f32_16x16x32_bf16 v[204:207], a[20:23], a[64:67], v[204:207]
  v_sub_f32 v14, v12, v14
  v_cvt_pk_bf16_f32 v15, v14, v14
  v_mfma_f32_16x16x32_bf16 v[208:211], a[24:27], a[52:55], v[208:211]
  buffer_load_dwordx4 v22, s[36:39], s81 offen offset:2048 lds
  v_mfma_f32_16x16x32_bf16 v[212:215], a[24:27], a[56:59], v[212:215]
  buffer_store_short v13, v50, s[48:51], 0 offen sc1
  v_mfma_f32_16x16x32_bf16 v[216:219], a[24:27], a[60:63], v[216:219]
  buffer_store_short v15, v50, s[48:51], s89 offen sc1
  v_mfma_f32_16x16x32_bf16 v[220:223], a[24:27], a[64:67], v[220:223]
  ds_read_b64_tr_b16 a[10:11], v44 offset:4672
  ds_read_b64_tr_b16 a[12:13], v44 offset:18512
  v_mfma_f32_16x16x32_bf16 v[224:227], a[28:31], a[52:55], v[224:227]
  ds_read_b64_tr_b16 a[14:15], v44 offset:23120
  ds_read_b64_tr_b16 a[16:17], v44 offset:128
  v_mfma_f32_16x16x32_bf16 v[228:231], a[28:31], a[56:59], v[228:231]
  ds_read_b64_tr_b16 a[18:19], v44 offset:4736
  ds_read_b64_tr_b16 a[20:21], v44 offset:18576
  v_mfma_f32_16x16x32_bf16 v[232:235], a[28:31], a[60:63], v[232:235]
  buffer_load_dwordx4 v23, s[36:39], s81 offen offset:3072 lds
  v_mfma_f32_16x16x32_bf16 v[236:239], a[28:31], a[64:67], v[236:239]
  ds_read_b64_tr_b16 a[22:23], v44 offset:23184
  ds_read_b64_tr_b16 a[24:25], v47
  v_mfma_f32_16x16x32_bf16 v[240:243], a[32:35], a[52:55], v[240:243]
  ds_read_b64_tr_b16 a[26:27], v47 offset:4608
  ds_read_b64_tr_b16 a[28:29], v44 offset:224
  v_mfma_f32_16x16x32_bf16 v[244:247], a[32:35], a[56:59], v[244:247]
  s_add_u32 s31, s31, 1
  s_and_b32 s31, s31, 7
  v_mfma_f32_16x16x32_bf16 v[248:251], a[32:35], a[60:63], v[248:251]
  s_lshl_b32 s80, s31, 7
  s_mul_i32 s81, s31, 0x2b000
  v_mfma_f32_16x16x32_bf16 v[252:255], a[32:35], a[64:67], v[252:255]
  s_add_u32 m0, s83, 0xd080
  ds_read_b64_tr_b16 a[30:31], v44 offset:4832
  s_waitcnt lgkmcnt(11)
  v_mfma_f32_16x16x32_bf16 v[112:115], a[0:3], a[36:39], v[112:115]
  buffer_load_dwordx4 v1, s[32:35], s80 offen lds
  v_mfma_f32_16x16x32_bf16 v[116:119], a[0:3], a[40:43], v[116:119]
  ds_read_b64_tr_b16 a[32:33], v44 offset:18672
  ds_read_b64_tr_b16 a[34:35], v44 offset:23280
  v_mfma_f32_16x16x32_bf16 v[120:123], a[0:3], a[44:47], v[120:123]
  ds_read_b64 a[52:53], v40
  ds_read_b64 a[54:55], v41
  v_mfma_f32_16x16x32_bf16 v[124:127], a[0:3], a[48:51], v[124:127]
  ds_read_b64_tr_b16 a[0:1], v44 offset:9216
  ds_read_b64_tr_b16 a[2:3], v44 offset:13824
  v_mfma_f32_16x16x32_bf16 v[128:131], a[4:7], a[36:39], v[128:131]
  ds_read_b64 a[56:57], v40 offset:2048
  ds_read_b64 a[58:59], v41 offset:2048
  v_mfma_f32_16x16x32_bf16 v[132:135], a[4:7], a[40:43], v[132:135]
  buffer_load_dwordx4 v2, s[32:35], s80 offen offset:1024 lds
  v_mfma_f32_16x16x32_bf16 v[136:139], a[4:7], a[44:47], v[136:139]
  ds_read_b64 a[60:61], v40 offset:4096
  ds_read_b64 a[62:63], v41 offset:4096
  v_mfma_f32_16x16x32_bf16 v[140:143], a[4:7], a[48:51], v[140:143]
  ds_read_b64 a[64:65], v40 offset:6144
  ds_read_b64 a[66:67], v41 offset:6144
  s_waitcnt lgkmcnt(13)
  v_mfma_f32_16x16x32_bf16 v[144:147], a[8:11], a[36:39], v[144:147]
  ds_read_b64_tr_b16 a[4:5], v44 offset:27664
  ds_read_b64_tr_b16 a[6:7], v44 offset:32272
  v_mfma_f32_16x16x32_bf16 v[148:151], a[8:11], a[40:43], v[148:151]
  v_mfma_f32_16x16x32_bf16 v[152:155], a[8:11], a[44:47], v[152:155]
  v_mfma_f32_16x16x32_bf16 v[156:159], a[8:11], a[48:51], v[156:159]
  buffer_load_dwordx4 v3, s[32:35], s80 offen offset:2048 lds
  v_mfma_f32_16x16x32_bf16 v[160:163], a[12:15], a[36:39], v[160:163]
  ds_read_b64_tr_b16 a[8:9], v44 offset:9280
  ds_read_b64_tr_b16 a[10:11], v44 offset:13888
  v_mfma_f32_16x16x32_bf16 v[164:167], a[12:15], a[40:43], v[164:167]
  v_mfma_f32_16x16x32_bf16 v[168:171], a[12:15], a[44:47], v[168:171]
  v_mfma_f32_16x16x32_bf16 v[172:175], a[12:15], a[48:51], v[172:175]
  ds_read_b64_tr_b16 a[12:13], v44 offset:27728
  ds_read_b64_tr_b16 a[14:15], v44 offset:32336
  v_mfma_f32_16x16x32_bf16 v[176:179], a[16:19], a[36:39], v[176:179]
  buffer_load_dwordx4 v4, s[32:35], s80 offen offset:3072 lds
  v_mfma_f32_16x16x32_bf16 v[180:183], a[16:19], a[40:43], v[180:183]
  v_mfma_f32_16x16x32_bf16 v[184:187], a[16:19], a[44:47], v[184:187]
  v_mfma_f32_16x16x32_bf16 v[188:191], a[16:19], a[48:51], v[188:191]
  ds_read_b64_tr_b16 a[16:17], v44 offset:9344
  ds_read_b64_tr_b16 a[18:19], v44 offset:13952
  v_mfma_f32_16x16x32_bf16 v[192:195], a[20:23], a[36:39], v[192:195]
  v_mfma_f32_16x16x32_bf16 v[196:199], a[20:23], a[40:43], v[196:199]
  s_add_u32 m0, s84, 0xd080
  v_mfma_f32_16x16x32_bf16 v[200:203], a[20:23], a[44:47], v[200:203]
  buffer_load_dwordx4 v7, s[36:39], s81 offen lds
  v_mfma_f32_16x16x32_bf16 v[204:207], a[20:23], a[48:51], v[204:207]
  ds_read_b64_tr_b16 a[20:21], v44 offset:27792
  ds_read_b64_tr_b16 a[22:23], v44 offset:32400
  v_mfma_f32_16x16x32_bf16 v[208:211], a[24:27], a[36:39], v[208:211]
  v_mfma_f32_16x16x32_bf16 v[212:215], a[24:27], a[40:43], v[212:215]
  v_mfma_f32_16x16x32_bf16 v[216:219], a[24:27], a[44:47], v[216:219]
  v_mfma_f32_16x16x32_bf16 v[220:223], a[24:27], a[48:51], v[220:223]
  buffer_load_dwordx4 v16, s[36:39], s81 offen offset:1024 lds
  s_waitcnt lgkmcnt(4)
  v_mfma_f32_16x16x32_bf16 v[224:227], a[28:31], a[36:39], v[224:227]
  ds_read_b64_tr_b16 a[24:25], v47 offset:9216
  ds_read_b64_tr_b16 a[26:27], v47 offset:13824
  v_mfma_f32_16x16x32_bf16 v[228:231], a[28:31], a[40:43], v[228:231]
  v_mfma_f32_16x16x32_bf16 v[232:235], a[28:31], a[44:47], v[232:235]
  v_mfma_f32_16x16x32_bf16 v[236:239], a[28:31], a[48:51], v[236:239]
  ds_read_b64_tr_b16 a[28:29], v44 offset:9440
  ds_read_b64_tr_b16 a[30:31], v44 offset:14048
  v_mfma_f32_16x16x32_bf16 v[240:243], a[32:35], a[36:39], v[240:243]
  v_mfma_f32_16x16x32_bf16 v[244:247], a[32:35], a[40:43], v[244:247]
  buffer_load_dwordx4 v17, s[36:39], s81 offen offset:2048 lds
  v_mfma_f32_16x16x32_bf16 v[248:251], a[32:35], a[44:47], v[248:251]
  v_mfma_f32_16x16x32_bf16 v[252:255], a[32:35], a[48:51], v[252:255]
  ds_read_b64_tr_b16 a[32:33], v44 offset:27888
  ds_read_b64_tr_b16 a[34:35], v44 offset:32496
  v_mfma_f32_16x16x32_bf16 v[112:115], a[0:3], a[52:55], v[112:115]
  v_mfma_f32_16x16x32_bf16 v[116:119], a[0:3], a[56:59], v[116:119]
  v_mfma_f32_16x16x32_bf16 v[120:123], a[0:3], a[60:63], v[120:123]
  buffer_load_dwordx4 v18, s[36:39], s81 offen offset:3072 lds
  v_mfma_f32_16x16x32_bf16 v[124:127], a[0:3], a[64:67], v[124:127]
  v_mfma_f32_16x16x32_bf16 v[128:131], a[4:7], a[52:55], v[128:131]
  v_mfma_f32_16x16x32_bf16 v[132:135], a[4:7], a[56:59], v[132:135]
  s_waitcnt vmcnt(8)
  s_waitcnt lgkmcnt(0)
  s_barrier
  ds_read_b64_tr_b16 a[0:1], v42
  v_mfma_f32_16x16x32_bf16 v[136:139], a[4:7], a[60:63], v[136:139]
  s_cmp_lg_u32 s26, 0
  s_cbranch_scc1 L_B_pub1
  s_lshl_b32 s86, s24, 8
  s_lshl2_add_u32 s86, s30, s86
  s_add_u32 s86, s86, 0x870000
  v_mov_b32 v5, s86
  v_mov_b32 v6, s29
  s_mov_b64 exec, 1
  buffer_store_dword v6, v5, s[48:51], 0 offen sc0 sc1
  s_mov_b64 exec, -1
L_B_pub1:
  v_mfma_f32_16x16x32_bf16 v[140:143], a[4:7], a[64:67], v[140:143]
  s_add_u32 m0, s85, 0xd080
  ds_read_b64_tr_b16 a[2:3], v42 offset:4608
  v_mfma_f32_16x16x32_bf16 v[144:147], a[8:11], a[52:55], v[144:147]
  buffer_load_dwordx4 v19, s[36:39], s81 offen lds
  v_mfma_f32_16x16x32_bf16 v[148:151], a[8:11], a[56:59], v[148:151]
  ds_read_b64 a[36:37], v30
  ds_read_b64 a[38:39], v31
  v_mfma_f32_16x16x32_bf16 v[152:155], a[8:11], a[60:63], v[152:155]
  ds_read_b64 a[40:41], v30 offset:2048
  ds_read_b64 a[42:43], v31 offset:2048
  v_mfma_f32_16x16x32_bf16 v[156:159], a[8:11], a[64:67], v[156:159]
  ds_read_b64 a[44:45], v30 offset:4096
  ds_read_b64 a[46:47], v31 offset:4096
  v_mfma_f32_16x16x32_bf16 v[160:163], a[12:15], a[52:55], v[160:163]
  s_add_u32 m0, s84, 0xf480
  ds_read_b64 a[48:49], v30 offset:6144
  v_mfma_f32_16x16x32_bf16 v[164:167], a[12:15], a[56:59], v[164:167]
  buffer_load_dwordx4 v20, s[36:39], s81 offen lds
  v_mfma_f32_16x16x32_bf16 v[168:171], a[12:15], a[60:63], v[168:171]
  ds_read_b64 a[50:51], v31 offset:6144
  ds_read_b64_tr_b16 a[4:5], v42 offset:18448
  v_mfma_f32_16x16x32_bf16 v[172:175], a[12:15], a[64:67], v[172:175]
  ds_read_b64_tr_b16 a[6:7], v42 offset:23056
  ds_read_b64_tr_b16 a[8:9], v42 offset:64
  v_mfma_f32_16x16x32_bf16 v[176:179], a[16:19], a[52:55], v[176:179]
  ds_read_b64_tr_b16 a[10:11], v42 offset:4672
  ds_read_b64_tr_b16 a[12:13], v42 offset:18512
  v_mfma_f32_16x16x32_bf16 v[180:183], a[16:19], a[56:59], v[180:183]
  ds_read_b64_tr_b16 a[14:15], v42 offset:23120
  v_mfma_f32_16x16x32_bf16 v[184:187], a[16:19], a[60:63], v[184:187]
  v_mfma_f32_16x16x32_bf16 v[188:191], a[16:19], a[64:67], v[188:191]
  buffer_load_dwordx4 v21, s[36:39], s81 offen offset:1024 lds
  v_mfma_f32_16x16x32_bf16 v[192:195], a[20:23], a[52:55], v[192:195]
  ds_read_b64_tr_b16 a[16:17], v42 offset:128
  ds_read_b64_tr_b16 a[18:19], v42 offset:4736
  v_mfma_f32_16x16x32_bf16 v[196:199], a[20:23], a[56:59], v[196:199]
  s_mov_b64 exec, 0xffff
  buffer_load_dword v62, v61, s[60:63], s7 offen
  s_mov_b64 exec, -1
  v_mfma_f32_16x16x32_bf16 v[200:203], a[20:23], a[60:63], v[200:203]
  v_mfma_f32_16x16x32_bf16 v[204:207], a[20:23], a[64:67], v[204:207]
  ds_read_b64_tr_b16 a[20:21], v42 offset:18576
  ds_read_b64_tr_b16 a[22:23], v42 offset:23184
  v_mfma_f32_16x16x32_bf16 v[208:211], a[24:27], a[52:55], v[208:211]
  buffer_load_dwordx4 v22, s[36:39], s81 offen offset:2048 lds
  v_mfma_f32_16x16x32_bf16 v[212:215], a[24:27], a[56:59], v[212:215]
  v_mfma_f32_16x16x32_bf16 v[216:219], a[24:27], a[60:63], v[216:219]
  v_mfma_f32_16x16x32_bf16 v[220:223], a[24:27], a[64:67], v[220:223]
  ds_read_b64_tr_b16 a[24:25], v45
  ds_read_b64_tr_b16 a[26:27], v45 offset:4608
  v_mfma_f32_16x16x32_bf16 v[224:227], a[28:31], a[52:55], v[224:227]
  v_mfma_f32_16x16x32_bf16 v[228:231], a[28:31], a[56:59], v[228:231]
  v_mfma_f32_16x16x32_bf16 v[232:235], a[28:31], a[60:63], v[232:235]
  buffer_load_dwordx4 v23, s[36:39], s81 offen offset:3072 lds
  v_mfma_f32_16x16x32_bf16 v[236:239], a[28:31], a[64:67], v[236:239]
  ds_read_b64_tr_b16 a[28:29], v42 offset:224
  ds_read_b64_tr_b16 a[30:31], v42 offset:4832
  v_mfma_f32_16x16x32_bf16 v[240:243], a[32:35], a[52:55], v[240:243]
  v_mfma_f32_16x16x32_bf16 v[244:247], a[32:35], a[56:59], v[244:247]
  v_mfma_f32_16x16x32_bf16 v[248:251], a[32:35], a[60:63], v[248:251]
  s_add_u32 s31, s31, 1
  s_and_b32 s31, s31, 7
  v_mfma_f32_16x16x32_bf16 v[252:255], a[32:35], a[64:67], v[252:255]
  s_lshl_b32 s80, s31, 7
  s_mul_i32 s81, s31, 0x2b000
  s_waitcnt lgkmcnt(4)
  v_mfma_f32_16x16x32_bf16 v[112:115], a[0:3], a[36:39], v[112:115]
  s_add_u32 m0, s83, 0x1a100
  ds_read_b64_tr_b16 a[32:33], v42 offset:18672
  v_mfma_f32_16x16x32_bf16 v[116:119], a[0:3], a[40:43], v[116:119]
  buffer_load_dwordx4 v1, s[32:35], s80 offen lds
  v_mfma_f32_16x16x32_bf16 v[120:123], a[0:3], a[44:47], v[120:123]
  ds_read_b64_tr_b16 a[34:35], v42 offset:23280
  ds_read_b64 a[52:53], v32
  v_mfma_f32_16x16x32_bf16 v[124:127], a[0:3], a[48:51], v[124:127]
  ds_read_b64_tr_b16 a[0:1], v42 offset:9216
  ds_read_b64_tr_b16 a[2:3], v42 offset:13824
  v_mfma_f32_16x16x32_bf16 v[128:131], a[4:7], a[36:39], v[128:131]
  ds_read_b64 a[54:55], v33
  ds_read_b64 a[56:57], v32 offset:2048
  v_mfma_f32_16x16x32_bf16 v[132:135], a[4:7], a[40:43], v[132:135]
  buffer_load_dwordx4 v2, s[32:35], s80 offen offset:1024 lds
  v_mfma_f32_16x16x32_bf16 v[136:139], a[4:7], a[44:47], v[136:139]
  ds_read_b64 a[58:59], v33 offset:2048
  ds_read_b64 a[60:61], v32 offset:4096
  v_mfma_f32_16x16x32_bf16 v[140:143], a[4:7], a[48:51], v[140:143]
  ds_read_b64 a[62:63], v33 offset:4096
  ds_read_b64 a[64:65], v32 offset:6144
  v_mfma_f32_16x16x32_bf16 v[144:147], a[8:11], a[36:39], v[144:147]
  ds_read_b64 a[66:67], v33 offset:6144
  ds_read_b64_tr_b16 a[4:5], v42 offset:27664
  v_mfma_f32_16x16x32_bf16 v[148:151], a[8:11], a[40:43], v[148:151]
  ds_read_b64_tr_b16 a[6:7], v42 offset:32272
  v_mfma_f32_16x16x32_bf16 v[152:155], a[8:11], a[44:47], v[152:155]
  v_mfma_f32_16x16x32_bf16 v[156:159], a[8:11], a[48:51], v[156:159]
  buffer_load_dwordx4 v3, s[32:35], s80 offen offset:2048 lds
  v_mfma_f32_16x16x32_bf16 v[160:163], a[12:15], a[36:39], v[160:163]
  ds_read_b64_tr_b16 a[8:9], v42 offset:9280
  ds_read_b64_tr_b16 a[10:11], v42 offset:13888
  v_mfma_f32_16x16x32_bf16 v[164:167], a[12:15], a[40:43], v[164:167]
  v_mfma_f32_16x16x32_bf16 v[168:171], a[12:15], a[44:47], v[168:171]
  v_mfma_f32_16x16x32_bf16 v[172:175], a[12:15], a[48:51], v[172:175]
  ds_read_b64_tr_b16 a[12:13], v42 offset:27728
  ds_read_b64_tr_b16 a[14:15], v42 offset:32336
  v_mfma_f32_16x16x32_bf16 v[176:179], a[16:19], a[36:39], v[176:179]
  buffer_load_dwordx4 v4, s[32:35], s80 offen offset:3072 lds
  v_mfma_f32_16x16x32_bf16 v[180:183], a[16:19], a[40:43], v[180:183]
  v_mfma_f32_16x16x32_bf16 v[184:187], a[16:19], a[44:47], v[184:187]
  v_mfma_f32_16x16x32_bf16 v[188:191], a[16:19], a[48:51], v[188:191]
  ds_read_b64_tr_b16 a[16:17], v42 offset:9344
  ds_read_b64_tr_b16 a[18:19], v42 offset:13952
  v_mfma_f32_16x16x32_bf16 v[192:195], a[20:23], a[36:39], v[192:195]
  v_mfma_f32_16x16x32_bf16 v[196:199], a[20:23], a[40:43], v[196:199]
  s_add_u32 m0, s84, 0x1a100
  v_mfma_f32_16x16x32_bf16 v[200:203], a[20:23], a[44:47], v[200:203]
  buffer_load_dwordx4 v7, s[36:39], s81 offen lds
  v_mfma_f32_16x16x32_bf16 v[204:207], a[20:23], a[48:51], v[204:207]
  ds_read_b64_tr_b16 a[20:21], v42 offset:27792
  ds_read_b64_tr_b16 a[22:23], v42 offset:32400
  s_waitcnt lgkmcnt(6)
  v_mfma_f32_16x16x32_bf16 v[208:211], a[24:27], a[36:39], v[208:211]
  v_mfma_f32_16x16x32_bf16 v[212:215], a[24:27], a[40:43], v[212:215]
  v_mfma_f32_16x16x32_bf16 v[216:219], a[24:27], a[44:47], v[216:219]
  v_mfma_f32_16x16x32_bf16 v[220:223], a[24:27], a[48:51], v[220:223]
  buffer_load_dwordx4 v16, s[36:39], s81 offen offset:1024 lds
  v_mfma_f32_16x16x32_bf16 v[224:227], a[28:31], a[36:39], v[224:227]
  ds_read_b64_tr_b16 a[24:25], v45 offset:9216
  ds_read_b64_tr_b16 a[26:27], v45 offset:13824
  v_mfma_f32_16x16x32_bf16 v[228:231], a[28:31], a[40:43], v[228:231]
  v_mfma_f32_16x16x32_bf16 v[232:235], a[28:31], a[44:47], v[232:235]
  v_mfma_f32_16x16x32_bf16 v[236:239], a[28:31], a[48:51], v[236:239]
  ds_read_b64_tr_b16 a[28:29], v42 offset:9440
  ds_read_b64_tr_b16 a[30:31], v42 offset:14048
  v_mfma_f32_16x16x32_bf16 v[240:243], a[32:35], a[36:39], v[240:243]
  v_mfma_f32_16x16x32_bf16 v[244:247], a[32:35], a[40:43], v[244:247]
  buffer_load_dwordx4 v17, s[36:39], s81 offen offset:2048 lds
  v_mfma_f32_16x16x32_bf16 v[248:251], a[32:35], a[44:47], v[248:251]
  v_mfma_f32_16x16x32_bf16 v[252:255], a[32:35], a[48:51], v[252:255]
  ds_read_b64_tr_b16 a[32:33], v42 offset:27888
  ds_read_b64_tr_b16 a[34:35], v42 offset:32496
  v_mfma_f32_16x16x32_bf16 v[112:115], a[0:3], a[52:55], v[112:115]
  v_mfma_f32_16x16x32_bf16 v[116:119], a[0:3], a[56:59], v[116:119]
  v_mfma_f32_16x16x32_bf16 v[120:123], a[0:3], a[60:63], v[120:123]
  buffer_load_dwordx4 v18, s[36:39], s81 offen offset:3072 lds
  v_mfma_f32_16x16x32_bf16 v[124:127], a[0:3], a[64:67], v[124:127]
  v_mfma_f32_16x16x32_bf16 v[128:131], a[4:7], a[52:55], v[128:131]
  v_mfma_f32_16x16x32_bf16 v[132:135], a[4:7], a[56:59], v[132:135]
  s_waitcnt vmcnt(8)
  s_waitcnt lgkmcnt(0)
  s_barrier
  ds_read_b64_tr_b16 a[0:1], v43
  v_mfma_f32_16x16x32_bf16 v[136:139], a[4:7], a[60:63], v[136:139]
  ds_read_b64_tr_b16 a[2:3], v43 offset:4608
  ds_read_b64 a[36:37], v34
  v_mfma_f32_16x16x32_bf16 v[140:143], a[4:7], a[64:67], v[140:143]
  s_add_u32 m0, s85, 0x1a100
  ds_read_b64 a[38:39], v35
  v_mfma_f32_16x16x32_bf16 v[144:147], a[8:11], a[52:55], v[144:147]
  buffer_load_dwordx4 v19, s[36:39], s81 offen lds
  v_mfma_f32_16x16x32_bf16 v[148:151], a[8:11], a[56:59], v[148:151]
  ds_read_b64 a[40:41], v34 offset:2048
  ds_read_b64 a[42:43], v35 offset:2048
  v_mfma_f32_16x16x32_bf16 v[152:155], a[8:11], a[60:63], v[152:155]
  ds_read_b64 a[44:45], v34 offset:4096
  ds_read_b64 a[46:47], v35 offset:4096
  v_mfma_f32_16x16x32_bf16 v[156:159], a[8:11], a[64:67], v[156:159]
  ds_read_b64 a[48:49], v34 offset:6144
  ds_read_b64 a[50:51], v35 offset:6144
  v_mfma_f32_16x16x32_bf16 v[160:163], a[12:15], a[52:55], v[160:163]
  s_add_u32 m0, s84, 0x1c500
  ds_read_b64_tr_b16 a[4:5], v43 offset:18448
  v_mfma_f32_16x16x32_bf16 v[164:167], a[12:15], a[56:59], v[164:167]
  buffer_load_dwordx4 v20, s[36:39], s81 offen lds
  v_mfma_f32_16x16x32_bf16 v[168:171], a[12:15], a[60:63], v[168:171]
  ds_read_b64_tr_b16 a[6:7], v43 offset:23056
  ds_read_b64_tr_b16 a[8:9], v43 offset:64
  v_mfma_f32_16x16x32_bf16 v[172:175], a[12:15], a[64:67], v[172:175]
  ds_read_b64_tr_b16 a[10:11], v43 offset:4672
  ds_read_b64_tr_b16 a[12:13], v43 offset:18512
  v_mfma_f32_16x16x32_bf16 v[176:179], a[16:19], a[52:55], v[176:179]
  ds_read_b64_tr_b16 a[14:15], v43 offset:23120
  v_mfma_f32_16x16x32_bf16 v[180:183], a[16:19], a[56:59], v[180:183]
  v_mfma_f32_16x16x32_bf16 v[184:187], a[16:19], a[60:63], v[184:187]
  v_mfma_f32_16x16x32_bf16 v[188:191], a[16:19], a[64:67], v[188:191]
  buffer_load_dwordx4 v21, s[36:39], s81 offen offset:1024 lds
  v_mfma_f32_16x16x32_bf16 v[192:195], a[20:23], a[52:55], v[192:195]
  ds_read_b64_tr_b16 a[16:17], v43 offset:128
  ds_read_b64_tr_b16 a[18:19], v43 offset:4736
  v_mfma_f32_16x16x32_bf16 v[196:199], a[20:23], a[56:59], v[196:199]
  s_add_u32 s90, s7, 0x10000
  s_mov_b64 exec, 0xfffff
  buffer_load_dword v62, v61, s[60:63], s90 offen
  s_mov_b64 exec, -1
  v_mfma_f32_16x16x32_bf16 v[200:203], a[20:23], a[60:63], v[200:203]
  v_mfma_f32_16x16x32_bf16 v[204:207], a[20:23], a[64:67], v[204:207]
  ds_read_b64_tr_b16 a[20:21], v43 offset:18576
  ds_read_b64_tr_b16 a[22:23], v43 offset:23184
  v_mfma_f32_16x16x32_bf16 v[208:211], a[24:27], a[52:55], v[208:211]
  buffer_load_dwordx4 v22, s[36:39], s81 offen offset:2048 lds
  v_mfma_f32_16x16x32_bf16 v[212:215], a[24:27], a[56:59], v[212:215]
  v_mfma_f32_16x16x32_bf16 v[216:219], a[24:27], a[60:63], v[216:219]
  v_mfma_f32_16x16x32_bf16 v[220:223], a[24:27], a[64:67], v[220:223]
  ds_read_b64_tr_b16 a[24:25], v46
  ds_read_b64_tr_b16 a[26:27], v46 offset:4608
  v_mfma_f32_16x16x32_bf16 v[224:227], a[28:31], a[52:55], v[224:227]
  v_mfma_f32_16x16x32_bf16 v[228:231], a[28:31], a[56:59], v[228:231]
  v_mfma_f32_16x16x32_bf16 v[232:235], a[28:31], a[60:63], v[232:235]
  buffer_load_dwordx4 v23, s[36:39], s81 offen offset:3072 lds
  v_mfma_f32_16x16x32_bf16 v[236:239], a[28:31], a[64:67], v[236:239]
  ds_read_b64_tr_b16 a[28:29], v43 offset:224
  ds_read_b64_tr_b16 a[30:31], v43 offset:4832
  v_mfma_f32_16x16x32_bf16 v[240:243], a[32:35], a[52:55], v[240:243]
  v_mfma_f32_16x16x32_bf16 v[244:247], a[32:35], a[56:59], v[244:247]
  v_mfma_f32_16x16x32_bf16 v[248:251], a[32:35], a[60:63], v[248:251]
  s_add_u32 s31, s31, 1
  s_and_b32 s31, s31, 7
  v_mfma_f32_16x16x32_bf16 v[252:255], a[32:35], a[64:67], v[252:255]
  s_lshl_b32 s80, s31, 7
  s_mul_i32 s81, s31, 0x2b000
  s_waitcnt lgkmcnt(4)
  v_mfma_f32_16x16x32_bf16 v[112:115], a[0:3], a[36:39], v[112:115]
  s_add_u32 m0, s83, 0
  ds_read_b64_tr_b16 a[32:33], v43 offset:18672
  v_mfma_f32_16x16x32_bf16 v[116:119], a[0:3], a[40:43], v[116:119]
  buffer_load_dwordx4 v1, s[32:35], s80 offen lds
  v_mfma_f32_16x16x32_bf16 v[120:123], a[0:3], a[44:47], v[120:123]
  ds_read_b64_tr_b16 a[34:35], v43 offset:23280
  ds_read_b64 a[52:53], v36
  v_mfma_f32_16x16x32_bf16 v[124:127], a[0:3], a[48:51], v[124:127]
  ds_read_b64_tr_b16 a[0:1], v43 offset:9216
  ds_read_b64_tr_b16 a[2:3], v43 offset:13824
  v_mfma_f32_16x16x32_bf16 v[128:131], a[4:7], a[36:39], v[128:131]
  ds_read_b64 a[54:55], v37
  ds_read_b64 a[56:57], v36 offset:2048
  v_mfma_f32_16x16x32_bf16 v[132:135], a[4:7], a[40:43], v[132:135]
  buffer_load_dwordx4 v2, s[32:35], s80 offen offset:1024 lds
  v_mfma_f32_16x16x32_bf16 v[136:139], a[4:7], a[44:47], v[136:139]
  ds_read_b64 a[58:59], v37 offset:2048
  ds_read_b64 a[60:61], v36 offset:4096
  v_mfma_f32_16x16x32_bf16 v[140:143], a[4:7], a[48:51], v[140:143]
  ds_read_b64 a[62:63], v37 offset:4096
  ds_read_b64 a[64:65], v36 offset:6144
  v_mfma_f32_16x16x32_bf16 v[144:147], a[8:11], a[36:39], v[144:147]
  ds_read_b64 a[66:67], v37 offset:6144
  ds_read_b64_tr_b16 a[4:5], v43 offset:27664
  v_mfma_f32_16x16x32_bf16 v[148:151], a[8:11], a[40:43], v[148:151]
  ds_read_b64_tr_b16 a[6:7], v43 offset:32272
  v_mfma_f32_16x16x32_bf16 v[152:155], a[8:11], a[44:47], v[152:155]
  v_mfma_f32_16x16x32_bf16 v[156:159], a[8:11], a[48:51], v[156:159]
  buffer_load_dwordx4 v3, s[32:35], s80 offen offset:2048 lds
  v_mfma_f32_16x16x32_bf16 v[160:163], a[12:15], a[36:39], v[160:163]
  ds_read_b64_tr_b16 a[8:9], v43 offset:9280
  ds_read_b64_tr_b16 a[10:11], v43 offset:13888
  v_mfma_f32_16x16x32_bf16 v[164:167], a[12:15], a[40:43], v[164:167]
  v_mfma_f32_16x16x32_bf16 v[168:171], a[12:15], a[44:47], v[168:171]
  v_mfma_f32_16x16x32_bf16 v[172:175], a[12:15], a[48:51], v[172:175]
  ds_read_b64_tr_b16 a[12:13], v43 offset:27728
  ds_read_b64_tr_b16 a[14:15], v43 offset:32336
  v_mfma_f32_16x16x32_bf16 v[176:179], a[16:19], a[36:39], v[176:179]
  buffer_load_dwordx4 v4, s[32:35], s80 offen offset:3072 lds
  v_mfma_f32_16x16x32_bf16 v[180:183], a[16:19], a[40:43], v[180:183]
  v_mfma_f32_16x16x32_bf16 v[184:187], a[16:19], a[44:47], v[184:187]
  v_mfma_f32_16x16x32_bf16 v[188:191], a[16:19], a[48:51], v[188:191]
  ds_read_b64_tr_b16 a[16:17], v43 offset:9344
  ds_read_b64_tr_b16 a[18:19], v43 offset:13952
  v_mfma_f32_16x16x32_bf16 v[192:195], a[20:23], a[36:39], v[192:195]
  v_mfma_f32_16x16x32_bf16 v[196:199], a[20:23], a[40:43], v[196:199]
  s_branch L_skip2B
.p2align 12
L_pad2B:
  s_setpc_b64 s[20:21]
L_skip2B:
  s_add_u32 m0, s84, 0
  v_mfma_f32_16x16x32_bf16 v[200:203], a[20:23], a[44:47], v[200:203]
  buffer_load_dwordx4 v7, s[36:39], s81 offen lds
  v_mfma_f32_16x16x32_bf16 v[204:207], a[20:23], a[48:51], v[204:207]
  ds_read_b64_tr_b16 a[20:21], v43 offset:27792
  ds_read_b64_tr_b16 a[22:23], v43 offset:32400
  s_waitcnt lgkmcnt(6)
  v_mfma_f32_16x16x32_bf16 v[208:211], a[24:27], a[36:39], v[208:211]
  v_mfma_f32_16x16x32_bf16 v[212:215], a[24:27], a[40:43], v[212:215]
  v_mfma_f32_16x16x32_bf16 v[216:219], a[24:27], a[44:47], v[216:219]
  v_mfma_f32_16x16x32_bf16 v[220:223], a[24:27], a[48:51], v[220:223]
  buffer_load_dwordx4 v16, s[36:39], s81 offen offset:1024 lds
  v_mfma_f32_16x16x32_bf16 v[224:227], a[28:31], a[36:39], v[224:227]
  ds_read_b64_tr_b16 a[24:25], v46 offset:9216
  ds_read_b64_tr_b16 a[26:27], v46 offset:13824
  v_mfma_f32_16x16x32_bf16 v[228:231], a[28:31], a[40:43], v[228:231]
  v_mfma_f32_16x16x32_bf16 v[232:235], a[28:31], a[44:47], v[232:235]
  v_mfma_f32_16x16x32_bf16 v[236:239], a[28:31], a[48:51], v[236:239]
  ds_read_b64_tr_b16 a[28:29], v43 offset:9440
  ds_read_b64_tr_b16 a[30:31], v43 offset:14048
  v_mfma_f32_16x16x32_bf16 v[240:243], a[32:35], a[36:39], v[240:243]
  v_mfma_f32_16x16x32_bf16 v[244:247], a[32:35], a[40:43], v[244:247]
  buffer_load_dwordx4 v17, s[36:39], s81 offen offset:2048 lds
  v_mfma_f32_16x16x32_bf16 v[248:251], a[32:35], a[44:47], v[248:251]
  v_mfma_f32_16x16x32_bf16 v[252:255], a[32:35], a[48:51], v[252:255]
  ds_read_b64_tr_b16 a[32:33], v43 offset:27888
  ds_read_b64_tr_b16 a[34:35], v43 offset:32496
  v_mfma_f32_16x16x32_bf16 v[112:115], a[0:3], a[52:55], v[112:115]
  v_mfma_f32_16x16x32_bf16 v[116:119], a[0:3], a[56:59], v[116:119]
  v_mfma_f32_16x16x32_bf16 v[120:123], a[0:3], a[60:63], v[120:123]
  buffer_load_dwordx4 v18, s[36:39], s81 offen offset:3072 lds
  v_mfma_f32_16x16x32_bf16 v[124:127], a[0:3], a[64:67], v[124:127]
  v_mfma_f32_16x16x32_bf16 v[128:131], a[4:7], a[52:55], v[128:131]
  v_mfma_f32_16x16x32_bf16 v[132:135], a[4:7], a[56:59], v[132:135]
  s_waitcnt vmcnt(8)
  s_waitcnt lgkmcnt(0)
  s_barrier
  ds_read_b64_tr_b16 a[0:1], v44
  v_mfma_f32_16x16x32_bf16 v[136:139], a[4:7], a[60:63], v[136:139]
  ds_read_b64_tr_b16 a[2:3], v44 offset:4608
  ds_read_b64 a[36:37], v38
  v_mfma_f32_16x16x32_bf16 v[140:143], a[4:7], a[64:67], v[140:143]
  s_add_u32 m0, s85, 0
  ds_read_b64 a[38:39], v39
  v_mfma_f32_16x16x32_bf16 v[144:147], a[8:11], a[52:55], v[144:147]
  buffer_load_dwordx4 v[52:55], v56, s[48:51], 0 offen sc0 sc1
  v_mfma_f32_16x16x32_bf16 v[148:151], a[8:11], a[56:59], v[148:151]
  buffer_load_dwordx4 v19, s[36:39], s81 offen lds
  v_mfma_f32_16x16x32_bf16 v[152:155], a[8:11], a[60:63], v[152:155]
  ds_read_b64 a[40:41], v38 offset:2048
  ds_read_b64 a[42:43], v39 offset:2048
  v_mfma_f32_16x16x32_bf16 v[156:159], a[8:11], a[64:67], v[156:159]
  ds_read_b64 a[44:45], v38 offset:4096
  ds_read_b64 a[46:47], v39 offset:4096
  v_mfma_f32_16x16x32_bf16 v[160:163], a[12:15], a[52:55], v[160:163]
  s_add_u32 m0, s84, 0x2400
  ds_read_b64 a[48:49], v38 offset:6144
  v_mfma_f32_16x16x32_bf16 v[164:167], a[12:15], a[56:59], v[164:167]
  buffer_load_dwordx4 v20, s[36:39], s81 offen lds
  v_mfma_f32_16x16x32_bf16 v[168:171], a[12:15], a[60:63], v[168:171]
  ds_read_b64 a[50:51], v39 offset:6144
  ds_read_b64_tr_b16 a[4:5], v44 offset:18448
  v_mfma_f32_16x16x32_bf16 v[172:175], a[12:15], a[64:67], v[172:175]
  ds_read_b64_tr_b16 a[6:7], v44 offset:23056
  ds_read_b64_tr_b16 a[8:9], v44 offset:64
  v_mfma_f32_16x16x32_bf16 v[176:179], a[16:19], a[52:55], v[176:179]
  ds_read_b64_tr_b16 a[10:11], v44 offset:4672
  ds_read_b64_tr_b16 a[12:13], v44 offset:18512
  v_mfma_f32_16x16x32_bf16 v[180:183], a[16:19], a[56:59], v[180:183]
  ds_read_b64_tr_b16 a[14:15], v44 offset:23120
  v_mfma_f32_16x16x32_bf16 v[184:187], a[16:19], a[60:63], v[184:187]
  v_mfma_f32_16x16x32_bf16 v[188:191], a[16:19], a[64:67], v[188:191]
  buffer_load_dwordx4 v21, s[36:39], s81 offen offset:1024 lds
  v_mfma_f32_16x16x32_bf16 v[192:195], a[20:23], a[52:55], v[192:195]
  ds_read_b64_tr_b16 a[16:17], v44 offset:128
  ds_read_b64_tr_b16 a[18:19], v44 offset:4736
  v_mfma_f32_16x16x32_bf16 v[196:199], a[20:23], a[56:59], v[196:199]
  s_mov_b64 exec, 0xffff
  buffer_load_dword v62, v61, s[60:63], s12 offen
  s_mov_b64 exec, -1
  v_mfma_f32_16x16x32_bf16 v[200:203], a[20:23], a[60:63], v[200:203]
  v_mfma_f32_16x16x32_bf16 v[204:207], a[20:23], a[64:67], v[204:207]
  ds_read_b64_tr_b16 a[20:21], v44 offset:18576
  ds_read_b64_tr_b16 a[22:23], v44 offset:23184
  v_mfma_f32_16x16x32_bf16 v[208:211], a[24:27], a[52:55], v[208:211]
  buffer_load_dwordx4 v22, s[36:39], s81 offen offset:2048 lds
  v_mfma_f32_16x16x32_bf16 v[212:215], a[24:27], a[56:59], v[212:215]
  v_mfma_f32_16x16x32_bf16 v[216:219], a[24:27], a[60:63], v[216:219]
  v_mfma_f32_16x16x32_bf16 v[220:223], a[24:27], a[64:67], v[220:223]
  ds_read_b64_tr_b16 a[24:25], v47
  ds_read_b64_tr_b16 a[26:27], v47 offset:4608
  v_mfma_f32_16x16x32_bf16 v[224:227], a[28:31], a[52:55], v[224:227]
  v_mfma_f32_16x16x32_bf16 v[228:231], a[28:31], a[56:59], v[228:231]
  v_mfma_f32_16x16x32_bf16 v[232:235], a[28:31], a[60:63], v[232:235]
  buffer_load_dwordx4 v23, s[36:39], s81 offen offset:3072 lds
  v_mfma_f32_16x16x32_bf16 v[236:239], a[28:31], a[64:67], v[236:239]
  ds_read_b64_tr_b16 a[28:29], v44 offset:224
  ds_read_b64_tr_b16 a[30:31], v44 offset:4832
  v_mfma_f32_16x16x32_bf16 v[240:243], a[32:35], a[52:55], v[240:243]
  v_mfma_f32_16x16x32_bf16 v[244:247], a[32:35], a[56:59], v[244:247]
  v_mfma_f32_16x16x32_bf16 v[248:251], a[32:35], a[60:63], v[248:251]
  s_add_u32 s31, s31, 1
  s_and_b32 s31, s31, 7
  v_mfma_f32_16x16x32_bf16 v[252:255], a[32:35], a[64:67], v[252:255]
  s_lshl_b32 s80, s31, 7
  s_mul_i32 s81, s31, 0x2b000
  s_waitcnt lgkmcnt(4)
  v_mfma_f32_16x16x32_bf16 v[112:115], a[0:3], a[36:39], v[112:115]
  s_add_u32 m0, s83, 0xd080
  ds_read_b64_tr_b16 a[32:33], v44 offset:18672
  v_mfma_f32_16x16x32_bf16 v[116:119], a[0:3], a[40:43], v[116:119]
  buffer_load_dwordx4 v1, s[32:35], s80 offen lds
  v_mfma_f32_16x16x32_bf16 v[120:123], a[0:3], a[44:47], v[120:123]
  ds_read_b64_tr_b16 a[34:35], v44 offset:23280
  ds_read_b64 a[52:53], v40
  v_mfma_f32_16x16x32_bf16 v[124:127], a[0:3], a[48:51], v[124:127]
  ds_read_b64_tr_b16 a[0:1], v44 offset:9216
  ds_read_b64_tr_b16 a[2:3], v44 offset:13824
  v_mfma_f32_16x16x32_bf16 v[128:131], a[4:7], a[36:39], v[128:131]
  ds_read_b64 a[54:55], v41
  ds_read_b64 a[56:57], v40 offset:2048
  v_mfma_f32_16x16x32_bf16 v[132:135], a[4:7], a[40:43], v[132:135]
  buffer_load_dwordx4 v2, s[32:35], s80 offen offset:1024 lds
  v_mfma_f32_16x16x32_bf16 v[136:139], a[4:7], a[44:47], v[136:139]
  ds_read_b64 a[58:59], v41 offset:2048
  ds_read_b64 a[60:61], v40 offset:4096
  v_mfma_f32_16x16x32_bf16 v[140:143], a[4:7], a[48:51], v[140:143]
  ds_read_b64 a[62:63], v41 offset:4096
  ds_read_b64 a[64:65], v40 offset:6144
  v_mfma_f32_16x16x32_bf16 v[144:147], a[8:11], a[36:39], v[144:147]
  ds_read_b64 a[66:67], v41 offset:6144
  ds_read_b64_tr_b16 a[4:5], v44 offset:27664
  v_mfma_f32_16x16x32_bf16 v[148:151], a[8:11], a[40:43], v[148:151]
  ds_read_b64_tr_b16 a[6:7], v44 offset:32272
  v_mfma_f32_16x16x32_bf16 v[152:155], a[8:11], a[44:47], v[152:155]
  v_mfma_f32_16x16x32_bf16 v[156:159], a[8:11], a[48:51], v[156:159]
  buffer_load_dwordx4 v3, s[32:35], s80 offen offset:2048 lds
  v_mfma_f32_16x16x32_bf16 v[160:163], a[12:15], a[36:39], v[160:163]
  ds_read_b64_tr_b16 a[8:9], v44 offset:9280
  ds_read_b64_tr_b16 a[10:11], v44 offset:13888
  v_mfma_f32_16x16x32_bf16 v[164:167], a[12:15], a[40:43], v[164:167]
  v_mfma_f32_16x16x32_bf16 v[168:171], a[12:15], a[44:47], v[168:171]
  v_mfma_f32_16x16x32_bf16 v[172:175], a[12:15], a[48:51], v[172:175]
  ds_read_b64_tr_b16 a[12:13], v44 offset:27728
  ds_read_b64_tr_b16 a[14:15], v44 offset:32336
  v_mfma_f32_16x16x32_bf16 v[176:179], a[16:19], a[36:39], v[176:179]
  buffer_load_dwordx4 v4, s[32:35], s80 offen offset:3072 lds
  v_mfma_f32_16x16x32_bf16 v[180:183], a[16:19], a[40:43], v[180:183]
  v_mfma_f32_16x16x32_bf16 v[184:187], a[16:19], a[44:47], v[184:187]
  v_mfma_f32_16x16x32_bf16 v[188:191], a[16:19], a[48:51], v[188:191]
  ds_read_b64_tr_b16 a[16:17], v44 offset:9344
  ds_read_b64_tr_b16 a[18:19], v44 offset:13952
  v_mfma_f32_16x16x32_bf16 v[192:195], a[20:23], a[36:39], v[192:195]
  v_mfma_f32_16x16x32_bf16 v[196:199], a[20:23], a[40:43], v[196:199]
  s_add_u32 m0, s84, 0xd080
  v_mfma_f32_16x16x32_bf16 v[200:203], a[20:23], a[44:47], v[200:203]
  buffer_load_dwordx4 v7, s[36:39], s81 offen lds
  v_mfma_f32_16x16x32_bf16 v[204:207], a[20:23], a[48:51], v[204:207]
  ds_read_b64_tr_b16 a[20:21], v44 offset:27792
  ds_read_b64_tr_b16 a[22:23], v44 offset:32400
  s_waitcnt lgkmcnt(6)
  v_mfma_f32_16x16x32_bf16 v[208:211], a[24:27], a[36:39], v[208:211]
  v_mfma_f32_16x16x32_bf16 v[212:215], a[24:27], a[40:43], v[212:215]
  v_mfma_f32_16x16x32_bf16 v[216:219], a[24:27], a[44:47], v[216:219]
  v_mfma_f32_16x16x32_bf16 v[220:223], a[24:27], a[48:51], v[220:223]
  buffer_load_dwordx4 v16, s[36:39], s81 offen offset:1024 lds
  v_mfma_f32_16x16x32_bf16 v[224:227], a[28:31], a[36:39], v[224:227]
  ds_read_b64_tr_b16 a[24:25], v47 offset:9216
  ds_read_b64_tr_b16 a[26:27], v47 offset:13824
  v_mfma_f32_16x16x32_bf16 v[228:231], a[28:31], a[40:43], v[228:231]
  v_mfma_f32_16x16x32_bf16 v[232:235], a[28:31], a[44:47], v[232:235]
  v_mfma_f32_16x16x32_bf16 v[236:239], a[28:31], a[48:51], v[236:239]
  ds_read_b64_tr_b16 a[28:29], v44 offset:9440
  ds_read_b64_tr_b16 a[30:31], v44 offset:14048
  v_mfma_f32_16x16x32_bf16 v[240:243], a[32:35], a[36:39], v[240:243]
  v_mfma_f32_16x16x32_bf16 v[244:247], a[32:35], a[40:43], v[244:247]
  buffer_load_dwordx4 v17, s[36:39], s81 offen offset:2048 lds
  v_mfma_f32_16x16x32_bf16 v[248:251], a[32:35], a[44:47], v[248:251]
  v_mfma_f32_16x16x32_bf16 v[252:255], a[32:35], a[48:51], v[252:255]
  ds_read_b64_tr_b16 a[32:33], v44 offset:27888
  ds_read_b64_tr_b16 a[34:35], v44 offset:32496
  v_mfma_f32_16x16x32_bf16 v[112:115], a[0:3], a[52:55], v[112:115]
  s_waitcnt vmcnt(13)
  v_xor_b32 v52, s29, v52
  v_xor_b32 v53, s29, v53
  v_xor_b32 v54, s29, v54
  v_xor_b32 v55, s29, v55
  v_or_b32 v52, v52, v53
  v_or3_b32 v52, v52, v54, v55
  v_cmp_ne_u32 vcc, 0, v52
  s_nop 4
  s_cbranch_vccz L_B_poll1_ok
  s_mov_b32 s0, 0
L_B_poll1_spin:
  buffer_load_dwordx4 v[52:55], v56, s[48:51], 0 offen sc0 sc1
  s_add_u32 s0, s0, 1
  s_waitcnt vmcnt(0)
  s_waitcnt vmcnt(0)
  v_xor_b32 v52, s29, v52
  v_xor_b32 v53, s29, v53
  v_xor_b32 v54, s29, v54
  v_xor_b32 v55, s29, v55
  v_or_b32 v52, v52, v53
  v_or3_b32 v52, v52, v54, v55
  v_cmp_ne_u32 vcc, 0, v52
  s_cmp_ge_u32 s0, 0x8000
  s_cbranch_scc1 L_B_poll1_ok
  s_nop 2
  s_cbranch_vccnz L_B_poll1_spin
L_B_poll1_ok:
  v_mfma_f32_16x16x32_bf16 v[116:119], a[0:3], a[56:59], v[116:119]
  buffer_load_dwordx4 v[68:71], v51, s[48:51], 0 offen sc1
  v_mfma_f32_16x16x32_bf16 v[120:123], a[0:3], a[60:63], v[120:123]
  buffer_load_dwordx4 v18, s[36:39], s81 offen offset:3072 lds
  v_mfma_f32_16x16x32_bf16 v[124:127], a[0:3], a[64:67], v[124:127]
  buffer_load_dwordx4 v[72:75], v51, s[48:51], 0 offen offset:256 sc1
  v_mfma_f32_16x16x32_bf16 v[128:131], a[4:7], a[52:55], v[128:131]
  v_mfma_f32_16x16x32_bf16 v[132:135], a[4:7], a[56:59], v[132:135]
  s_waitcnt vmcnt(10)
  s_waitcnt lgkmcnt(0)
  s_barrier
  ds_read_b64_tr_b16 a[0:1], v42
  v_mfma_f32_16x16x32_bf16 v[136:139], a[4:7], a[60:63], v[136:139]
  ds_read_b64_tr_b16 a[2:3], v42 offset:4608
  ds_read_b64 a[36:37], v30
  v_mfma_f32_16x16x32_bf16 v[140:143], a[4:7], a[64:67], v[140:143]
  s_add_u32 m0, s85, 0xd080
  ds_read_b64 a[38:39], v31
  v_mfma_f32_16x16x32_bf16 v[144:147], a[8:11], a[52:55], v[144:147]
  buffer_load_dwordx4 v19, s[36:39], s81 offen lds
  v_mfma_f32_16x16x32_bf16 v[148:151], a[8:11], a[56:59], v[148:151]
  ds_read_b64 a[40:41], v30 offset:2048
  ds_read_b64 a[42:43], v31 offset:2048
  v_mfma_f32_16x16x32_bf16 v[152:155], a[8:11], a[60:63], v[152:155]
  ds_read_b64 a[44:45], v30 offset:4096
  ds_read_b64 a[46:47], v31 offset:4096
  v_mfma_f32_16x16x32_bf16 v[156:159], a[8:11], a[64:67], v[156:159]
  ds_read_b64 a[48:49], v30 offset:6144
  ds_read_b64 a[50:51], v31 offset:6144
  v_mfma_f32_16x16x32_bf16 v[160:163], a[12:15], a[52:55], v[160:163]
  s_add_u32 m0, s84, 0xf480
  ds_read_b64_tr_b16 a[4:5], v42 offset:18448
  v_mfma_f32_16x16x32_bf16 v[164:167], a[12:15], a[56:59], v[164:167]
  buffer_load_dwordx4 v20, s[36:39], s81 offen lds
  v_mfma_f32_16x16x32_bf16 v[168:171], a[12:15], a[60:63], v[168:171]
  ds_read_b64_tr_b16 a[6:7], v42 offset:23056
  ds_read_b64_tr_b16 a[8:9], v42 offset:64
  v_mfma_f32_16x16x32_bf16 v[172:175], a[12:15], a[64:67], v[172:175]
  ds_read_b64_tr_b16 a[10:11], v42 offset:4672
  ds_read_b64_tr_b16 a[12:13], v42 offset:18512
  v_mfma_f32_16x16x32_bf16 v[176:179], a[16:19], a[52:55], v[176:179]
  ds_read_b64_tr_b16 a[14:15], v42 offset:23120
  v_mfma_f32_16x16x32_bf16 v[180:183], a[16:19], a[56:59], v[180:183]
  v_mfma_f32_16x16x32_bf16 v[184:187], a[16:19], a[60:63], v[184:187]
  v_mfma_f32_16x16x32_bf16 v[188:191], a[16:19], a[64:67], v[188:191]
  buffer_load_dwordx4 v21, s[36:39], s81 offen offset:1024 lds
  v_mfma_f32_16x16x32_bf16 v[192:195], a[20:23], a[52:55], v[192:195]
  ds_read_b64_tr_b16 a[16:17], v42 offset:128
  ds_read_b64_tr_b16 a[18:19], v42 offset:4736
  v_mfma_f32_16x16x32_bf16 v[196:199], a[20:23], a[56:59], v[196:199]
  s_add_u32 s90, s12, 0x10000
  s_mov_b64 exec, 0xfffff
  buffer_load_dword v62, v61, s[60:63], s90 offen
  s_mov_b64 exec, -1
  v_mfma_f32_16x16x32_bf16 v[200:203], a[20:23], a[60:63], v[200:203]
  v_mfma_f32_16x16x32_bf16 v[204:207], a[20:23], a[64:67], v[204:207]
  ds_read_b64_tr_b16 a[20:21], v42 offset:18576
  ds_read_b64_tr_b16 a[22:23], v42 offset:23184
  v_mfma_f32_16x16x32_bf16 v[208:211], a[24:27], a[52:55], v[208:211]
  buffer_load_dwordx4 v22, s[36:39], s81 offen offset:2048 lds
  v_mfma_f32_16x16x32_bf16 v[212:215], a[24:27], a[56:59], v[212:215]
  v_mfma_f32_16x16x32_bf16 v[216:219], a[24:27], a[60:63], v[216:219]
  v_mfma_f32_16x16x32_bf16 v[220:223], a[24:27], a[64:67], v[220:223]
  ds_read_b64_tr_b16 a[24:25], v45
  ds_read_b64_tr_b16 a[26:27], v45 offset:4608
  v_mfma_f32_16x16x32_bf16 v[224:227], a[28:31], a[52:55], v[224:227]
  v_mfma_f32_16x16x32_bf16 v[228:231], a[28:31], a[56:59], v[228:231]
  v_mfma_f32_16x16x32_bf16 v[232:235], a[28:31], a[60:63], v[232:235]
  buffer_load_dwordx4 v23, s[36:39], s81 offen offset:3072 lds
  v_mfma_f32_16x16x32_bf16 v[236:239], a[28:31], a[64:67], v[236:239]
  ds_read_b64_tr_b16 a[28:29], v42 offset:224
  ds_read_b64_tr_b16 a[30:31], v42 offset:4832
  v_mfma_f32_16x16x32_bf16 v[240:243], a[32:35], a[52:55], v[240:243]
  v_mfma_f32_16x16x32_bf16 v[244:247], a[32:35], a[56:59], v[244:247]
  v_mfma_f32_16x16x32_bf16 v[248:251], a[32:35], a[60:63], v[248:251]
  v_mfma_f32_16x16x32_bf16 v[252:255], a[32:35], a[64:67], v[252:255]
  s_add_u32 m0, s84, 0x1a100
  ds_read_b64_tr_b16 a[32:33], v42 offset:18672
  s_waitcnt lgkmcnt(5)
  v_mfma_f32_16x16x32_bf16 v[112:115], a[0:3], a[36:39], v[112:115]
  buffer_load_dwordx4 v7, s[68:71], 0 offen sc1 lds
  v_mfma_f32_16x16x32_bf16 v[116:119], a[0:3], a[40:43], v[116:119]
  ds_read_b64_tr_b16 a[34:35], v42 offset:23280
  ds_read_b64 a[52:53], v32
  v_mfma_f32_16x16x32_bf16 v[120:123], a[0:3], a[44:47], v[120:123]
  ds_read_b64 a[54:55], v33
  ds_read_b64 a[56:57], v32 offset:2048
  v_mfma_f32_16x16x32_bf16 v[124:127], a[0:3], a[48:51], v[124:127]
  ds_read_b64_tr_b16 a[0:1], v42 offset:9216
  ds_read_b64_tr_b16 a[2:3], v42 offset:13824
  v_mfma_f32_16x16x32_bf16 v[128:131], a[4:7], a[36:39], v[128:131]
  ds_read_b64 a[58:59], v33 offset:2048
  ds_read_b64 a[60:61], v32 offset:4096
  v_mfma_f32_16x16x32_bf16 v[132:135], a[4:7], a[40:43], v[132:135]
  buffer_load_dwordx4 v16, s[68:71], 0 offen offset:1024 sc1 lds
  v_mfma_f32_16x16x32_bf16 v[136:139], a[4:7], a[44:47], v[136:139]
  ds_read_b64 a[62:63], v33 offset:4096
  ds_read_b64 a[64:65], v32 offset:6144
  v_mfma_f32_16x16x32_bf16 v[140:143], a[4:7], a[48:51], v[140:143]
  ds_read_b64 a[66:67], v33 offset:6144
  ds_read_b64_tr_b16 a[4:5], v42 offset:27664
  v_mfma_f32_16x16x32_bf16 v[144:147], a[8:11], a[36:39], v[144:147]
  ds_read_b64_tr_b16 a[6:7], v42 offset:32272
  v_mfma_f32_16x16x32_bf16 v[148:151], a[8:11], a[40:43], v[148:151]
  v_mfma_f32_16x16x32_bf16 v[152:155], a[8:11], a[44:47], v[152:155]
  v_mfma_f32_16x16x32_bf16 v[156:159], a[8:11], a[48:51], v[156:159]
  buffer_load_dwordx4 v17, s[68:71], 0 offen offset:2048 sc1 lds
  v_mfma_f32_16x16x32_bf16 v[160:163], a[12:15], a[36:39], v[160:163]
  ds_read_b64_tr_b16 a[8:9], v42 offset:9280
  ds_read_b64_tr_b16 a[10:11], v42 offset:13888
  v_mfma_f32_16x16x32_bf16 v[164:167], a[12:15], a[40:43], v[164:167]
  v_mfma_f32_16x16x32_bf16 v[168:171], a[12:15], a[44:47], v[168:171]
  v_mfma_f32_16x16x32_bf16 v[172:175], a[12:15], a[48:51], v[172:175]
  ds_read_b64_tr_b16 a[12:13], v42 offset:27728
  ds_read_b64_tr_b16 a[14:15], v42 offset:32336
  v_mfma_f32_16x16x32_bf16 v[176:179], a[16:19], a[36:39], v[176:179]
  buffer_load_dwordx4 v18, s[68:71], 0 offen offset:3072 sc1 lds
  v_mfma_f32_16x16x32_bf16 v[180:183], a[16:19], a[40:43], v[180:183]
  v_mfma_f32_16x16x32_bf16 v[184:187], a[16:19], a[44:47], v[184:187]
  v_mfma_f32_16x16x32_bf16 v[188:191], a[16:19], a[48:51], v[188:191]
  ds_read_b64_tr_b16 a[16:17], v42 offset:9344
  ds_read_b64_tr_b16 a[18:19], v42 offset:13952
  v_mfma_f32_16x16x32_bf16 v[192:195], a[20:23], a[36:39], v[192:195]
  v_mfma_f32_16x16x32_bf16 v[196:199], a[20:23], a[40:43], v[196:199]
  s_add_u32 m0, s85, 0x1a100
  v_mfma_f32_16x16x32_bf16 v[200:203], a[20:23], a[44:47], v[200:203]
  s_mov_b64 exec, 0xffff
  buffer_load_dword v62, v61, s[56:59], s13 offen
  s_mov_b64 exec, -1
  v_mfma_f32_16x16x32_bf16 v[204:207], a[20:23], a[48:51], v[204:207]
  buffer_load_dwordx4 v19, s[68:71], 0 offen sc1 lds
  s_waitcnt lgkmcnt(4)
  v_mfma_f32_16x16x32_bf16 v[208:211], a[24:27], a[36:39], v[208:211]
  ds_read_b64_tr_b16 a[20:21], v42 offset:27792
  ds_read_b64_tr_b16 a[22:23], v42 offset:32400
  v_mfma_f32_16x16x32_bf16 v[212:215], a[24:27], a[40:43], v[212:215]
  v_mfma_f32_16x16x32_bf16 v[216:219], a[24:27], a[44:47], v[216:219]
  v_mfma_f32_16x16x32_bf16 v[220:223], a[24:27], a[48:51], v[220:223]
  ds_read_b64_tr_b16 a[24:25], v45 offset:9216
  ds_read_b64_tr_b16 a[26:27], v45 offset:13824
  v_mfma_f32_16x16x32_bf16 v[224:227], a[28:31], a[36:39], v[224:227]
  v_mfma_f32_16x16x32_bf16 v[228:231], a[28:31], a[40:43], v[228:231]
  v_mfma_f32_16x16x32_bf16 v[232:235], a[28:31], a[44:47], v[232:235]
  v_mfma_f32_16x16x32_bf16 v[236:239], a[28:31], a[48:51], v[236:239]
  ds_read_b64_tr_b16 a[28:29], v42 offset:9440
  ds_read_b64_tr_b16 a[30:31], v42 offset:14048
  v_mfma_f32_16x16x32_bf16 v[240:243], a[32:35], a[36:39], v[240:243]
  v_mfma_f32_16x16x32_bf16 v[244:247], a[32:35], a[40:43], v[244:247]
  v_mfma_f32_16x16x32_bf16 v[248:251], a[32:35], a[44:47], v[248:251]
  v_mfma_f32_16x16x32_bf16 v[252:255], a[32:35], a[48:51], v[252:255]
  ds_read_b64_tr_b16 a[32:33], v42 offset:27888
  ds_read_b64_tr_b16 a[34:35], v42 offset:32496
  v_mfma_f32_16x16x32_bf16 v[112:115], a[0:3], a[52:55], v[112:115]
  v_mfma_f32_16x16x32_bf16 v[116:119], a[0:3], a[56:59], v[116:119]
  v_mfma_f32_16x16x32_bf16 v[120:123], a[0:3], a[60:63], v[120:123]
  v_mfma_f32_16x16x32_bf16 v[124:127], a[0:3], a[64:67], v[124:127]
  v_mfma_f32_16x16x32_bf16 v[128:131], a[4:7], a[52:55], v[128:131]
  s_waitcnt vmcnt(14)
  v_mov_b32 v76, v68
  v_mov_b32 v77, v68
  v_mfma_f32_16x16x32_bf16 v[132:135], a[4:7], a[56:59], v[132:135]
  s_waitcnt vmcnt(6)
  s_waitcnt lgkmcnt(0)
  s_barrier
  ds_read_b64_tr_b16 a[0:1], v43
  v_mfma_f32_16x16x32_bf16 v[136:139], a[4:7], a[60:63], v[136:139]
  ds_read_b64_tr_b16 a[2:3], v43 offset:4608
  ds_read_b64 a[36:37], v34
  v_mfma_f32_16x16x32_bf16 v[140:143], a[4:7], a[64:67], v[140:143]
  s_add_u32 s1, s6, 0
  ds_read_b64 a[38:39], v35
  v_mfma_f32_16x16x32_bf16 v[144:147], a[8:11], a[52:55], v[144:147]
  s_add_u32 m0, s3, 0
  ds_read_b64 a[40:41], v34 offset:2048
  v_mfma_f32_16x16x32_bf16 v[148:151], a[8:11], a[56:59], v[148:151]
  buffer_load_dwordx4 v24, s[60:63], s1 offen lds
  v_mfma_f32_16x16x32_bf16 v[152:155], a[8:11], a[60:63], v[152:155]
  ds_read_b64 a[42:43], v35 offset:2048
  ds_read_b64 a[44:45], v34 offset:4096
  v_mfma_f32_16x16x32_bf16 v[156:159], a[8:11], a[64:67], v[156:159]
  ds_read_b64 a[46:47], v35 offset:4096
  ds_read_b64 a[48:49], v34 offset:6144
  v_mfma_f32_16x16x32_bf16 v[160:163], a[12:15], a[52:55], v[160:163]
  ds_read_b64 a[50:51], v35 offset:6144
  ds_read_b64_tr_b16 a[4:5], v43 offset:18448
  v_mfma_f32_16x16x32_bf16 v[164:167], a[12:15], a[56:59], v[164:167]
  buffer_load_dwordx4 v25, s[60:63], s1 offen offset:1024 lds
  v_mfma_f32_16x16x32_bf16 v[168:171], a[12:15], a[60:63], v[168:171]
  ds_read_b64_tr_b16 a[6:7], v43 offset:23056
  ds_read_b64_tr_b16 a[8:9], v43 offset:64
  v_mfma_f32_16x16x32_bf16 v[172:175], a[12:15], a[64:67], v[172:175]
  s_add_u32 s1, s6, 0x3800
  ds_read_b64_tr_b16 a[10:11], v43 offset:4672
  v_mfma_f32_16x16x32_bf16 v[176:179], a[16:19], a[52:55], v[176:179]
  ds_read_b64_tr_b16 a[12:13], v43 offset:18512
  ds_read_b64_tr_b16 a[14:15], v43 offset:23120
  v_mfma_f32_16x16x32_bf16 v[180:183], a[16:19], a[56:59], v[180:183]
  buffer_load_dwordx4 v24, s[60:63], s1 offen offset:2048 lds
  v_mfma_f32_16x16x32_bf16 v[184:187], a[16:19], a[60:63], v[184:187]
  v_mov_b32 v78, v68
  v_mov_b32 v79, v68
  v_mfma_f32_16x16x32_bf16 v[188:191], a[16:19], a[64:67], v[188:191]
  ds_read_b64_tr_b16 a[16:17], v43 offset:128
  ds_read_b64_tr_b16 a[18:19], v43 offset:4736
  v_mfma_f32_16x16x32_bf16 v[192:195], a[20:23], a[52:55], v[192:195]
  v_mov_b32 v80, v70
  v_mov_b32 v81, v70
  v_mfma_f32_16x16x32_bf16 v[196:199], a[20:23], a[56:59], v[196:199]
  buffer_load_dwordx4 v25, s[60:63], s1 offen offset:3072 lds
  v_mfma_f32_16x16x32_bf16 v[200:203], a[20:23], a[60:63], v[200:203]
  s_add_u32 s90, s13, 0x10000
  s_mov_b64 exec, 0xffff
  buffer_load_dword v62, v61, s[56:59], s90 offen
  s_mov_b64 exec, -1
  v_mfma_f32_16x16x32_bf16 v[204:207], a[20:23], a[64:67], v[204:207]
  ds_read_b64_tr_b16 a[20:21], v43 offset:18576
  ds_read_b64_tr_b16 a[22:23], v43 offset:23184
  v_mfma_f32_16x16x32_bf16 v[208:211], a[24:27], a[52:55], v[208:211]
  s_add_u32 s1, s6, 0x8000
  v_mov_b32 v82, v70
  v_mfma_f32_16x16x32_bf16 v[212:215], a[24:27], a[56:59], v[212:215]
  s_add_u32 m0, s3, 0x1000
  v_mov_b32 v83, v70
  v_mfma_f32_16x16x32_bf16 v[216:219], a[24:27], a[60:63], v[216:219]
  buffer_load_dwordx4 v24, s[60:63], s1 offen lds
  v_mfma_f32_16x16x32_bf16 v[220:223], a[24:27], a[64:67], v[220:223]
  ds_read_b64_tr_b16 a[24:25], v46
  ds_read_b64_tr_b16 a[26:27], v46 offset:4608
  v_mfma_f32_16x16x32_bf16 v[224:227], a[28:31], a[52:55], v[224:227]
  v_mov_b32 v84, v72
  v_mov_b32 v85, v72
  v_mfma_f32_16x16x32_bf16 v[228:231], a[28:31], a[56:59], v[228:231]
  v_mov_b32 v86, v72
  v_mov_b32 v87, v72
  v_mfma_f32_16x16x32_bf16 v[232:235], a[28:31], a[60:63], v[232:235]
  buffer_load_dwordx4 v25, s[60:63], s1 offen offset:1024 lds
  v_mfma_f32_16x16x32_bf16 v[236:239], a[28:31], a[64:67], v[236:239]
  ds_read_b64_tr_b16 a[28:29], v43 offset:224
  ds_read_b64_tr_b16 a[30:31], v43 offset:4832
  v_mfma_f32_16x16x32_bf16 v[240:243], a[32:35], a[52:55], v[240:243]
  s_add_u32 s1, s6, 0xb800
  v_mov_b32 v88, v74
  v_mfma_f32_16x16x32_bf16 v[244:247], a[32:35], a[56:59], v[244:247]
  v_mov_b32 v89, v74
  v_mov_b32 v90, v74
  v_mfma_f32_16x16x32_bf16 v[248:251], a[32:35], a[60:63], v[248:251]
  buffer_load_dwordx4 v24, s[60:63], s1 offen offset:2048 lds
  v_mfma_f32_16x16x32_bf16 v[252:255], a[32:35], a[64:67], v[252:255]
  ds_read_b64_tr_b16 a[32:33], v43 offset:18672
  ds_read_b64_tr_b16 a[34:35], v43 offset:23280
  s_waitcnt lgkmcnt(6)
  v_mfma_f32_16x16x32_bf16 v[112:115], a[0:3], a[36:39], v[112:115]
  ds_read_b64 a[52:53], v36
  ds_read_b64 a[54:55], v37
  v_mfma_f32_16x16x32_bf16 v[116:119], a[0:3], a[40:43], v[116:119]
  ds_read_b64 a[56:57], v36 offset:2048
  ds_read_b64 a[58:59], v37 offset:2048
  v_mfma_f32_16x16x32_bf16 v[120:123], a[0:3], a[44:47], v[120:123]
  ds_read_b64 a[60:61], v36 offset:4096
  ds_read_b64 a[62:63], v37 offset:4096
  v_mfma_f32_16x16x32_bf16 v[124:127], a[0:3], a[48:51], v[124:127]
  buffer_load_dwordx4 v25, s[60:63], s1 offen offset:3072 lds
  v_mfma_f32_16x16x32_bf16 v[128:131], a[4:7], a[36:39], v[128:131]
  ds_read_b64_tr_b16 a[0:1], v43 offset:9216
  ds_read_b64_tr_b16 a[2:3], v43 offset:13824
  v_mfma_f32_16x16x32_bf16 v[132:135], a[4:7], a[40:43], v[132:135]
  s_add_u32 s1, s7, 0
  ds_read_b64 a[64:65], v36 offset:6144
  v_mfma_f32_16x16x32_bf16 v[136:139], a[4:7], a[44:47], v[136:139]
  s_add_u32 m0, s3, 0x2000
  ds_read_b64 a[66:67], v37 offset:6144
  v_mfma_f32_16x16x32_bf16 v[140:143], a[4:7], a[48:51], v[140:143]
  buffer_load_dwordx4 v24, s[60:63], s1 offen lds
  v_mfma_f32_16x16x32_bf16 v[144:147], a[8:11], a[36:39], v[144:147]
  ds_read_b64_tr_b16 a[4:5], v43 offset:27664
  ds_read_b64_tr_b16 a[6:7], v43 offset:32272
  v_mfma_f32_16x16x32_bf16 v[148:151], a[8:11], a[40:43], v[148:151]
  v_mov_b32 v91, v74
  v_rsq_f32 v2, v69
  v_mfma_f32_16x16x32_bf16 v[152:155], a[8:11], a[44:47], v[152:155]
  v_mul_f32 v3, v2, v2
  v_mul_f32 v3, v3, v2
  v_mfma_f32_16x16x32_bf16 v[156:159], a[8:11], a[48:51], v[156:159]
  buffer_load_dwordx4 v25, s[60:63], s1 offen offset:1024 lds
  v_mfma_f32_16x16x32_bf16 v[160:163], a[12:15], a[36:39], v[160:163]
  ds_read_b64_tr_b16 a[8:9], v43 offset:9280
  ds_read_b64_tr_b16 a[10:11], v43 offset:13888
  v_mfma_f32_16x16x32_bf16 v[164:167], a[12:15], a[40:43], v[164:167]
  v_mul_f32 v2, 0xc0135761, v2
  v_mul_f32 v3, 0xbdd2d3e8, v3
  v_mfma_f32_16x16x32_bf16 v[168:171], a[12:15], a[44:47], v[168:171]
  s_add_u32 s1, s7, 0x3800
  v_rsq_f32 v4, v71
  v_mfma_f32_16x16x32_bf16 v[172:175], a[12:15], a[48:51], v[172:175]
  ds_read_b64_tr_b16 a[12:13], v43 offset:27728
  ds_read_b64_tr_b16 a[14:15], v43 offset:32336
  v_mfma_f32_16x16x32_bf16 v[176:179], a[16:19], a[36:39], v[176:179]
  buffer_load_dwordx4 v24, s[60:63], s1 offen offset:2048 lds
  v_mfma_f32_16x16x32_bf16 v[180:183], a[16:19], a[40:43], v[180:183]
  v_mul_f32 v5, v4, v4
  v_mul_f32 v5, v5, v4
  v_mfma_f32_16x16x32_bf16 v[184:187], a[16:19], a[44:47], v[184:187]
  v_mul_f32 v4, 0xc0135761, v4
  v_mul_f32 v5, 0xbdd2d3e8, v5
  v_mfma_f32_16x16x32_bf16 v[188:191], a[16:19], a[48:51], v[188:191]
  ds_read_b64_tr_b16 a[16:17], v43 offset:9344
  ds_read_b64_tr_b16 a[18:19], v43 offset:13952
  v_mfma_f32_16x16x32_bf16 v[192:195], a[20:23], a[36:39], v[192:195]
  buffer_load_dwordx4 v25, s[60:63], s1 offen offset:3072 lds
  v_mfma_f32_16x16x32_bf16 v[196:199], a[20:23], a[40:43], v[196:199]
  v_rsq_f32 v8, v73
  s_nop 0
  v_mul_f32 v9, v8, v8
  v_mfma_f32_16x16x32_bf16 v[200:203], a[20:23], a[44:47], v[200:203]
  v_mul_f32 v9, v9, v8
  v_mul_f32 v8, 0xc0135761, v8
  v_mfma_f32_16x16x32_bf16 v[204:207], a[20:23], a[48:51], v[204:207]
  ds_read_b64_tr_b16 a[20:21], v43 offset:27792
  ds_read_b64_tr_b16 a[22:23], v43 offset:32400
  s_waitcnt lgkmcnt(6)
  v_mfma_f32_16x16x32_bf16 v[208:211], a[24:27], a[36:39], v[208:211]
  v_mul_f32 v9, 0xbdd2d3e8, v9
  v_rsq_f32 v10, v75
  v_mfma_f32_16x16x32_bf16 v[212:215], a[24:27], a[40:43], v[212:215]
  v_mul_f32 v11, v10, v10
  v_mul_f32 v11, v11, v10
  v_mfma_f32_16x16x32_bf16 v[216:219], a[24:27], a[44:47], v[216:219]
  v_mul_f32 v10, 0xc0135761, v10
  v_mul_f32 v11, 0xbdd2d3e8, v11
  v_mfma_f32_16x16x32_bf16 v[220:223], a[24:27], a[48:51], v[220:223]
  ds_read_b64_tr_b16 a[24:25], v46 offset:9216
  ds_read_b64_tr_b16 a[26:27], v46 offset:13824
  v_mfma_f32_16x16x32_bf16 v[224:227], a[28:31], a[36:39], v[224:227]
  v_cmp_gt_u32 vcc, 32, v0
  s_nop 1
  v_cndmask_b32 v12, v71, v69, vcc
  v_mfma_f32_16x16x32_bf16 v[228:231], a[28:31], a[40:43], v[228:231]
  v_cmp_gt_u32 vcc, 32, v0
  s_nop 1
  v_cndmask_b32 v14, v75, v73, vcc
  v_mfma_f32_16x16x32_bf16 v[232:235], a[28:31], a[44:47], v[232:235]
  v_lshlrev_b32 v1, 4, v0
  v_lshrrev_b32 v6, 5, v0
  v_mfma_f32_16x16x32_bf16 v[236:239], a[28:31], a[48:51], v[236:239]
  ds_read_b64_tr_b16 a[28:29], v43 offset:9440
  ds_read_b64_tr_b16 a[30:31], v43 offset:14048
  v_mfma_f32_16x16x32_bf16 v[240:243], a[32:35], a[36:39], v[240:243]
  s_branch L_skip3B
.p2align 12
L_pad3B:
  s_setpc_b64 s[20:21]
L_skip3B:
  v_lshlrev_b32 v6, 4, v6
  v_and_b32 v26, 15, v0
  v_mfma_f32_16x16x32_bf16 v[244:247], a[32:35], a[40:43], v[244:247]
  v_add_u32 v6, v6, v26
  v_lshlrev_b32 v6, 4, v6
  v_mfma_f32_16x16x32_bf16 v[248:251], a[32:35], a[44:47], v[248:251]
  v_bfe_u32 v26, v0, 4, 1
  v_lshl_add_u32 v6, v26, 3, v6
  v_mfma_f32_16x16x32_bf16 v[252:255], a[32:35], a[48:51], v[252:255]
  ds_read_b64_tr_b16 a[32:33], v43 offset:27888
  ds_read_b64_tr_b16 a[34:35], v43 offset:32496
  v_mfma_f32_16x16x32_bf16 v[112:115], a[0:3], a[52:55], v[112:115]
  s_lshr_b32 s88, s26, 1
  s_lshl_b32 s86, s88, 9
  v_mfma_f32_16x16x32_bf16 v[116:119], a[0:3], a[56:59], v[116:119]
  v_add_u32 v6, s86, v6
  s_and_b32 s86, s26, 1
  v_mfma_f32_16x16x32_bf16 v[120:123], a[0:3], a[60:63], v[120:123]
  s_lshl1_add_u32 s86, s24, s86
  s_mul_i32 s86, s86, 0x3c000
  v_mfma_f32_16x16x32_bf16 v[124:127], a[0:3], a[64:67], v[124:127]
  s_lshr_b32 s87, s25, 1
  s_mul_i32 s87, s87, 0xf000
  v_mfma_f32_16x16x32_bf16 v[128:131], a[4:7], a[52:55], v[128:131]
  s_add_u32 s86, s86, s87
  s_and_b32 s87, s25, 1
  v_mfma_f32_16x16x32_bf16 v[132:135], a[4:7], a[56:59], v[132:135]
  s_waitcnt vmcnt(13)
  s_waitcnt lgkmcnt(0)
  s_barrier
  ds_read_b64_tr_b16 a[0:1], v44
  v_mfma_f32_16x16x32_bf16 v[136:139], a[4:7], a[60:63], v[136:139]
  s_add_u32 s1, s7, 0x8000
  ds_read_b64_tr_b16 a[2:3], v44 offset:4608
  v_mfma_f32_16x16x32_bf16 v[140:143], a[4:7], a[64:67], v[140:143]
  s_add_u32 m0, s3, 0xd080
  ds_read_b64_tr_b16 a[4:5], v44 offset:18448
  v_mfma_f32_16x16x32_bf16 v[144:147], a[8:11], a[52:55], v[144:147]
  buffer_load_dwordx4 v24, s[60:63], s1 offen lds
  v_mfma_f32_16x16x32_bf16 v[148:151], a[8:11], a[56:59], v[148:151]
  ds_read_b64_tr_b16 a[6:7], v44 offset:23056
  s_mul_i32 s89, s87, 6
  v_mfma_f32_16x16x32_bf16 v[152:155], a[8:11], a[60:63], v[152:155]
  s_add_u32 s89, s89, s88
  s_add_u32 s89, s89, 4
  v_mfma_f32_16x16x32_bf16 v[156:159], a[8:11], a[64:67], v[156:159]
  ds_read_b64_tr_b16 a[8:9], v44 offset:64
  ds_read_b64_tr_b16 a[10:11], v44 offset:4672
  v_mfma_f32_16x16x32_bf16 v[160:163], a[12:15], a[52:55], v[160:163]
  buffer_load_dwordx4 v25, s[60:63], s1 offen offset:1024 lds
  v_mfma_f32_16x16x32_bf16 v[164:167], a[12:15], a[56:59], v[164:167]
  s_lshl_b32 s89, s89, 11
  s_add_u32 s10, s86, s89
  v_mfma_f32_16x16x32_bf16 v[168:171], a[12:15], a[60:63], v[168:171]
  s_add_u32 s1, s7, 0xb800
  s_mul_i32 s89, s87, 0x1800
  v_mfma_f32_16x16x32_bf16 v[172:175], a[12:15], a[64:67], v[172:175]
  ds_read_b64_tr_b16 a[12:13], v44 offset:18512
  ds_read_b64_tr_b16 a[14:15], v44 offset:23120
  v_mfma_f32_16x16x32_bf16 v[176:179], a[16:19], a[52:55], v[176:179]
  buffer_load_dwordx4 v24, s[60:63], s1 offen offset:2048 lds
  v_mfma_f32_16x16x32_bf16 v[180:183], a[16:19], a[56:59], v[180:183]
  s_add_u32 s11, s86, s89
  s_add_u32 s11, s11, 0xc000
  v_mfma_f32_16x16x32_bf16 v[184:187], a[16:19], a[60:63], v[184:187]
  s_lshl_b32 s88, s88, 11
  s_add_u32 s88, s88, 0x800
  v_mfma_f32_16x16x32_bf16 v[188:191], a[16:19], a[64:67], v[188:191]
  ds_read_b64_tr_b16 a[16:17], v44 offset:128
  ds_read_b64_tr_b16 a[18:19], v44 offset:4736
  v_mfma_f32_16x16x32_bf16 v[192:195], a[20:23], a[52:55], v[192:195]
  s_add_u32 s88, s88, s11
  v_rsq_f32 v28, v12
  v_mfma_f32_16x16x32_bf16 v[196:199], a[20:23], a[56:59], v[196:199]
  s_waitcnt vmcnt(3)
  buffer_load_dwordx4 v25, s[60:63], s1 offen offset:3072 lds
  v_mfma_f32_16x16x32_bf16 v[200:203], a[20:23], a[60:63], v[200:203]
  s_cmp_eq_u32 s25, 6
  s_cselect_b32 s91, 0, -1
  v_mfma_f32_16x16x32_bf16 v[204:207], a[20:23], a[64:67], v[204:207]
  s_add_u32 s1, s7, 0x10000
  ds_read_b64_tr_b16 a[20:21], v44 offset:18576
  v_mfma_f32_16x16x32_bf16 v[208:211], a[24:27], a[52:55], v[208:211]
  s_add_u32 m0, s3, 0xe080
  ds_read_b64_tr_b16 a[22:23], v44 offset:23184
  v_mfma_f32_16x16x32_bf16 v[212:215], a[24:27], a[56:59], v[212:215]
  buffer_load_dwordx4 v24, s[60:63], s1 offen lds
  v_mfma_f32_16x16x32_bf16 v[216:219], a[24:27], a[60:63], v[216:219]
  v_mul_f32 v29, v28, v28
  v_mul_f32 v29, v29, v28
  v_mfma_f32_16x16x32_bf16 v[220:223], a[24:27], a[64:67], v[220:223]
  ds_read_b64_tr_b16 a[24:25], v47
  ds_read_b64_tr_b16 a[26:27], v47 offset:4608
  v_mfma_f32_16x16x32_bf16 v[224:227], a[28:31], a[52:55], v[224:227]
  v_mul_f32 v28, 0xc0135761, v28
  v_mul_f32 v29, 0xbdd2d3e8, v29
  v_mfma_f32_16x16x32_bf16 v[228:231], a[28:31], a[56:59], v[228:231]
  buffer_load_dwordx4 v25, s[60:63], s1 offen offset:1024 lds
  v_mfma_f32_16x16x32_bf16 v[232:235], a[28:31], a[60:63], v[232:235]
  v_rsq_f32 v48, v14
  s_nop 0
  v_mul_f32 v49, v48, v48
  v_mfma_f32_16x16x32_bf16 v[236:239], a[28:31], a[64:67], v[236:239]
  ds_read_b64_tr_b16 a[28:29], v44 offset:224
  ds_read_b64_tr_b16 a[30:31], v44 offset:4832
  v_mfma_f32_16x16x32_bf16 v[240:243], a[32:35], a[52:55], v[240:243]
  s_add_u32 s1, s7, 0x13800
  v_mul_f32 v49, v49, v48
  v_mfma_f32_16x16x32_bf16 v[244:247], a[32:35], a[56:59], v[244:247]
  v_mul_f32 v48, 0xc0135761, v48
  v_mul_f32 v49, 0xbdd2d3e8, v49
  v_mfma_f32_16x16x32_bf16 v[248:251], a[32:35], a[60:63], v[248:251]
  buffer_load_dwordx4 v24, s[60:63], s1 offen offset:2048 lds
  v_mfma_f32_16x16x32_bf16 v[252:255], a[32:35], a[64:67], v[252:255]
  ds_read_b64_tr_b16 a[32:33], v44 offset:18672
  ds_read_b64_tr_b16 a[34:35], v44 offset:23280
  s_waitcnt lgkmcnt(6)
  v_mfma_f32_16x16x32_bf16 v[112:115], a[0:3], v[76:79], v[112:115]
  ds_read_b64_tr_b16 a[124:125], v57
  ds_read_b64_tr_b16 a[126:127], v57 offset:512
  v_mfma_f32_16x16x32_bf16 v[116:119], a[0:3], v[80:83], v[116:119]
  ds_read_b64_tr_b16 a[128:129], v58
  ds_read_b64_tr_b16 a[130:131], v58 offset:512
  v_mfma_f32_16x16x32_bf16 v[120:123], a[0:3], v[84:87], v[120:123]
  buffer_load_dwordx4 v25, s[60:63], s1 offen offset:3072 lds
  v_mfma_f32_16x16x32_bf16 v[124:127], a[0:3], v[88:91], v[124:127]
  ds_read_b64_tr_b16 a[132:133], v59
  ds_read_b64_tr_b16 a[134:135], v59 offset:512
  v_mfma_f32_16x16x32_bf16 v[128:131], a[4:7], v[76:79], v[128:131]
  ds_read_b64_tr_b16 a[136:137], v60
  ds_read_b64_tr_b16 a[138:139], v60 offset:512
  v_mfma_f32_16x16x32_bf16 v[132:135], a[4:7], v[80:83], v[132:135]
  s_add_u32 s1, s12, 0
  ds_read_b64_tr_b16 a[140:141], v57 offset:4096
  v_mfma_f32_16x16x32_bf16 v[136:139], a[4:7], v[84:87], v[136:139]
  s_add_u32 m0, s3, 0xf080
  ds_read_b64_tr_b16 a[142:143], v57 offset:4608
  v_mfma_f32_16x16x32_bf16 v[140:143], a[4:7], v[88:91], v[140:143]
  buffer_load_dwordx4 v24, s[60:63], s1 offen lds
  v_mfma_f32_16x16x32_bf16 v[144:147], a[8:11], v[76:79], v[144:147]
  ds_read_b64_tr_b16 a[144:145], v58 offset:4096
  ds_read_b64_tr_b16 a[146:147], v58 offset:4608
  v_mfma_f32_16x16x32_bf16 v[148:151], a[8:11], v[80:83], v[148:151]
  ds_read_b64_tr_b16 a[148:149], v59 offset:4096
  ds_read_b64_tr_b16 a[150:151], v59 offset:4608
  v_mfma_f32_16x16x32_bf16 v[152:155], a[8:11], v[84:87], v[152:155]
  ds_read_b64_tr_b16 a[152:153], v60 offset:4096
  ds_read_b64_tr_b16 a[154:155], v60 offset:4608
  v_mfma_f32_16x16x32_bf16 v[156:159], a[8:11], v[88:91], v[156:159]
  buffer_load_dwordx4 v25, s[60:63], s1 offen offset:1024 lds
  v_mfma_f32_16x16x32_bf16 v[160:163], a[12:15], v[76:79], v[160:163]
  ds_read_b64_tr_b16 a[156:157], v57 offset:8192
  ds_read_b64_tr_b16 a[158:159], v57 offset:8704
  v_mfma_f32_16x16x32_bf16 v[164:167], a[12:15], v[80:83], v[164:167]
  s_add_u32 s1, s12, 0x3800
  ds_read_b64_tr_b16 a[160:161], v58 offset:8192
  v_mfma_f32_16x16x32_bf16 v[168:171], a[12:15], v[84:87], v[168:171]
  ds_read_b64_tr_b16 a[162:163], v58 offset:8704
  ds_read_b64_tr_b16 a[164:165], v59 offset:8192
  v_mfma_f32_16x16x32_bf16 v[172:175], a[12:15], v[88:91], v[172:175]
  buffer_load_dwordx4 v24, s[60:63], s1 offen offset:2048 lds
  v_mfma_f32_16x16x32_bf16 v[176:179], a[16:19], v[76:79], v[176:179]
  ds_read_b64_tr_b16 a[166:167], v59 offset:8704
  ds_read_b64_tr_b16 a[168:169], v60 offset:8192
  v_mfma_f32_16x16x32_bf16 v[180:183], a[16:19], v[80:83], v[180:183]
  ds_read_b64_tr_b16 a[170:171], v60 offset:8704
  v_mfma_f32_16x16x32_bf16 v[184:187], a[16:19], v[84:87], v[184:187]
  v_mfma_f32_16x16x32_bf16 v[188:191], a[16:19], v[88:91], v[188:191]
  v_mfma_f32_16x16x32_bf16 v[192:195], a[20:23], v[76:79], v[192:195]
  buffer_load_dwordx4 v25, s[60:63], s1 offen offset:3072 lds
  v_mfma_f32_16x16x32_bf16 v[196:199], a[20:23], v[80:83], v[196:199]
  v_mfma_f32_16x16x32_bf16 v[200:203], a[20:23], v[84:87], v[200:203]
  v_mfma_f32_16x16x32_bf16 v[204:207], a[20:23], v[88:91], v[204:207]
  s_waitcnt lgkmcnt(8)
  v_mfma_f32_16x16x32_bf16 v[208:211], a[24:27], v[76:79], v[208:211]
  v_mfma_f32_16x16x32_bf16 v[212:215], a[24:27], v[80:83], v[212:215]
  v_mfma_f32_16x16x32_bf16 v[216:219], a[24:27], v[84:87], v[216:219]
  v_mfma_f32_16x16x32_bf16 v[220:223], a[24:27], v[88:91], v[220:223]
  v_mfma_f32_16x16x32_bf16 v[224:227], a[28:31], v[76:79], v[224:227]
  v_mfma_f32_16x16x32_bf16 v[228:231], a[28:31], v[80:83], v[228:231]
  v_mfma_f32_16x16x32_bf16 v[232:235], a[28:31], v[84:87], v[232:235]
  v_mfma_f32_16x16x32_bf16 v[236:239], a[28:31], v[88:91], v[236:239]
  v_mfma_f32_16x16x32_bf16 v[240:243], a[32:35], v[76:79], v[240:243]
  v_mfma_f32_16x16x32_bf16 v[244:247], a[32:35], v[80:83], v[244:247]
  v_mfma_f32_16x16x32_bf16 v[248:251], a[32:35], v[84:87], v[248:251]
  v_mfma_f32_16x16x32_bf16 v[252:255], a[32:35], v[88:91], v[252:255]
  s_barrier
  s_add_u32 s1, s12, 0x8000
  s_add_u32 m0, s3, 0x1a100
  v_pk_mul_f32 v[16:17], v[112:113], v[112:113]
  buffer_load_dwordx4 v24, s[60:63], s1 offen lds
  v_pk_mul_f32 v[22:23], v[114:115], v[114:115]
  v_pk_mul_f32 v[34:35], v[116:117], v[116:117]
  v_pk_mul_f32 v[40:41], v[118:119], v[118:119]
  v_pk_mul_f32 v[18:19], v[112:113], v[128:129]
  v_pk_mul_f32 v[30:31], v[114:115], v[130:131]
  v_pk_mul_f32 v[36:37], v[116:117], v[132:133]
  v_pk_mul_f32 v[42:43], v[118:119], v[134:135]
  v_pk_fma_f32 v[16:17], v[16:17], v[2:3], v[2:3] op_sel:[0,1,0] op_sel_hi:[1,1,0]
  v_pk_fma_f32 v[22:23], v[22:23], v[2:3], v[2:3] op_sel:[0,1,0] op_sel_hi:[1,1,0]
  v_pk_fma_f32 v[34:35], v[34:35], v[4:5], v[4:5] op_sel:[0,1,0] op_sel_hi:[1,1,0]
  v_pk_fma_f32 v[40:41], v[40:41], v[4:5], v[4:5] op_sel:[0,1,0] op_sel_hi:[1,1,0]
  v_pk_mul_f32 v[16:17], v[112:113], v[16:17]
  v_pk_mul_f32 v[22:23], v[114:115], v[22:23]
  buffer_load_dwordx4 v25, s[60:63], s1 offen offset:1024 lds
  s_add_u32 s1, s12, 0xb800
  v_pk_mul_f32 v[34:35], v[116:117], v[34:35]
  v_pk_mul_f32 v[40:41], v[118:119], v[40:41]
  v_exp_f32 v20, v16
  v_exp_f32 v32, v22
  v_exp_f32 v38, v34
  v_exp_f32 v44, v40
  v_exp_f32 v21, v17
  v_exp_f32 v33, v23
  v_exp_f32 v39, v35
  v_exp_f32 v45, v41
  v_pk_fma_f32 v[20:21], v[20:21], v[68:69], v[68:69] op_sel:[0,1,1] op_sel_hi:[1,1,1]
  v_pk_fma_f32 v[32:33], v[32:33], v[68:69], v[68:69] op_sel:[0,1,1] op_sel_hi:[1,1,1]
  v_pk_fma_f32 v[38:39], v[38:39], v[70:71], v[70:71] op_sel:[0,1,1] op_sel_hi:[1,1,1]
  buffer_load_dwordx4 v24, s[60:63], s1 offen offset:2048 lds
  v_pk_fma_f32 v[44:45], v[44:45], v[70:71], v[70:71] op_sel:[0,1,1] op_sel_hi:[1,1,1]
  v_rcp_f32 v20, v20
  v_rcp_f32 v32, v32
  v_rcp_f32 v38, v38
  v_rcp_f32 v44, v44
  v_rcp_f32 v21, v21
  v_rcp_f32 v33, v33
  v_rcp_f32 v39, v39
  v_rcp_f32 v45, v45
  v_pk_mul_f32 v[18:19], v[18:19], v[20:21]
  v_pk_mul_f32 v[30:31], v[30:31], v[32:33]
  v_pk_mul_f32 v[36:37], v[36:37], v[38:39]
  v_pk_mul_f32 v[42:43], v[42:43], v[44:45]
  buffer_load_dwordx4 v25, s[60:63], s1 offen offset:3072 lds
  s_add_u32 s1, s12, 0x10000
  s_add_u32 m0, s3, 0x1b100
  v_cvt_pk_bf16_f32 v52, v18, v19
  v_cvt_pk_bf16_f32 v53, v30, v31
  v_cvt_pk_bf16_f32 v54, v36, v37
  v_cvt_pk_bf16_f32 v55, v42, v43
  s_nop 0
  v_permlane16_swap_b32 v52, v54
  v_permlane16_swap_b32 v53, v55
  buffer_store_dwordx4 v[52:55], v1, s[48:51], s10 offen sc1
  v_pk_mul_f32 v[16:17], v[120:121], v[120:121]
  v_pk_mul_f32 v[22:23], v[122:123], v[122:123]
  v_pk_mul_f32 v[34:35], v[124:125], v[124:125]
  v_pk_mul_f32 v[40:41], v[126:127], v[126:127]
  v_pk_mul_f32 v[18:19], v[120:121], v[136:137]
  v_pk_mul_f32 v[30:31], v[122:123], v[138:139]
  v_pk_mul_f32 v[36:37], v[124:125], v[140:141]
  v_pk_mul_f32 v[42:43], v[126:127], v[142:143]
  v_pk_fma_f32 v[16:17], v[16:17], v[8:9], v[8:9] op_sel:[0,1,0] op_sel_hi:[1,1,0]
  v_pk_fma_f32 v[22:23], v[22:23], v[8:9], v[8:9] op_sel:[0,1,0] op_sel_hi:[1,1,0]
  v_pk_fma_f32 v[34:35], v[34:35], v[10:11], v[10:11] op_sel:[0,1,0] op_sel_hi:[1,1,0]
  v_pk_fma_f32 v[40:41], v[40:41], v[10:11], v[10:11] op_sel:[0,1,0] op_sel_hi:[1,1,0]
  v_pk_mul_f32 v[16:17], v[120:121], v[16:17]
  buffer_load_dwordx4 v24, s[60:63], s1 offen lds
  v_pk_mul_f32 v[22:23], v[122:123], v[22:23]
  v_pk_mul_f32 v[34:35], v[124:125], v[34:35]
  v_pk_mul_f32 v[40:41], v[126:127], v[40:41]
  v_exp_f32 v20, v16
  v_exp_f32 v32, v22
  v_exp_f32 v38, v34
  v_exp_f32 v44, v40
  v_exp_f32 v21, v17
  v_exp_f32 v33, v23
  v_exp_f32 v39, v35
  v_exp_f32 v45, v41
  v_pk_fma_f32 v[20:21], v[20:21], v[72:73], v[72:73] op_sel:[0,1,1] op_sel_hi:[1,1,1]
  v_pk_fma_f32 v[32:33], v[32:33], v[72:73], v[72:73] op_sel:[0,1,1] op_sel_hi:[1,1,1]
  buffer_load_dwordx4 v25, s[60:63], s1 offen offset:1024 lds
  s_add_u32 s1, s12, 0x13800
  v_pk_fma_f32 v[38:39], v[38:39], v[74:75], v[74:75] op_sel:[0,1,1] op_sel_hi:[1,1,1]
  v_pk_fma_f32 v[44:45], v[44:45], v[74:75], v[74:75] op_sel:[0,1,1] op_sel_hi:[1,1,1]
  v_rcp_f32 v20, v20
  v_rcp_f32 v32, v32
  v_rcp_f32 v38, v38
  v_rcp_f32 v44, v44
  v_rcp_f32 v21, v21
  v_rcp_f32 v33, v33
  v_rcp_f32 v39, v39
  v_rcp_f32 v45, v45
  v_pk_mul_f32 v[18:19], v[18:19], v[20:21]
  v_pk_mul_f32 v[30:31], v[30:31], v[32:33]
  v_pk_mul_f32 v[36:37], v[36:37], v[38:39]
  buffer_load_dwordx4 v24, s[60:63], s1 offen offset:2048 lds
  v_pk_mul_f32 v[42:43], v[42:43], v[44:45]
  v_cvt_pk_bf16_f32 v64, v18, v19
  v_cvt_pk_bf16_f32 v65, v30, v31
  v_cvt_pk_bf16_f32 v66, v36, v37
  v_cvt_pk_bf16_f32 v67, v42, v43
  s_nop 0
  v_permlane16_swap_b32 v64, v66
  v_permlane16_swap_b32 v65, v67
  buffer_store_dwordx4 v[64:67], v1, s[48:51], s10 offen offset:1024 sc1
  s_add_u32 s10, s10, 0x1000
  v_pk_mul_f32 v[16:17], v[144:145], v[144:145]
  v_pk_mul_f32 v[22:23], v[146:147], v[146:147]
  v_pk_mul_f32 v[34:35], v[148:149], v[148:149]
  v_pk_mul_f32 v[40:41], v[150:151], v[150:151]
  v_pk_mul_f32 v[18:19], v[144:145], v[160:161]
  v_pk_mul_f32 v[30:31], v[146:147], v[162:163]
  v_pk_mul_f32 v[36:37], v[148:149], v[164:165]
  v_pk_mul_f32 v[42:43], v[150:151], v[166:167]
  v_pk_fma_f32 v[16:17], v[16:17], v[2:3], v[2:3] op_sel:[0,1,0] op_sel_hi:[1,1,0]
  v_pk_fma_f32 v[22:23], v[22:23], v[2:3], v[2:3] op_sel:[0,1,0] op_sel_hi:[1,1,0]
  v_pk_fma_f32 v[34:35], v[34:35], v[4:5], v[4:5] op_sel:[0,1,0] op_sel_hi:[1,1,0]
  v_pk_fma_f32 v[40:41], v[40:41], v[4:5], v[4:5] op_sel:[0,1,0] op_sel_hi:[1,1,0]
  buffer_load_dwordx4 v25, s[60:63], s1 offen offset:3072 lds
  s_add_u32 s1, s13, 0
  s_add_u32 m0, s3, 0x1c100
  v_pk_mul_f32 v[16:17], v[144:145], v[16:17]
  v_pk_mul_f32 v[22:23], v[146:147], v[22:23]
  v_pk_mul_f32 v[34:35], v[148:149], v[34:35]
  v_pk_mul_f32 v[40:41], v[150:151], v[40:41]
  v_exp_f32 v20, v16
  v_exp_f32 v32, v22
  v_exp_f32 v38, v34
  v_exp_f32 v44, v40
  v_exp_f32 v21, v17
  v_exp_f32 v33, v23
  v_exp_f32 v39, v35
  v_exp_f32 v45, v41
  v_pk_fma_f32 v[20:21], v[20:21], v[68:69], v[68:69] op_sel:[0,1,1] op_sel_hi:[1,1,1]
  buffer_load_dwordx4 v24, s[56:59], s1 offen lds
  v_pk_fma_f32 v[32:33], v[32:33], v[68:69], v[68:69] op_sel:[0,1,1] op_sel_hi:[1,1,1]
  v_pk_fma_f32 v[38:39], v[38:39], v[70:71], v[70:71] op_sel:[0,1,1] op_sel_hi:[1,1,1]
  v_pk_fma_f32 v[44:45], v[44:45], v[70:71], v[70:71] op_sel:[0,1,1] op_sel_hi:[1,1,1]
  v_rcp_f32 v20, v20
  v_rcp_f32 v32, v32
  v_rcp_f32 v38, v38
  v_rcp_f32 v44, v44
  v_rcp_f32 v21, v21
  v_rcp_f32 v33, v33
  v_rcp_f32 v39, v39
  v_rcp_f32 v45, v45
  v_pk_mul_f32 v[18:19], v[18:19], v[20:21]
  v_pk_mul_f32 v[30:31], v[30:31], v[32:33]
  buffer_load_dwordx4 v25, s[56:59], s1 offen offset:1024 lds
  s_add_u32 s1, s13, 0x3800
  v_pk_mul_f32 v[36:37], v[36:37], v[38:39]
  v_pk_mul_f32 v[42:43], v[42:43], v[44:45]
  v_cvt_pk_bf16_f32 v52, v18, v19
  v_cvt_pk_bf16_f32 v53, v30, v31
  v_cvt_pk_bf16_f32 v54, v36, v37
  v_cvt_pk_bf16_f32 v55, v42, v43
  s_nop 0
  v_permlane16_swap_b32 v52, v54
  v_permlane16_swap_b32 v53, v55
  buffer_store_dwordx4 v[52:55], v1, s[48:51], s10 offen sc1
  v_pk_mul_f32 v[16:17], v[152:153], v[152:153]
  v_pk_mul_f32 v[22:23], v[154:155], v[154:155]
  v_pk_mul_f32 v[34:35], v[156:157], v[156:157]
  v_pk_mul_f32 v[40:41], v[158:159], v[158:159]
  v_pk_mul_f32 v[18:19], v[152:153], v[168:169]
  v_pk_mul_f32 v[30:31], v[154:155], v[170:171]
  v_pk_mul_f32 v[36:37], v[156:157], v[172:173]
  v_pk_mul_f32 v[42:43], v[158:159], v[174:175]
  v_pk_fma_f32 v[16:17], v[16:17], v[8:9], v[8:9] op_sel:[0,1,0] op_sel_hi:[1,1,0]
  v_pk_fma_f32 v[22:23], v[22:23], v[8:9], v[8:9] op_sel:[0,1,0] op_sel_hi:[1,1,0]
  v_pk_fma_f32 v[34:35], v[34:35], v[10:11], v[10:11] op_sel:[0,1,0] op_sel_hi:[1,1,0]
  v_pk_fma_f32 v[40:41], v[40:41], v[10:11], v[10:11] op_sel:[0,1,0] op_sel_hi:[1,1,0]
  v_pk_mul_f32 v[16:17], v[152:153], v[16:17]
  buffer_load_dwordx4 v24, s[56:59], s1 offen offset:2048 lds
  v_pk_mul_f32 v[22:23], v[154:155], v[22:23]
  v_pk_mul_f32 v[34:35], v[156:157], v[34:35]
  v_pk_mul_f32 v[40:41], v[158:159], v[40:41]
  v_exp_f32 v20, v16
  v_exp_f32 v32, v22
  v_exp_f32 v38, v34
  v_exp_f32 v44, v40
  v_exp_f32 v21, v17
  v_exp_f32 v33, v23
  v_exp_f32 v39, v35
  v_exp_f32 v45, v41
  v_pk_fma_f32 v[20:21], v[20:21], v[72:73], v[72:73] op_sel:[0,1,1] op_sel_hi:[1,1,1]
  v_pk_fma_f32 v[32:33], v[32:33], v[72:73], v[72:73] op_sel:[0,1,1] op_sel_hi:[1,1,1]
  buffer_load_dwordx4 v25, s[56:59], s1 offen offset:3072 lds
  s_waitcnt lgkmcnt(0)
  s_add_u32 s1, s13, 0x8000
  s_add_u32 m0, s3, 0
  v_pk_fma_f32 v[38:39], v[38:39], v[74:75], v[74:75] op_sel:[0,1,1] op_sel_hi:[1,1,1]
  v_pk_fma_f32 v[44:45], v[44:45], v[74:75], v[74:75] op_sel:[0,1,1] op_sel_hi:[1,1,1]
  v_rcp_f32 v20, v20
  v_rcp_f32 v32, v32
  v_rcp_f32 v38, v38
  v_rcp_f32 v44, v44
  v_rcp_f32 v21, v21
  v_rcp_f32 v33, v33
  v_rcp_f32 v39, v39
  v_rcp_f32 v45, v45
  v_pk_mul_f32 v[18:19], v[18:19], v[20:21]
  v_pk_mul_f32 v[30:31], v[30:31], v[32:33]
  v_pk_mul_f32 v[36:37], v[36:37], v[38:39]
  buffer_load_dwordx4 v24, s[56:59], s1 offen lds
  v_pk_mul_f32 v[42:43], v[42:43], v[44:45]
  v_cvt_pk_bf16_f32 v64, v18, v19
  v_cvt_pk_bf16_f32 v65, v30, v31
  v_cvt_pk_bf16_f32 v66, v36, v37
  v_cvt_pk_bf16_f32 v67, v42, v43
  s_nop 0
  v_permlane16_swap_b32 v64, v66
  v_permlane16_swap_b32 v65, v67
  buffer_store_dwordx4 v[64:67], v1, s[48:51], s10 offen offset:1024 sc1
  s_add_u32 s10, s10, 0x1000
  v_pk_mul_f32 v[16:17], v[176:177], v[176:177]
  v_pk_mul_f32 v[22:23], v[178:179], v[178:179]
  v_pk_mul_f32 v[34:35], v[180:181], v[180:181]
  v_pk_mul_f32 v[40:41], v[182:183], v[182:183]
  v_pk_mul_f32 v[18:19], v[176:177], v[192:193]
  v_pk_mul_f32 v[30:31], v[178:179], v[194:195]
  v_pk_mul_f32 v[36:37], v[180:181], v[196:197]
  v_pk_mul_f32 v[42:43], v[182:183], v[198:199]
  v_pk_fma_f32 v[16:17], v[16:17], v[2:3], v[2:3] op_sel:[0,1,0] op_sel_hi:[1,1,0]
  v_pk_fma_f32 v[22:23], v[22:23], v[2:3], v[2:3] op_sel:[0,1,0] op_sel_hi:[1,1,0]
  v_pk_fma_f32 v[34:35], v[34:35], v[4:5], v[4:5] op_sel:[0,1,0] op_sel_hi:[1,1,0]
  v_pk_fma_f32 v[40:41], v[40:41], v[4:5], v[4:5] op_sel:[0,1,0] op_sel_hi:[1,1,0]
  buffer_load_dwordx4 v25, s[56:59], s1 offen offset:1024 lds
  s_add_u32 s1, s13, 0xb800
  v_pk_mul_f32 v[16:17], v[176:177], v[16:17]
  v_pk_mul_f32 v[22:23], v[178:179], v[22:23]
  v_pk_mul_f32 v[34:35], v[180:181], v[34:35]
  v_pk_mul_f32 v[40:41], v[182:183], v[40:41]
  v_exp_f32 v20, v16
  v_exp_f32 v32, v22
  v_exp_f32 v38, v34
  v_exp_f32 v44, v40
  v_exp_f32 v21, v17
  v_exp_f32 v33, v23
  v_exp_f32 v39, v35
  v_exp_f32 v45, v41
  v_pk_fma_f32 v[20:21], v[20:21], v[68:69], v[68:69] op_sel:[0,1,1] op_sel_hi:[1,1,1]
  buffer_load_dwordx4 v24, s[56:59], s1 offen offset:2048 lds
  v_pk_fma_f32 v[32:33], v[32:33], v[68:69], v[68:69] op_sel:[0,1,1] op_sel_hi:[1,1,1]
  v_pk_fma_f32 v[38:39], v[38:39], v[70:71], v[70:71] op_sel:[0,1,1] op_sel_hi:[1,1,1]
  v_pk_fma_f32 v[44:45], v[44:45], v[70:71], v[70:71] op_sel:[0,1,1] op_sel_hi:[1,1,1]
  v_rcp_f32 v20, v20
  v_rcp_f32 v32, v32
  v_rcp_f32 v38, v38
  v_rcp_f32 v44, v44
  v_rcp_f32 v21, v21
  v_rcp_f32 v33, v33
  v_rcp_f32 v39, v39
  v_rcp_f32 v45, v45
  v_pk_mul_f32 v[18:19], v[18:19], v[20:21]
  v_pk_mul_f32 v[30:31], v[30:31], v[32:33]
  buffer_load_dwordx4 v25, s[56:59], s1 offen offset:3072 lds
  s_add_u32 s1, s13, 0x10000
  s_add_u32 m0, s3, 0x1000
  v_pk_mul_f32 v[36:37], v[36:37], v[38:39]
  v_pk_mul_f32 v[42:43], v[42:43], v[44:45]
  v_cvt_pk_bf16_f32 v52, v18, v19
  v_cvt_pk_bf16_f32 v53, v30, v31
  v_cvt_pk_bf16_f32 v54, v36, v37
  v_cvt_pk_bf16_f32 v55, v42, v43
  s_nop 0
  v_permlane16_swap_b32 v52, v54
  v_permlane16_swap_b32 v53, v55
  buffer_store_dwordx4 v[52:55], v1, s[48:51], s10 offen sc1
  v_pk_mul_f32 v[16:17], v[184:185], v[184:185]
  v_pk_mul_f32 v[22:23], v[186:187], v[186:187]
  v_pk_mul_f32 v[34:35], v[188:189], v[188:189]
  v_pk_mul_f32 v[40:41], v[190:191], v[190:191]
  v_pk_mul_f32 v[18:19], v[184:185], v[200:201]
  v_pk_mul_f32 v[30:31], v[186:187], v[202:203]
  v_pk_mul_f32 v[36:37], v[188:189], v[204:205]
  v_pk_mul_f32 v[42:43], v[190:191], v[206:207]
  v_pk_fma_f32 v[16:17], v[16:17], v[8:9], v[8:9] op_sel:[0,1,0] op_sel_hi:[1,1,0]
  v_pk_fma_f32 v[22:23], v[22:23], v[8:9], v[8:9] op_sel:[0,1,0] op_sel_hi:[1,1,0]
  v_pk_fma_f32 v[34:35], v[34:35], v[10:11], v[10:11] op_sel:[0,1,0] op_sel_hi:[1,1,0]
  v_pk_fma_f32 v[40:41], v[40:41], v[10:11], v[10:11] op_sel:[0,1,0] op_sel_hi:[1,1,0]
  v_pk_mul_f32 v[16:17], v[184:185], v[16:17]
  buffer_load_dwordx4 v24, s[56:59], s1 offen lds
  v_pk_mul_f32 v[22:23], v[186:187], v[22:23]
  v_pk_mul_f32 v[34:35], v[188:189], v[34:35]
  v_pk_mul_f32 v[40:41], v[190:191], v[40:41]
  v_exp_f32 v20, v16
  v_exp_f32 v32, v22
  v_exp_f32 v38, v34
  v_exp_f32 v44, v40
  v_exp_f32 v21, v17
  v_exp_f32 v33, v23
  v_exp_f32 v39, v35
  v_exp_f32 v45, v41
  v_pk_fma_f32 v[20:21], v[20:21], v[72:73], v[72:73] op_sel:[0,1,1] op_sel_hi:[1,1,1]
  v_pk_fma_f32 v[32:33], v[32:33], v[72:73], v[72:73] op_sel:[0,1,1] op_sel_hi:[1,1,1]
  buffer_load_dwordx4 v25, s[56:59], s1 offen offset:1024 lds
  s_add_u32 s1, s13, 0x13800
  v_pk_fma_f32 v[38:39], v[38:39], v[74:75], v[74:75] op_sel:[0,1,1] op_sel_hi:[1,1,1]
  v_pk_fma_f32 v[44:45], v[44:45], v[74:75], v[74:75] op_sel:[0,1,1] op_sel_hi:[1,1,1]
  v_rcp_f32 v20, v20
  v_rcp_f32 v32, v32
  v_rcp_f32 v38, v38
  v_rcp_f32 v44, v44
  v_rcp_f32 v21, v21
  v_rcp_f32 v33, v33
  v_rcp_f32 v39, v39
  v_rcp_f32 v45, v45
  v_pk_mul_f32 v[18:19], v[18:19], v[20:21]
  v_pk_mul_f32 v[30:31], v[30:31], v[32:33]
  v_pk_mul_f32 v[36:37], v[36:37], v[38:39]
  buffer_load_dwordx4 v24, s[56:59], s1 offen offset:2048 lds
  v_pk_mul_f32 v[42:43], v[42:43], v[44:45]
  v_cvt_pk_bf16_f32 v64, v18, v19
  v_cvt_pk_bf16_f32 v65, v30, v31
  v_cvt_pk_bf16_f32 v66, v36, v37
  v_cvt_pk_bf16_f32 v67, v42, v43
  s_nop 0
  v_permlane16_swap_b32 v64, v66
  v_permlane16_swap_b32 v65, v67
  buffer_store_dwordx4 v[64:67], v1, s[48:51], s10 offen offset:1024 sc1
  v_permlane32_swap_b32 v208, v212
  v_permlane32_swap_b32 v209, v213
  v_permlane32_swap_b32 v210, v214
  v_permlane32_swap_b32 v211, v215
  v_permlane32_swap_b32 v216, v220
  v_permlane32_swap_b32 v217, v221
  v_permlane32_swap_b32 v218, v222
  v_permlane32_swap_b32 v219, v223
  v_pk_mul_f32 v[16:17], v[208:209], v[208:209]
  v_pk_mul_f32 v[22:23], v[210:211], v[210:211]
  v_pk_mul_f32 v[34:35], v[216:217], v[216:217]
  v_pk_mul_f32 v[40:41], v[218:219], v[218:219]
  v_pk_mul_f32 v[18:19], v[208:209], v[212:213]
  buffer_load_dwordx4 v25, s[56:59], s1 offen offset:3072 lds
  s_add_u32 s1, s13, 0x18000
  s_add_u32 m0, s3, 0x2000
  v_pk_mul_f32 v[30:31], v[210:211], v[214:215]
  v_pk_mul_f32 v[36:37], v[216:217], v[220:221]
  v_pk_mul_f32 v[42:43], v[218:219], v[222:223]
  v_pk_fma_f32 v[16:17], v[16:17], v[28:29], v[28:29] op_sel:[0,1,0] op_sel_hi:[1,1,0]
  v_pk_fma_f32 v[22:23], v[22:23], v[28:29], v[28:29] op_sel:[0,1,0] op_sel_hi:[1,1,0]
  v_pk_fma_f32 v[34:35], v[34:35], v[48:49], v[48:49] op_sel:[0,1,0] op_sel_hi:[1,1,0]
  v_pk_fma_f32 v[40:41], v[40:41], v[48:49], v[48:49] op_sel:[0,1,0] op_sel_hi:[1,1,0]
  v_pk_mul_f32 v[16:17], v[208:209], v[16:17]
  v_pk_mul_f32 v[22:23], v[210:211], v[22:23]
  v_pk_mul_f32 v[34:35], v[216:217], v[34:35]
  v_pk_mul_f32 v[40:41], v[218:219], v[40:41]
  v_exp_f32 v20, v16
  v_exp_f32 v32, v22
  buffer_load_dwordx4 v24, s[56:59], s1 offen lds
  v_exp_f32 v38, v34
  v_exp_f32 v44, v40
  v_exp_f32 v21, v17
  v_exp_f32 v33, v23
  v_exp_f32 v39, v35
  v_exp_f32 v45, v41
  v_pk_fma_f32 v[20:21], v[20:21], v[12:13], v[12:13] op_sel_hi:[1,0,0]
  v_pk_fma_f32 v[32:33], v[32:33], v[12:13], v[12:13] op_sel_hi:[1,0,0]
  v_pk_fma_f32 v[38:39], v[38:39], v[14:15], v[14:15] op_sel_hi:[1,0,0]
  v_pk_fma_f32 v[44:45], v[44:45], v[14:15], v[14:15] op_sel_hi:[1,0,0]
  v_rcp_f32 v20, v20
  v_rcp_f32 v32, v32
  v_rcp_f32 v38, v38
  buffer_load_dwordx4 v25, s[56:59], s1 offen offset:1024 lds
  s_add_u32 s1, s13, 0x1b800
  v_rcp_f32 v44, v44
  v_rcp_f32 v21, v21
  v_rcp_f32 v33, v33
  v_rcp_f32 v39, v39
  v_rcp_f32 v45, v45
  v_pk_mul_f32 v[18:19], v[18:19], v[20:21]
  v_pk_mul_f32 v[30:31], v[30:31], v[32:33]
  v_pk_mul_f32 v[36:37], v[36:37], v[38:39]
  v_pk_mul_f32 v[42:43], v[42:43], v[44:45]
  v_cvt_pk_bf16_f32 v52, v18, v19
  v_cvt_pk_bf16_f32 v53, v30, v31
  v_cvt_pk_bf16_f32 v54, v36, v37
  v_cvt_pk_bf16_f32 v55, v42, v43
  buffer_load_dwordx4 v24, s[56:59], s1 offen offset:2048 lds
  buffer_store_dwordx2 v[52:53], v6, s[48:51], s11 offen sc1
  buffer_store_dwordx2 v[54:55], v6, s[48:51], s11 offen offset:1024 sc1
  s_waitcnt vmcnt(6)
  s_barrier
  s_cmp_lg_u32 s26, 0
  s_cbranch_scc1 L_B_pub2a
  s_lshl_b32 s86, s24, 8
  s_lshl2_add_u32 s86, s30, s86
  s_add_u32 s86, s86, 0x872000
  v_mov_b32 v7, s86
  v_mov_b32 v46, s29
  s_mov_b64 exec, 1
  buffer_store_dword v46, v7, s[48:51], 0 offen sc0 sc1
  s_mov_b64 exec, -1
L_B_pub2a:
  v_pk_mul_f32 v[16:17], v[224:225], v[224:225]
  v_pk_mul_f32 v[22:23], v[226:227], v[226:227]
  v_pk_mul_f32 v[34:35], v[228:229], v[228:229]
  v_pk_mul_f32 v[40:41], v[230:231], v[230:231]
  v_pk_mul_f32 v[18:19], v[224:225], v[240:241]
  v_pk_mul_f32 v[30:31], v[226:227], v[242:243]
  v_pk_mul_f32 v[36:37], v[228:229], v[244:245]
  v_pk_mul_f32 v[42:43], v[230:231], v[246:247]
  v_pk_fma_f32 v[16:17], v[16:17], v[2:3], v[2:3] op_sel:[0,1,0] op_sel_hi:[1,1,0]
  v_pk_fma_f32 v[22:23], v[22:23], v[2:3], v[2:3] op_sel:[0,1,0] op_sel_hi:[1,1,0]
  v_pk_fma_f32 v[34:35], v[34:35], v[4:5], v[4:5] op_sel:[0,1,0] op_sel_hi:[1,1,0]
  v_pk_fma_f32 v[40:41], v[40:41], v[4:5], v[4:5] op_sel:[0,1,0] op_sel_hi:[1,1,0]
  v_pk_mul_f32 v[16:17], v[224:225], v[16:17]
  buffer_load_dwordx4 v25, s[56:59], s1 offen offset:3072 lds
  v_pk_mul_f32 v[22:23], v[226:227], v[22:23]
  v_pk_mul_f32 v[34:35], v[228:229], v[34:35]
  v_pk_mul_f32 v[40:41], v[230:231], v[40:41]
  v_exp_f32 v20, v16
  v_exp_f32 v32, v22
  v_exp_f32 v38, v34
  v_exp_f32 v44, v40
  v_exp_f32 v21, v17
  v_exp_f32 v33, v23
  s_branch L_skip4B
.p2align 12
L_pad4B:
  s_setpc_b64 s[20:21]
L_skip4B:
  v_exp_f32 v39, v35
  v_exp_f32 v45, v41
  v_pk_fma_f32 v[20:21], v[20:21], v[68:69], v[68:69] op_sel:[0,1,1] op_sel_hi:[1,1,1]
  v_pk_fma_f32 v[32:33], v[32:33], v[68:69], v[68:69] op_sel:[0,1,1] op_sel_hi:[1,1,1]
  v_pk_fma_f32 v[38:39], v[38:39], v[70:71], v[70:71] op_sel:[0,1,1] op_sel_hi:[1,1,1]
  v_pk_fma_f32 v[44:45], v[44:45], v[70:71], v[70:71] op_sel:[0,1,1] op_sel_hi:[1,1,1]
  v_rcp_f32 v20, v20
  v_rcp_f32 v32, v32
  v_rcp_f32 v38, v38
  v_rcp_f32 v44, v44
  v_rcp_f32 v21, v21
  v_rcp_f32 v33, v33
  v_rcp_f32 v39, v39
  v_rcp_f32 v45, v45
  v_pk_mul_f32 v[18:19], v[18:19], v[20:21]
  v_pk_mul_f32 v[30:31], v[30:31], v[32:33]
  v_pk_mul_f32 v[36:37], v[36:37], v[38:39]
  v_pk_mul_f32 v[42:43], v[42:43], v[44:45]
  v_cvt_pk_bf16_f32 v64, v18, v19
  v_cvt_pk_bf16_f32 v65, v30, v31
  v_cvt_pk_bf16_f32 v66, v36, v37
  v_cvt_pk_bf16_f32 v67, v42, v43
  v_and_b32 v64, s91, v64
  v_and_b32 v65, s91, v65
  v_and_b32 v66, s91, v66
  v_and_b32 v67, s91, v67
  s_nop 0
  v_permlane16_swap_b32 v64, v66
  v_permlane16_swap_b32 v65, v67
  buffer_store_dwordx4 v[64:67], v1, s[48:51], s88 offen sc1
  v_pk_mul_f32 v[16:17], v[232:233], v[232:233]
  v_pk_mul_f32 v[22:23], v[234:235], v[234:235]
  v_pk_mul_f32 v[34:35], v[236:237], v[236:237]
  v_pk_mul_f32 v[40:41], v[238:239], v[238:239]
  v_pk_mul_f32 v[18:19], v[232:233], v[248:249]
  v_pk_mul_f32 v[30:31], v[234:235], v[250:251]
  v_pk_mul_f32 v[36:37], v[236:237], v[252:253]
  v_pk_mul_f32 v[42:43], v[238:239], v[254:255]
  v_pk_fma_f32 v[16:17], v[16:17], v[8:9], v[8:9] op_sel:[0,1,0] op_sel_hi:[1,1,0]
  v_pk_fma_f32 v[22:23], v[22:23], v[8:9], v[8:9] op_sel:[0,1,0] op_sel_hi:[1,1,0]
  v_pk_fma_f32 v[34:35], v[34:35], v[10:11], v[10:11] op_sel:[0,1,0] op_sel_hi:[1,1,0]
  v_pk_fma_f32 v[40:41], v[40:41], v[10:11], v[10:11] op_sel:[0,1,0] op_sel_hi:[1,1,0]
  v_pk_mul_f32 v[16:17], v[232:233], v[16:17]
  v_pk_mul_f32 v[22:23], v[234:235], v[22:23]
  v_pk_mul_f32 v[34:35], v[236:237], v[34:35]
  v_pk_mul_f32 v[40:41], v[238:239], v[40:41]
  v_exp_f32 v20, v16
  v_exp_f32 v32, v22
  v_exp_f32 v38, v34
  v_exp_f32 v44, v40
  v_exp_f32 v21, v17
  v_exp_f32 v33, v23
  v_exp_f32 v39, v35
  v_exp_f32 v45, v41
  v_pk_fma_f32 v[20:21], v[20:21], v[72:73], v[72:73] op_sel:[0,1,1] op_sel_hi:[1,1,1]
  v_pk_fma_f32 v[32:33], v[32:33], v[72:73], v[72:73] op_sel:[0,1,1] op_sel_hi:[1,1,1]
  v_pk_fma_f32 v[38:39], v[38:39], v[74:75], v[74:75] op_sel:[0,1,1] op_sel_hi:[1,1,1]
  v_pk_fma_f32 v[44:45], v[44:45], v[74:75], v[74:75] op_sel:[0,1,1] op_sel_hi:[1,1,1]
  v_rcp_f32 v20, v20
  v_rcp_f32 v32, v32
  v_rcp_f32 v38, v38
  v_rcp_f32 v44, v44
  v_rcp_f32 v21, v21
  v_rcp_f32 v33, v33
  v_rcp_f32 v39, v39
  v_rcp_f32 v45, v45
  v_pk_mul_f32 v[18:19], v[18:19], v[20:21]
  v_pk_mul_f32 v[30:31], v[30:31], v[32:33]
  v_pk_mul_f32 v[36:37], v[36:37], v[38:39]
  v_pk_mul_f32 v[42:43], v[42:43], v[44:45]
  v_cvt_pk_bf16_f32 v52, v18, v19
  v_cvt_pk_bf16_f32 v53, v30, v31
  v_cvt_pk_bf16_f32 v54, v36, v37
  v_cvt_pk_bf16_f32 v55, v42, v43
  v_and_b32 v52, s91, v52
  v_and_b32 v53, s91, v53
  v_and_b32 v54, s91, v54
  v_and_b32 v55, s91, v55
  s_nop 0
  v_permlane16_swap_b32 v52, v54
  v_permlane16_swap_b32 v53, v55
  buffer_store_dwordx4 v[52:55], v1, s[48:51], s88 offen offset:1024 sc1
  ds_read_b64_tr_b16 a[172:173], v57 offset:53376
  s_mul_i32 s86, s27, 0x3c000
  ds_read_b64_tr_b16 a[174:175], v57 offset:53888
  s_add_u32 s52, s22, s86
  s_addc_u32 s53, s23, 0
  ds_read_b64_tr_b16 a[176:177], v58 offset:53376
  s_mov_b32 s54, 0x3c000
  ds_read_b64_tr_b16 a[178:179], v58 offset:53888
  s_mov_b32 s55, 0x20000
  ds_read_b64_tr_b16 a[180:181], v59 offset:53376
  s_mov_b32 s64, s18
  ds_read_b64_tr_b16 a[182:183], v59 offset:53888
  s_mov_b32 s65, s19
  ds_read_b64_tr_b16 a[184:185], v60 offset:53376
  s_mov_b32 s66, 0x200000
  ds_read_b64_tr_b16 a[186:187], v60 offset:53888
  s_mov_b32 s67, 0x20000
  ds_read_b64_tr_b16 a[188:189], v57 offset:57472
  v_add_u32 v1, 0x1a100, v57
  ds_read_b64_tr_b16 a[190:191], v57 offset:57984
  v_add_u32 v2, 0x1a100, v58
  ds_read_b64_tr_b16 a[192:193], v58 offset:57472
  v_add_u32 v3, 0x1a100, v59
  ds_read_b64_tr_b16 a[194:195], v58 offset:57984
  v_add_u32 v20, 0x1a100, v60
  ds_read_b64_tr_b16 a[196:197], v59 offset:57472
  v_and_b32 v27, 15, v0
  ds_read_b64_tr_b16 a[198:199], v59 offset:57984
  v_lshrrev_b32 v52, 5, v0
  ds_read_b64_tr_b16 a[200:201], v60 offset:57472
  v_lshlrev_b32 v52, 11, v52
  ds_read_b64_tr_b16 a[202:203], v60 offset:57984
  v_lshl_add_u32 v52, v27, 4, v52
  ds_read_b64_tr_b16 a[204:205], v57 offset:61568
  v_bfe_u32 v22, v0, 4, 1
  ds_read_b64_tr_b16 a[206:207], v57 offset:62080
  v_lshl_add_u32 v52, v22, 9, v52
  ds_read_b64_tr_b16 a[208:209], v58 offset:61568
  s_and_b32 s86, s26, 1
  ds_read_b64_tr_b16 a[210:211], v58 offset:62080
  s_lshl_b32 s86, s86, 8
  ds_read_b64_tr_b16 a[212:213], v59 offset:61568
  s_mul_i32 s87, s26, 0xf000
  ds_read_b64_tr_b16 a[214:215], v59 offset:62080
  s_add_u32 s86, s86, s87
  ds_read_b64_tr_b16 a[216:217], v60 offset:61568
  v_add_u32 v21, s86, v52
  ds_read_b64_tr_b16 a[218:219], v60 offset:62080
  s_waitcnt lgkmcnt(0)
  s_add_u32 s1, s7, 0x18000
  s_add_u32 m0, s3, 0xd080
  v_xor_b32 v22, 0x100, v21
  buffer_load_dwordx4 v24, s[60:63], s1 offen lds
  s_lshr_b32 s86, s27, 1
  s_lshl_b32 s86, s86, 8
  buffer_load_dwordx4 v25, s[60:63], s1 offen offset:1024 lds
  s_add_u32 s1, s7, 0x1b800
  s_add_u32 s86, s86, 0x872000
  v_lshl_add_u32 v54, v27, 2, s86
  buffer_load_dwordx4 v24, s[60:63], s1 offen offset:2048 lds
  s_and_b32 s86, s26, 1
  s_lshl_b32 s87, s27, 6
  buffer_load_dwordx4 v25, s[60:63], s1 offen offset:3072 lds
  s_add_u32 s1, s7, 0x20000
  s_add_u32 m0, s3, 0xe080
  s_add_u32 s86, s86, s87
  s_lshl_b32 s86, s86, 10
  buffer_load_dwordx4 v24, s[60:63], s1 offen lds
  s_mov_b32 s82, 0x8000
  s_lshl_b32 s87, s28, 7
  buffer_load_dwordx4 v25, s[60:63], s1 offen offset:1024 lds
  s_add_u32 s1, s12, 0x17800
  s_add_u32 s86, s86, s87
  s_and_b32 s87, s26, 2
  buffer_load_dwordx4 v24, s[60:63], s1 offen offset:2048 lds
  s_lshl_b32 s87, s87, 5
  s_add_u32 s86, s86, s87
  buffer_load_dwordx4 v25, s[60:63], s1 offen offset:3072 lds
  s_add_u32 s1, s12, 0x1c000
  s_add_u32 m0, s3, 0xf080
  v_lshlrev_b32 v27, 11, v27
  v_add_u32 v27, s86, v27
  buffer_load_dwordx4 v24, s[60:63], s1 offen lds
  v_lshrrev_b32 v52, 4, v0
  v_lshl_add_u32 v23, v52, 3, v27
  buffer_load_dwordx4 v25, s[60:63], s1 offen offset:1024 lds
  s_add_u32 s1, s12, 0x1f800
  v_add_u32 v23, 0x1000, v23
  v_bfe_u32 v52, v0, 4, 1
  buffer_load_dwordx4 v24, s[60:63], s1 offen offset:2048 lds
  v_lshl_add_u32 v27, v52, 5, v27
  v_lshrrev_b32 v52, 5, v0
  buffer_load_dwordx4 v25, s[60:63], s1 offen offset:3072 lds
  v_lshl_add_u32 v26, v52, 4, v27
  s_cmp_lg_u32 s26, 0
  s_cbranch_scc1 L_B_rq1
  buffer_load_dword v53, v54, s[48:51], 0 offen sc0 sc1
L_B_rq1:
  s_waitcnt vmcnt(12)
  s_barrier
  s_cmp_lg_u32 s26, 0
  s_cbranch_scc1 L_B_pub2
  s_lshl_b32 s86, s24, 8
  s_lshl2_add_u32 s86, s30, s86
  s_add_u32 s86, s86, 0x873000
  v_mov_b32 v62, s86
  v_mov_b32 v63, s29
  s_mov_b64 exec, 1
  buffer_store_dword v63, v62, s[48:51], 0 offen sc0 sc1
  s_mov_b64 exec, -1
L_B_pub2:
  s_cmp_lg_u32 s26, 0
  s_cbranch_scc1 L_B_ck1
  s_waitcnt vmcnt(1)
  v_cmp_ne_u32 vcc, s29, v53
  s_nop 4
  s_cbranch_vccz L_B_ck1_ok
  s_mov_b32 s0, 0
L_B_ck1_spin:
  buffer_load_dword v53, v54, s[48:51], 0 offen sc0 sc1
  s_add_u32 s0, s0, 1
  s_waitcnt vmcnt(0)
  s_waitcnt vmcnt(0)
  v_cmp_ne_u32 vcc, s29, v53
  s_cmp_ge_u32 s0, 0x8000
  s_cbranch_scc1 L_B_ck1_ok
  s_nop 2
  s_cbranch_vccnz L_B_ck1_spin
L_B_ck1_ok:
L_B_ck1:
  s_barrier
  v_add_u32 v54, 0x1000, v54
  s_mov_b32 s81, 0
  buffer_load_dwordx4 a[48:51], v21, s[52:55], s81 offen sc1
  buffer_load_dwordx4 a[52:55], v22, s[52:55], s81 offen sc1
  buffer_load_dwordx4 a[56:59], v21, s[52:55], s81 offen offset:1024 sc1
  buffer_load_dwordx4 a[60:63], v22, s[52:55], s81 offen offset:1024 sc1
  s_mov_b32 s81, 0x1000
  buffer_load_dwordx4 a[64:67], v21, s[52:55], s81 offen sc1
  buffer_load_dwordx4 a[68:71], v22, s[52:55], s81 offen sc1
  buffer_load_dwordx4 a[72:75], v21, s[52:55], s81 offen offset:1024 sc1
  buffer_load_dwordx4 a[76:79], v22, s[52:55], s81 offen offset:1024 sc1
  s_mov_b32 s81, 0x2000
  buffer_load_dwordx4 a[80:83], v21, s[52:55], s81 offen sc1
  buffer_load_dwordx4 a[84:87], v22, s[52:55], s81 offen sc1
  s_waitcnt vmcnt(9)
  v_mfma_f32_16x16x32_bf16 v[4:7], a[124:127], a[48:51], 0
  v_mfma_f32_16x16x32_bf16 v[8:11], a[128:131], a[48:51], 0
  buffer_load_dwordx4 a[88:91], v21, s[52:55], s81 offen offset:1024 sc1
  v_mfma_f32_16x16x32_bf16 v[28:31], a[132:135], a[48:51], 0
  v_mfma_f32_16x16x32_bf16 v[32:35], a[136:139], a[48:51], 0
  s_waitcnt vmcnt(9)
  v_mfma_f32_16x16x32_bf16 v[12:15], a[124:127], a[52:55], 0
  v_mfma_f32_16x16x32_bf16 v[16:19], a[128:131], a[52:55], 0
  buffer_load_dwordx4 a[92:95], v22, s[52:55], s81 offen offset:1024 sc1
  v_mfma_f32_16x16x32_bf16 v[36:39], a[132:135], a[52:55], 0
  v_mfma_f32_16x16x32_bf16 v[40:43], a[136:139], a[52:55], 0
  s_waitcnt vmcnt(9)
  v_mfma_f32_16x16x32_bf16 v[44:47], a[124:127], a[56:59], 0
  v_mfma_f32_16x16x32_bf16 v[48:51], a[128:131], a[56:59], 0
  s_mov_b32 s81, 0x3000
  buffer_load_dwordx4 a[96:99], v21, s[52:55], s81 offen sc1
  v_mfma_f32_16x16x32_bf16 v[72:75], a[132:135], a[56:59], 0
  v_mfma_f32_16x16x32_bf16 v[76:79], a[136:139], a[56:59], 0
  s_waitcnt vmcnt(9)
  v_mfma_f32_16x16x32_bf16 v[64:67], a[124:127], a[60:63], 0
  v_mfma_f32_16x16x32_bf16 v[68:71], a[128:131], a[60:63], 0
  buffer_load_dwordx4 a[100:103], v22, s[52:55], s81 offen sc1
  v_mfma_f32_16x16x32_bf16 v[80:83], a[132:135], a[60:63], 0
  v_mfma_f32_16x16x32_bf16 v[84:87], a[136:139], a[60:63], 0
  s_waitcnt vmcnt(9)
  v_mfma_f32_16x16x32_bf16 v[4:7], a[140:143], a[64:67], v[4:7]
  v_mfma_f32_16x16x32_bf16 v[8:11], a[144:147], a[64:67], v[8:11]
  buffer_load_dwordx4 a[104:107], v21, s[52:55], s81 offen offset:1024 sc1
  v_mfma_f32_16x16x32_bf16 v[28:31], a[148:151], a[64:67], v[28:31]
  v_mfma_f32_16x16x32_bf16 v[32:35], a[152:155], a[64:67], v[32:35]
  s_waitcnt vmcnt(9)
  v_mfma_f32_16x16x32_bf16 v[12:15], a[140:143], a[68:71], v[12:15]
  v_mfma_f32_16x16x32_bf16 v[16:19], a[144:147], a[68:71], v[16:19]
  buffer_load_dwordx4 a[108:111], v22, s[52:55], s81 offen offset:1024 sc1
  v_mfma_f32_16x16x32_bf16 v[36:39], a[148:151], a[68:71], v[36:39]
  v_mfma_f32_16x16x32_bf16 v[40:43], a[152:155], a[68:71], v[40:43]
  s_waitcnt vmcnt(9)
  v_mfma_f32_16x16x32_bf16 v[44:47], a[140:143], a[72:75], v[44:47]
  v_mfma_f32_16x16x32_bf16 v[48:51], a[144:147], a[72:75], v[48:51]
  s_mov_b32 s81, 0x4000
  buffer_load_dwordx4 a[112:115], v21, s[52:55], s81 offen sc1
  v_mfma_f32_16x16x32_bf16 v[72:75], a[148:151], a[72:75], v[72:75]
  v_mfma_f32_16x16x32_bf16 v[76:79], a[152:155], a[72:75], v[76:79]
  s_waitcnt vmcnt(9)
  v_mfma_f32_16x16x32_bf16 v[64:67], a[140:143], a[76:79], v[64:67]
  v_mfma_f32_16x16x32_bf16 v[68:71], a[144:147], a[76:79], v[68:71]
  buffer_load_dwordx4 a[116:119], v22, s[52:55], s81 offen sc1
  v_mfma_f32_16x16x32_bf16 v[80:83], a[148:151], a[76:79], v[80:83]
  v_mfma_f32_16x16x32_bf16 v[84:87], a[152:155], a[76:79], v[84:87]
  s_waitcnt vmcnt(9)
  v_mfma_f32_16x16x32_bf16 v[4:7], a[156:159], a[80:83], v[4:7]
  v_mfma_f32_16x16x32_bf16 v[8:11], a[160:163], a[80:83], v[8:11]
  buffer_load_dwordx4 a[120:123], v21, s[52:55], s81 offen offset:1024 sc1
  v_mfma_f32_16x16x32_bf16 v[28:31], a[164:167], a[80:83], v[28:31]
  v_mfma_f32_16x16x32_bf16 v[32:35], a[168:171], a[80:83], v[32:35]
  s_waitcnt vmcnt(9)
  v_mfma_f32_16x16x32_bf16 v[12:15], a[156:159], a[84:87], v[12:15]
  v_mfma_f32_16x16x32_bf16 v[16:19], a[160:163], a[84:87], v[16:19]
  buffer_load_dwordx4 a[220:223], v22, s[52:55], s81 offen offset:1024 sc1
  v_mfma_f32_16x16x32_bf16 v[36:39], a[164:167], a[84:87], v[36:39]
  v_mfma_f32_16x16x32_bf16 v[40:43], a[168:171], a[84:87], v[40:43]
  s_cmp_lg_u32 s26, 0
  s_cbranch_scc1 L_B_rq2
  buffer_load_dword v53, v54, s[48:51], 0 offen sc0 sc1
L_B_rq2:
  s_waitcnt vmcnt(9)
  v_mfma_f32_16x16x32_bf16 v[44:47], a[156:159], a[88:91], v[44:47]
  v_mfma_f32_16x16x32_bf16 v[48:51], a[160:163], a[88:91], v[48:51]
  s_mov_b32 s81, 0x5000
  buffer_load_dwordx4 a[224:227], v21, s[52:55], s81 offen sc1
  v_mfma_f32_16x16x32_bf16 v[72:75], a[164:167], a[88:91], v[72:75]
  v_mfma_f32_16x16x32_bf16 v[76:79], a[168:171], a[88:91], v[76:79]
  s_waitcnt vmcnt(9)
  v_mfma_f32_16x16x32_bf16 v[64:67], a[156:159], a[92:95], v[64:67]
  v_mfma_f32_16x16x32_bf16 v[68:71], a[160:163], a[92:95], v[68:71]
  buffer_load_dwordx4 a[228:231], v22, s[52:55], s81 offen sc1
  v_mfma_f32_16x16x32_bf16 v[80:83], a[164:167], a[92:95], v[80:83]
  v_mfma_f32_16x16x32_bf16 v[84:87], a[168:171], a[92:95], v[84:87]
  s_waitcnt vmcnt(9)
  v_mfma_f32_16x16x32_bf16 v[4:7], a[172:175], a[96:99], v[4:7]
  v_mfma_f32_16x16x32_bf16 v[8:11], a[176:179], a[96:99], v[8:11]
  buffer_load_dwordx4 a[232:235], v21, s[52:55], s81 offen offset:1024 sc1
  v_mfma_f32_16x16x32_bf16 v[28:31], a[180:183], a[96:99], v[28:31]
  v_mfma_f32_16x16x32_bf16 v[32:35], a[184:187], a[96:99], v[32:35]
  s_waitcnt vmcnt(9)
  v_mfma_f32_16x16x32_bf16 v[12:15], a[172:175], a[100:103], v[12:15]
  v_mfma_f32_16x16x32_bf16 v[16:19], a[176:179], a[100:103], v[16:19]
  buffer_load_dwordx4 a[236:239], v22, s[52:55], s81 offen offset:1024 sc1
  v_mfma_f32_16x16x32_bf16 v[36:39], a[180:183], a[100:103], v[36:39]
  v_mfma_f32_16x16x32_bf16 v[40:43], a[184:187], a[100:103], v[40:43]
  s_waitcnt vmcnt(9)
  v_mfma_f32_16x16x32_bf16 v[44:47], a[172:175], a[104:107], v[44:47]
  v_mfma_f32_16x16x32_bf16 v[48:51], a[176:179], a[104:107], v[48:51]
  s_mov_b32 s81, 0x6000
  buffer_load_dwordx4 a[48:51], v21, s[52:55], s81 offen sc1
  v_mfma_f32_16x16x32_bf16 v[72:75], a[180:183], a[104:107], v[72:75]
  v_mfma_f32_16x16x32_bf16 v[76:79], a[184:187], a[104:107], v[76:79]
  s_waitcnt vmcnt(9)
  v_mfma_f32_16x16x32_bf16 v[64:67], a[172:175], a[108:111], v[64:67]
  v_mfma_f32_16x16x32_bf16 v[68:71], a[176:179], a[108:111], v[68:71]
  buffer_load_dwordx4 a[52:55], v22, s[52:55], s81 offen sc1
  v_mfma_f32_16x16x32_bf16 v[80:83], a[180:183], a[108:111], v[80:83]
  v_mfma_f32_16x16x32_bf16 v[84:87], a[184:187], a[108:111], v[84:87]
  s_waitcnt vmcnt(9)
  v_mfma_f32_16x16x32_bf16 v[4:7], a[188:191], a[112:115], v[4:7]
  ds_read_b64_tr_b16 a[0:1], v1
  ds_read_b64_tr_b16 a[2:3], v1 offset:512
  v_mfma_f32_16x16x32_bf16 v[8:11], a[192:195], a[112:115], v[8:11]
  buffer_load_dwordx4 a[56:59], v21, s[52:55], s81 offen offset:1024 sc1
  v_mfma_f32_16x16x32_bf16 v[28:31], a[196:199], a[112:115], v[28:31]
  ds_read_b64_tr_b16 a[4:5], v2
  ds_read_b64_tr_b16 a[6:7], v2 offset:512
  v_mfma_f32_16x16x32_bf16 v[32:35], a[200:203], a[112:115], v[32:35]
  ds_read_b64_tr_b16 a[8:9], v3
  ds_read_b64_tr_b16 a[10:11], v3 offset:512
  s_waitcnt vmcnt(9)
  v_mfma_f32_16x16x32_bf16 v[12:15], a[188:191], a[116:119], v[12:15]
  ds_read_b64_tr_b16 a[12:13], v20
  ds_read_b64_tr_b16 a[14:15], v20 offset:512
  v_mfma_f32_16x16x32_bf16 v[16:19], a[192:195], a[116:119], v[16:19]
  buffer_load_dwordx4 a[60:63], v22, s[52:55], s81 offen offset:1024 sc1
  v_mfma_f32_16x16x32_bf16 v[36:39], a[196:199], a[116:119], v[36:39]
  v_mfma_f32_16x16x32_bf16 v[40:43], a[200:203], a[116:119], v[40:43]
  s_waitcnt vmcnt(9)
  v_mfma_f32_16x16x32_bf16 v[44:47], a[188:191], a[120:123], v[44:47]
  v_mfma_f32_16x16x32_bf16 v[48:51], a[192:195], a[120:123], v[48:51]
  s_mov_b32 s81, 0x7000
  buffer_load_dwordx4 a[64:67], v21, s[52:55], s81 offen sc1
  v_mfma_f32_16x16x32_bf16 v[72:75], a[196:199], a[120:123], v[72:75]
  v_mfma_f32_16x16x32_bf16 v[76:79], a[200:203], a[120:123], v[76:79]
  s_waitcnt vmcnt(9)
  v_mfma_f32_16x16x32_bf16 v[64:67], a[188:191], a[220:223], v[64:67]
  v_mfma_f32_16x16x32_bf16 v[68:71], a[192:195], a[220:223], v[68:71]
  buffer_load_dwordx4 a[68:71], v22, s[52:55], s81 offen sc1
  v_mfma_f32_16x16x32_bf16 v[80:83], a[196:199], a[220:223], v[80:83]
  v_mfma_f32_16x16x32_bf16 v[84:87], a[200:203], a[220:223], v[84:87]
  s_waitcnt vmcnt(9)
  v_mfma_f32_16x16x32_bf16 v[4:7], a[204:207], a[224:227], v[4:7]
  ds_read_b64_tr_b16 a[16:17], v1 offset:4096
  ds_read_b64_tr_b16 a[18:19], v1 offset:4608
  v_mfma_f32_16x16x32_bf16 v[8:11], a[208:211], a[224:227], v[8:11]
  buffer_load_dwordx4 a[72:75], v21, s[52:55], s81 offen offset:1024 sc1
  v_mfma_f32_16x16x32_bf16 v[28:31], a[212:215], a[224:227], v[28:31]
  ds_read_b64_tr_b16 a[20:21], v2 offset:4096
  ds_read_b64_tr_b16 a[22:23], v2 offset:4608
  v_mfma_f32_16x16x32_bf16 v[32:35], a[216:219], a[224:227], v[32:35]
  ds_read_b64_tr_b16 a[24:25], v3 offset:4096
  ds_read_b64_tr_b16 a[26:27], v3 offset:4608
  s_waitcnt vmcnt(9)
  v_mfma_f32_16x16x32_bf16 v[12:15], a[204:207], a[228:231], v[12:15]
  ds_read_b64_tr_b16 a[28:29], v20 offset:4096
  ds_read_b64_tr_b16 a[30:31], v20 offset:4608
  v_mfma_f32_16x16x32_bf16 v[16:19], a[208:211], a[228:231], v[16:19]
  buffer_load_dwordx4 a[76:79], v22, s[52:55], s81 offen offset:1024 sc1
  v_mfma_f32_16x16x32_bf16 v[36:39], a[212:215], a[228:231], v[36:39]
  v_mfma_f32_16x16x32_bf16 v[40:43], a[216:219], a[228:231], v[40:43]
  s_cmp_lg_u32 s26, 0
  s_cbranch_scc1 L_B_ck2
  v_cmp_ne_u32 vcc, s29, v53
  s_nop 4
  s_cbranch_vccz L_B_ck2_ok
  s_mov_b32 s0, 0
L_B_ck2_spin:
  buffer_load_dword v53, v54, s[48:51], 0 offen sc0 sc1
  s_add_u32 s0, s0, 1
  s_waitcnt vmcnt(0)
  s_waitcnt vmcnt(0)
  v_cmp_ne_u32 vcc, s29, v53
  s_cmp_ge_u32 s0, 0x8000
  s_cbranch_scc1 L_B_ck2_ok
  s_nop 2
  s_cbranch_vccnz L_B_ck2_spin
L_B_ck2_ok:
L_B_ck2:
  s_barrier
  s_waitcnt vmcnt(9)
  v_mfma_f32_16x16x32_bf16 v[44:47], a[204:207], a[232:235], v[44:47]
  v_mfma_f32_16x16x32_bf16 v[48:51], a[208:211], a[232:235], v[48:51]
  s_mov_b32 s81, 0x8000
  buffer_load_dwordx4 a[80:83], v21, s[52:55], s81 offen sc1
  v_mfma_f32_16x16x32_bf16 v[72:75], a[212:215], a[232:235], v[72:75]
  v_mfma_f32_16x16x32_bf16 v[76:79], a[216:219], a[232:235], v[76:79]
  buffer_load_dwordx2 v[88:89], v23, s[32:35], 0 offen
  s_waitcnt vmcnt(10)
  v_mfma_f32_16x16x32_bf16 v[64:67], a[204:207], a[236:239], v[64:67]
  v_mfma_f32_16x16x32_bf16 v[68:71], a[208:211], a[236:239], v[68:71]
  buffer_load_dwordx4 a[84:87], v22, s[52:55], s81 offen sc1
  v_mfma_f32_16x16x32_bf16 v[80:83], a[212:215], a[236:239], v[80:83]
  v_mfma_f32_16x16x32_bf16 v[84:87], a[216:219], a[236:239], v[84:87]
  s_waitcnt vmcnt(10) lgkmcnt(0)
  v_mfma_f32_16x16x32_bf16 v[4:7], a[0:3], a[48:51], v[4:7]
  ds_read_b64_tr_b16 a[32:33], v1 offset:8192
  ds_read_b64_tr_b16 a[34:35], v1 offset:8704
  v_mfma_f32_16x16x32_bf16 v[8:11], a[4:7], a[48:51], v[8:11]
  buffer_load_dwordx4 a[88:91], v21, s[52:55], s81 offen offset:1024 sc1
  v_mfma_f32_16x16x32_bf16 v[28:31], a[8:11], a[48:51], v[28:31]
  ds_read_b64_tr_b16 a[36:37], v2 offset:8192
  ds_read_b64_tr_b16 a[38:39], v2 offset:8704
  v_mfma_f32_16x16x32_bf16 v[32:35], a[12:15], a[48:51], v[32:35]
  buffer_load_dwordx2 v[90:91], v23, s[32:35], 0 offen offset:32
  s_waitcnt vmcnt(11)
  v_mfma_f32_16x16x32_bf16 v[12:15], a[0:3], a[52:55], v[12:15]
  ds_read_b64_tr_b16 a[40:41], v3 offset:8192
  ds_read_b64_tr_b16 a[42:43], v3 offset:8704
  v_mfma_f32_16x16x32_bf16 v[16:19], a[4:7], a[52:55], v[16:19]
  buffer_load_dwordx4 a[92:95], v22, s[52:55], s81 offen offset:1024 sc1
  v_mfma_f32_16x16x32_bf16 v[36:39], a[8:11], a[52:55], v[36:39]
  ds_read_b64_tr_b16 a[44:45], v20 offset:8192
  ds_read_b64_tr_b16 a[46:47], v20 offset:8704
  v_mfma_f32_16x16x32_bf16 v[40:43], a[12:15], a[52:55], v[40:43]
  ds_read_b64_tr_b16 a[124:125], v57 offset:8192
  ds_read_b64_tr_b16 a[126:127], v57 offset:8704
  s_waitcnt vmcnt(11)
  v_mfma_f32_16x16x32_bf16 v[44:47], a[0:3], a[56:59], v[44:47]
  ds_read_b64_tr_b16 a[128:129], v58 offset:8192
  ds_read_b64_tr_b16 a[130:131], v58 offset:8704
  v_mfma_f32_16x16x32_bf16 v[48:51], a[4:7], a[56:59], v[48:51]
  s_mov_b32 s81, 0x9000
  buffer_load_dwordx4 a[96:99], v21, s[52:55], s81 offen sc1
  v_mfma_f32_16x16x32_bf16 v[72:75], a[8:11], a[56:59], v[72:75]
  ds_read_b64_tr_b16 a[132:133], v59 offset:8192
  ds_read_b64_tr_b16 a[134:135], v59 offset:8704
  v_mfma_f32_16x16x32_bf16 v[76:79], a[12:15], a[56:59], v[76:79]
  buffer_load_dwordx2 v[92:93], v23, s[32:35], s82 offen
  s_waitcnt vmcnt(12)
  v_mfma_f32_16x16x32_bf16 v[64:67], a[0:3], a[60:63], v[64:67]
  ds_read_b64_tr_b16 a[136:137], v60 offset:8192
  ds_read_b64_tr_b16 a[138:139], v60 offset:8704
  v_mfma_f32_16x16x32_bf16 v[68:71], a[4:7], a[60:63], v[68:71]
  buffer_load_dwordx4 a[100:103], v22, s[52:55], s81 offen sc1
  v_mfma_f32_16x16x32_bf16 v[80:83], a[8:11], a[60:63], v[80:83]
  ds_read_b64_tr_b16 a[140:141], v57 offset:53376
  ds_read_b64_tr_b16 a[142:143], v57 offset:53888
  v_mfma_f32_16x16x32_bf16 v[84:87], a[12:15], a[60:63], v[84:87]
  ds_read_b64_tr_b16 a[144:145], v58 offset:53376
  ds_read_b64_tr_b16 a[146:147], v58 offset:53888
  s_waitcnt vmcnt(12)
  v_mfma_f32_16x16x32_bf16 v[4:7], a[16:19], a[64:67], v[4:7]
  ds_read_b64_tr_b16 a[0:1], v57
  ds_read_b64_tr_b16 a[2:3], v57 offset:512
  v_mfma_f32_16x16x32_bf16 v[8:11], a[20:23], a[64:67], v[8:11]
  buffer_load_dwordx4 a[104:107], v21, s[52:55], s81 offen offset:1024 sc1
  v_mfma_f32_16x16x32_bf16 v[28:31], a[24:27], a[64:67], v[28:31]
  ds_read_b64_tr_b16 a[4:5], v58
  ds_read_b64_tr_b16 a[6:7], v58 offset:512
  v_mfma_f32_16x16x32_bf16 v[32:35], a[28:31], a[64:67], v[32:35]
  buffer_load_dwordx2 v[94:95], v23, s[32:35], s82 offen offset:32
  s_waitcnt vmcnt(13)
  v_mfma_f32_16x16x32_bf16 v[12:15], a[16:19], a[68:71], v[12:15]
  ds_read_b64_tr_b16 a[8:9], v59
  ds_read_b64_tr_b16 a[10:11], v59 offset:512
  v_mfma_f32_16x16x32_bf16 v[16:19], a[20:23], a[68:71], v[16:19]
  buffer_load_dwordx4 a[108:111], v22, s[52:55], s81 offen offset:1024 sc1
  v_mfma_f32_16x16x32_bf16 v[36:39], a[24:27], a[68:71], v[36:39]
  ds_read_b64_tr_b16 a[12:13], v60
  ds_read_b64_tr_b16 a[14:15], v60 offset:512
  v_mfma_f32_16x16x32_bf16 v[40:43], a[28:31], a[68:71], v[40:43]
  ds_read_b64_tr_b16 a[148:149], v59 offset:53376
  ds_read_b64_tr_b16 a[150:151], v59 offset:53888
  s_waitcnt vmcnt(13)
  v_mfma_f32_16x16x32_bf16 v[44:47], a[16:19], a[72:75], v[44:47]
  ds_read_b64_tr_b16 a[152:153], v60 offset:53376
  ds_read_b64_tr_b16 a[154:155], v60 offset:53888
  v_mfma_f32_16x16x32_bf16 v[48:51], a[20:23], a[72:75], v[48:51]
  s_mov_b32 s81, 0xa000
  buffer_load_dwordx4 a[112:115], v21, s[52:55], s81 offen sc1
  v_mfma_f32_16x16x32_bf16 v[72:75], a[24:27], a[72:75], v[72:75]
  ds_read_b64_tr_b16 a[156:157], v57 offset:57472
  ds_read_b64_tr_b16 a[158:159], v57 offset:57984
  v_mfma_f32_16x16x32_bf16 v[76:79], a[28:31], a[72:75], v[76:79]
  ds_read_b64_tr_b16 a[160:161], v58 offset:57472
  ds_read_b64_tr_b16 a[162:163], v58 offset:57984
  s_waitcnt vmcnt(13)
  v_mfma_f32_16x16x32_bf16 v[64:67], a[16:19], a[76:79], v[64:67]
  ds_read_b64_tr_b16 a[164:165], v59 offset:57472
  ds_read_b64_tr_b16 a[166:167], v59 offset:57984
  v_mfma_f32_16x16x32_bf16 v[68:71], a[20:23], a[76:79], v[68:71]
  buffer_load_dwordx4 a[116:119], v22, s[52:55], s81 offen sc1
  v_mfma_f32_16x16x32_bf16 v[80:83], a[24:27], a[76:79], v[80:83]
  ds_read_b64_tr_b16 a[168:169], v60 offset:57472
  ds_read_b64_tr_b16 a[170:171], v60 offset:57984
  v_mfma_f32_16x16x32_bf16 v[84:87], a[28:31], a[76:79], v[84:87]
  s_waitcnt vmcnt(13) lgkmcnt(14)
  v_mfma_f32_16x16x32_bf16 v[4:7], a[32:35], a[80:83], v[4:7]
  ds_read_b64_tr_b16 a[16:17], v57 offset:4096
  ds_read_b64_tr_b16 a[18:19], v57 offset:4608
  v_mfma_f32_16x16x32_bf16 v[8:11], a[36:39], a[80:83], v[8:11]
  buffer_load_dwordx4 a[120:123], v21, s[52:55], s81 offen offset:1024 sc1
  v_mfma_f32_16x16x32_bf16 v[28:31], a[40:43], a[80:83], v[28:31]
  ds_read_b64_tr_b16 a[20:21], v58 offset:4096
  ds_read_b64_tr_b16 a[22:23], v58 offset:4608
  v_mfma_f32_16x16x32_bf16 v[32:35], a[44:47], a[80:83], v[32:35]
  ds_read_b64_tr_b16 a[24:25], v59 offset:4096
  ds_read_b64_tr_b16 a[26:27], v59 offset:4608
  s_waitcnt vmcnt(12)
  v_mfma_f32_16x16x32_bf16 v[12:15], a[32:35], a[84:87], v[12:15]
  ds_read_b64_tr_b16 a[28:29], v60 offset:4096
  ds_read_b64_tr_b16 a[30:31], v60 offset:4608
  v_mfma_f32_16x16x32_bf16 v[16:19], a[36:39], a[84:87], v[16:19]
  buffer_load_dwordx4 a[220:223], v22, s[52:55], s81 offen offset:1024 sc1
  v_mfma_f32_16x16x32_bf16 v[36:39], a[40:43], a[84:87], v[36:39]
  ds_read_b64_tr_b16 a[172:173], v57 offset:61568
  ds_read_b64_tr_b16 a[174:175], v57 offset:62080
  v_mfma_f32_16x16x32_bf16 v[40:43], a[44:47], a[84:87], v[40:43]
  ds_read_b64_tr_b16 a[176:177], v58 offset:61568
  ds_read_b64_tr_b16 a[178:179], v58 offset:62080
  s_waitcnt vmcnt(12)
  v_mfma_f32_16x16x32_bf16 v[44:47], a[32:35], a[88:91], v[44:47]
  ds_read_b64_tr_b16 a[180:181], v59 offset:61568
  ds_read_b64_tr_b16 a[182:183], v59 offset:62080
  v_mfma_f32_16x16x32_bf16 v[48:51], a[36:39], a[88:91], v[48:51]
  s_mov_b32 s81, 0xb000
  buffer_load_dwordx4 a[224:227], v21, s[52:55], s81 offen sc1
  v_mfma_f32_16x16x32_bf16 v[72:75], a[40:43], a[88:91], v[72:75]
  v_lshlrev_b32 v27, 4, v0
  v_add_u32 v97, s3, v27
  v_mfma_f32_16x16x32_bf16 v[76:79], a[44:47], a[88:91], v[76:79]
  s_xor_b32 s86, s26, 1
  s_mul_i32 s86, s86, 0x3000
  s_waitcnt vmcnt(11)
  v_mfma_f32_16x16x32_bf16 v[64:67], a[32:35], a[92:95], v[64:67]
  v_add_u32 v62, s86, v27
  s_xor_b32 s86, s26, 2
  v_mfma_f32_16x16x32_bf16 v[68:71], a[36:39], a[92:95], v[68:71]
  buffer_load_dwordx4 a[228:231], v22, s[52:55], s81 offen sc1
  v_mfma_f32_16x16x32_bf16 v[80:83], a[40:43], a[92:95], v[80:83]
  s_mul_i32 s86, s86, 0x3000
  v_add_u32 v63, s86, v27
  v_mfma_f32_16x16x32_bf16 v[84:87], a[44:47], a[92:95], v[84:87]
  s_xor_b32 s86, s26, 3
  s_mul_i32 s86, s86, 0x3000
  s_waitcnt vmcnt(11)
  v_mfma_f32_16x16x32_bf16 v[4:7], a[0:3], a[96:99], v[4:7]
  v_add_u32 v96, s86, v27
  v_lshrrev_b32 v98, 2, v0
  v_mfma_f32_16x16x32_bf16 v[8:11], a[4:7], a[96:99], v[8:11]
  s_mov_b32 s81, 0xc000
  buffer_load_dwordx4 a[232:235], v21, s[52:55], s81 offen sc1
  v_mfma_f32_16x16x32_bf16 v[28:31], a[8:11], a[96:99], v[28:31]
  v_lshlrev_b32 v98, 8, v98
  v_and_b32 v52, 3, v0
  s_waitcnt lgkmcnt(2)
  v_mfma_f32_16x16x32_bf16 v[32:35], a[12:15], a[96:99], v[32:35]
  v_lshl_add_u32 v98, v52, 4, v98
  v_add_u32 v98, 0x873000, v98
  s_waitcnt vmcnt(10)
  v_mfma_f32_16x16x32_bf16 v[12:15], a[0:3], a[100:103], v[12:15]
  ds_read_b64_tr_b16 a[184:185], v60 offset:61568
  ds_read_b64_tr_b16 a[186:187], v60 offset:62080
  v_mfma_f32_16x16x32_bf16 v[16:19], a[4:7], a[100:103], v[16:19]
  buffer_load_dwordx4 a[236:239], v22, s[52:55], s81 offen sc1
  v_mfma_f32_16x16x32_bf16 v[36:39], a[8:11], a[100:103], v[36:39]
  v_mfma_f32_16x16x32_bf16 v[40:43], a[12:15], a[100:103], v[40:43]
  s_waitcnt vmcnt(10)
  v_mfma_f32_16x16x32_bf16 v[44:47], a[0:3], a[104:107], v[44:47]
  v_mfma_f32_16x16x32_bf16 v[48:51], a[4:7], a[104:107], v[48:51]
  s_mov_b32 s81, 0xd000
  buffer_load_dwordx4 a[48:51], v21, s[52:55], s81 offen sc1
  v_mfma_f32_16x16x32_bf16 v[72:75], a[8:11], a[104:107], v[72:75]
  v_mfma_f32_16x16x32_bf16 v[76:79], a[12:15], a[104:107], v[76:79]
  s_waitcnt vmcnt(9)
  v_mfma_f32_16x16x32_bf16 v[64:67], a[0:3], a[108:111], v[64:67]
  v_mfma_f32_16x16x32_bf16 v[68:71], a[4:7], a[108:111], v[68:71]
  buffer_load_dwordx4 a[52:55], v22, s[52:55], s81 offen sc1
  v_mfma_f32_16x16x32_bf16 v[80:83], a[8:11], a[108:111], v[80:83]
  v_mfma_f32_16x16x32_bf16 v[84:87], a[12:15], a[108:111], v[84:87]
  s_waitcnt vmcnt(9)
  v_mfma_f32_16x16x32_bf16 v[4:7], a[16:19], a[112:115], v[4:7]
  v_mfma_f32_16x16x32_bf16 v[8:11], a[20:23], a[112:115], v[8:11]
  s_mov_b32 s81, 0xe000
  buffer_load_dwordx4 a[56:59], v22, s[52:55], s81 offen sc1
  v_mfma_f32_16x16x32_bf16 v[28:31], a[24:27], a[112:115], v[28:31]
  s_branch L_skip5B
.p2align 12
L_pad5B:
  s_setpc_b64 s[20:21]
L_skip5B:
  v_lshlrev_b32 v100, 16, v88
  v_and_b32 v101, 0xffff0000, v88
  v_mfma_f32_16x16x32_bf16 v[32:35], a[28:31], a[112:115], v[32:35]
  v_lshlrev_b32 v102, 16, v89
  v_and_b32 v103, 0xffff0000, v89
  s_waitcnt vmcnt(9)
  v_mfma_f32_16x16x32_bf16 v[12:15], a[16:19], a[116:119], v[12:15]
  v_lshlrev_b32 v104, 16, v90
  v_and_b32 v105, 0xffff0000, v90
  v_mfma_f32_16x16x32_bf16 v[16:19], a[20:23], a[116:119], v[16:19]
  buffer_load_dwordx4 a[60:63], v21, s[52:55], s81 offen sc1
  v_mfma_f32_16x16x32_bf16 v[36:39], a[24:27], a[116:119], v[36:39]
  v_lshlrev_b32 v106, 16, v91
  v_and_b32 v107, 0xffff0000, v91
  v_mfma_f32_16x16x32_bf16 v[40:43], a[28:31], a[116:119], v[40:43]
  v_lshlrev_b32 v108, 16, v92
  v_and_b32 v109, 0xffff0000, v92
  s_waitcnt vmcnt(9)
  v_mfma_f32_16x16x32_bf16 v[44:47], a[16:19], a[120:123], v[44:47]
  v_lshlrev_b32 v110, 16, v93
  v_and_b32 v111, 0xffff0000, v93
  v_mfma_f32_16x16x32_bf16 v[48:51], a[20:23], a[120:123], v[48:51]
  s_mov_b32 s81, 0xb000
  buffer_load_dwordx4 a[64:67], v21, s[52:55], s81 offen offset:1024 sc1
  v_mfma_f32_16x16x32_bf16 v[72:75], a[24:27], a[120:123], v[72:75]
  v_lshlrev_b32 v112, 16, v94
  v_and_b32 v113, 0xffff0000, v94
  v_mfma_f32_16x16x32_bf16 v[76:79], a[28:31], a[120:123], v[76:79]
  v_lshlrev_b32 v114, 16, v95
  v_and_b32 v115, 0xffff0000, v95
  s_waitcnt vmcnt(9)
  v_mfma_f32_16x16x32_bf16 v[64:67], a[16:19], a[220:223], v[64:67]
  v_mfma_f32_16x16x32_bf16 v[68:71], a[20:23], a[220:223], v[68:71]
  buffer_load_dwordx4 a[68:71], v22, s[52:55], s81 offen offset:1024 sc1
  v_mfma_f32_16x16x32_bf16 v[80:83], a[24:27], a[220:223], v[80:83]
  v_mfma_f32_16x16x32_bf16 v[84:87], a[28:31], a[220:223], v[84:87]
  s_waitcnt vmcnt(9)
  v_mfma_f32_16x16x32_bf16 v[4:7], a[124:127], a[224:227], v[4:7]
  v_mfma_f32_16x16x32_bf16 v[8:11], a[128:131], a[224:227], v[8:11]
  s_mov_b32 s81, 0xc000
  buffer_load_dwordx4 a[72:75], v21, s[52:55], s81 offen offset:1024 sc1
  v_mfma_f32_16x16x32_bf16 v[28:31], a[132:135], a[224:227], v[28:31]
  v_mfma_f32_16x16x32_bf16 v[32:35], a[136:139], a[224:227], v[32:35]
  s_waitcnt vmcnt(9)
  v_mfma_f32_16x16x32_bf16 v[12:15], a[124:127], a[228:231], v[12:15]
  v_mfma_f32_16x16x32_bf16 v[16:19], a[128:131], a[228:231], v[16:19]
  buffer_load_dwordx4 a[76:79], v22, s[52:55], s81 offen offset:1024 sc1
  v_mfma_f32_16x16x32_bf16 v[36:39], a[132:135], a[228:231], v[36:39]
  v_mfma_f32_16x16x32_bf16 v[40:43], a[136:139], a[228:231], v[40:43]
  s_waitcnt vmcnt(9)
  v_mfma_f32_16x16x32_bf16 v[4:7], a[140:143], a[232:235], v[4:7]
  v_mfma_f32_16x16x32_bf16 v[8:11], a[144:147], a[232:235], v[8:11]
  s_mov_b32 s81, 0xd000
  buffer_load_dwordx4 a[80:83], v21, s[52:55], s81 offen offset:1024 sc1
  v_mfma_f32_16x16x32_bf16 v[28:31], a[148:151], a[232:235], v[28:31]
  v_mfma_f32_16x16x32_bf16 v[32:35], a[152:155], a[232:235], v[32:35]
  s_waitcnt vmcnt(9)
  v_mfma_f32_16x16x32_bf16 v[12:15], a[140:143], a[236:239], v[12:15]
  v_mfma_f32_16x16x32_bf16 v[16:19], a[144:147], a[236:239], v[16:19]
  buffer_load_dwordx4 a[84:87], v22, s[52:55], s81 offen offset:1024 sc1
  v_mfma_f32_16x16x32_bf16 v[36:39], a[148:151], a[236:239], v[36:39]
  v_mfma_f32_16x16x32_bf16 v[40:43], a[152:155], a[236:239], v[40:43]
  s_waitcnt vmcnt(9)
  v_mfma_f32_16x16x32_bf16 v[4:7], a[156:159], a[48:51], v[4:7]
  v_mfma_f32_16x16x32_bf16 v[8:11], a[160:163], a[48:51], v[8:11]
  s_mov_b32 s81, 0xe000
  buffer_load_dwordx4 a[88:91], v22, s[52:55], s81 offen offset:1024 sc1
  v_mfma_f32_16x16x32_bf16 v[28:31], a[164:167], a[48:51], v[28:31]
  v_mfma_f32_16x16x32_bf16 v[32:35], a[168:171], a[48:51], v[32:35]
  s_waitcnt vmcnt(9)
  v_mfma_f32_16x16x32_bf16 v[12:15], a[156:159], a[52:55], v[12:15]
  v_mfma_f32_16x16x32_bf16 v[16:19], a[160:163], a[52:55], v[16:19]
  buffer_load_dwordx4 a[92:95], v21, s[52:55], s81 offen offset:1024 sc1
  v_mfma_f32_16x16x32_bf16 v[36:39], a[164:167], a[52:55], v[36:39]
  v_mfma_f32_16x16x32_bf16 v[40:43], a[168:171], a[52:55], v[40:43]
  s_waitcnt vmcnt(9) lgkmcnt(0)
  v_mfma_f32_16x16x32_bf16 v[36:39], a[180:183], a[56:59], v[36:39]
  v_mfma_f32_16x16x32_bf16 v[40:43], a[184:187], a[56:59], v[40:43]
  v_mfma_f32_16x16x32_bf16 v[12:15], a[172:175], a[56:59], v[12:15]
  v_mfma_f32_16x16x32_bf16 v[16:19], a[176:179], a[56:59], v[16:19]
  s_waitcnt vmcnt(8)
  v_mfma_f32_16x16x32_bf16 v[28:31], a[180:183], a[60:63], v[28:31]
  v_mfma_f32_16x16x32_bf16 v[32:35], a[184:187], a[60:63], v[32:35]
  v_mfma_f32_16x16x32_bf16 v[4:7], a[172:175], a[60:63], v[4:7]
  v_mfma_f32_16x16x32_bf16 v[8:11], a[176:179], a[60:63], v[8:11]
  s_waitcnt vmcnt(7)
  v_mfma_f32_16x16x32_bf16 v[44:47], a[124:127], a[64:67], v[44:47]
  v_mfma_f32_16x16x32_bf16 v[48:51], a[128:131], a[64:67], v[48:51]
  ds_write_b128 v97, v[12:15]
  ds_write_b128 v97, v[16:19] offset:1024
  v_mfma_f32_16x16x32_bf16 v[72:75], a[132:135], a[64:67], v[72:75]
  ds_write_b128 v97, v[36:39] offset:4096
  ds_write_b128 v97, v[40:43] offset:5120
  v_mfma_f32_16x16x32_bf16 v[76:79], a[136:139], a[64:67], v[76:79]
  ds_write_b128 v97, v[28:31] offset:2048
  ds_write_b128 v97, v[32:35] offset:3072
  s_waitcnt vmcnt(6)
  v_mfma_f32_16x16x32_bf16 v[64:67], a[124:127], a[68:71], v[64:67]
  v_add_f32 v4, v4, v100
  v_add_f32 v5, v5, v101
  v_mfma_f32_16x16x32_bf16 v[68:71], a[128:131], a[68:71], v[68:71]
  v_add_f32 v6, v6, v102
  v_add_f32 v7, v7, v103
  v_mfma_f32_16x16x32_bf16 v[80:83], a[132:135], a[68:71], v[80:83]
  v_add_f32 v8, v8, v104
  v_add_f32 v9, v9, v105
  v_mfma_f32_16x16x32_bf16 v[84:87], a[136:139], a[68:71], v[84:87]
  s_waitcnt lgkmcnt(0)
  s_barrier
  v_add_f32 v10, v10, v106
  s_waitcnt vmcnt(5)
  v_mfma_f32_16x16x32_bf16 v[44:47], a[140:143], a[72:75], v[44:47]
  v_add_f32 v11, v11, v107
  ds_read_b128 v[12:15], v62
  v_mfma_f32_16x16x32_bf16 v[48:51], a[144:147], a[72:75], v[48:51]
  ds_read_b128 v[16:19], v62 offset:1024
  ds_read_b128 v[28:31], v63 offset:2048
  v_mfma_f32_16x16x32_bf16 v[72:75], a[148:151], a[72:75], v[72:75]
  ds_read_b128 v[32:35], v63 offset:3072
  ds_read_b128 v[36:39], v96 offset:4096
  ds_read_b128 v[40:43], v96 offset:5120
  v_mfma_f32_16x16x32_bf16 v[76:79], a[152:155], a[72:75], v[76:79]
  s_waitcnt lgkmcnt(5)
  v_add_f32 v4, v4, v12
  v_add_f32 v5, v5, v13
  s_waitcnt vmcnt(4)
  v_mfma_f32_16x16x32_bf16 v[64:67], a[140:143], a[76:79], v[64:67]
  v_add_f32 v6, v6, v14
  v_add_f32 v7, v7, v15
  v_mfma_f32_16x16x32_bf16 v[68:71], a[144:147], a[76:79], v[68:71]
  s_waitcnt lgkmcnt(4)
  v_add_f32 v8, v8, v16
  v_add_f32 v9, v9, v17
  v_mfma_f32_16x16x32_bf16 v[80:83], a[148:151], a[76:79], v[80:83]
  v_add_f32 v10, v10, v18
  v_add_f32 v11, v11, v19
  v_mfma_f32_16x16x32_bf16 v[84:87], a[152:155], a[76:79], v[84:87]
  s_waitcnt lgkmcnt(3)
  v_add_f32 v4, v4, v28
  v_add_f32 v5, v5, v29
  s_waitcnt vmcnt(3)
  v_mfma_f32_16x16x32_bf16 v[44:47], a[156:159], a[80:83], v[44:47]
  v_add_f32 v6, v6, v30
  v_add_f32 v7, v7, v31
  v_mfma_f32_16x16x32_bf16 v[48:51], a[160:163], a[80:83], v[48:51]
  s_waitcnt lgkmcnt(2)
  v_add_f32 v8, v8, v32
  v_add_f32 v9, v9, v33
  v_mfma_f32_16x16x32_bf16 v[72:75], a[164:167], a[80:83], v[72:75]
  v_add_f32 v10, v10, v34
  v_add_f32 v11, v11, v35
  v_mfma_f32_16x16x32_bf16 v[76:79], a[168:171], a[80:83], v[76:79]
  s_waitcnt lgkmcnt(1)
  v_add_f32 v4, v4, v36
  v_add_f32 v5, v5, v37
  s_waitcnt vmcnt(2)
  v_mfma_f32_16x16x32_bf16 v[64:67], a[156:159], a[84:87], v[64:67]
  v_add_f32 v6, v6, v38
  v_add_f32 v7, v7, v39
  v_mfma_f32_16x16x32_bf16 v[68:71], a[160:163], a[84:87], v[68:71]
  s_waitcnt lgkmcnt(0)
  v_add_f32 v8, v8, v40
  v_add_f32 v9, v9, v41
  v_mfma_f32_16x16x32_bf16 v[80:83], a[164:167], a[84:87], v[80:83]
  v_add_f32 v10, v10, v42
  v_add_f32 v11, v11, v43
  v_mfma_f32_16x16x32_bf16 v[84:87], a[168:171], a[84:87], v[84:87]
  v_cvt_pk_bf16_f32 v88, v4, v5
  v_cvt_pk_bf16_f32 v89, v6, v7
  s_waitcnt vmcnt(1)
  v_mfma_f32_16x16x32_bf16 v[80:83], a[180:183], a[88:91], v[80:83]
  v_cvt_pk_bf16_f32 v90, v8, v9
  v_cvt_pk_bf16_f32 v91, v10, v11
  v_mfma_f32_16x16x32_bf16 v[84:87], a[184:187], a[88:91], v[84:87]
  v_permlane16_swap_b32 v88, v90
  v_permlane16_swap_b32 v89, v91
  v_mfma_f32_16x16x32_bf16 v[64:67], a[172:175], a[88:91], v[64:67]
  buffer_store_dwordx4 v[88:91], v26, s[64:67], 0 offen sc1
  v_mfma_f32_16x16x32_bf16 v[68:71], a[176:179], a[88:91], v[68:71]
  s_waitcnt vmcnt(1)
  v_mfma_f32_16x16x32_bf16 v[72:75], a[180:183], a[92:95], v[72:75]
  v_mfma_f32_16x16x32_bf16 v[76:79], a[184:187], a[92:95], v[76:79]
  v_mfma_f32_16x16x32_bf16 v[44:47], a[172:175], a[92:95], v[44:47]
  v_mfma_f32_16x16x32_bf16 v[48:51], a[176:179], a[92:95], v[48:51]
  s_or_b32 s87, s2, s26
  s_cmp_lg_u32 s87, 0
  s_cbranch_scc1 L_B_ep0
  buffer_load_dwordx4 v[116:119], v98, s[48:51], 0 offen sc0 sc1
L_B_ep0:
  ds_write_b128 v97, v[64:67] offset:6144
  ds_write_b128 v97, v[68:71] offset:7168
  ds_write_b128 v97, v[80:83] offset:10240
  ds_write_b128 v97, v[84:87] offset:11264
  ds_write_b128 v97, v[72:75] offset:8192
  ds_write_b128 v97, v[76:79] offset:9216
  v_pk_add_f32 v[44:45], v[44:45], v[108:109]
  v_pk_add_f32 v[46:47], v[46:47], v[110:111]
  v_pk_add_f32 v[48:49], v[48:49], v[112:113]
  v_pk_add_f32 v[50:51], v[50:51], v[114:115]
  s_waitcnt lgkmcnt(0)
  s_barrier
  ds_read_b128 v[64:67], v62 offset:6144
  ds_read_b128 v[68:71], v62 offset:7168
  ds_read_b128 v[72:75], v63 offset:8192
  ds_read_b128 v[76:79], v63 offset:9216
  ds_read_b128 v[80:83], v96 offset:10240
  ds_read_b128 v[84:87], v96 offset:11264
  s_waitcnt lgkmcnt(5)
  v_pk_add_f32 v[44:45], v[44:45], v[64:65]
  v_pk_add_f32 v[46:47], v[46:47], v[66:67]
  s_waitcnt lgkmcnt(4)
  v_pk_add_f32 v[48:49], v[48:49], v[68:69]
  v_pk_add_f32 v[50:51], v[50:51], v[70:71]
  s_waitcnt lgkmcnt(3)
  v_pk_add_f32 v[44:45], v[44:45], v[72:73]
  v_pk_add_f32 v[46:47], v[46:47], v[74:75]
  s_waitcnt lgkmcnt(2)
  v_pk_add_f32 v[48:49], v[48:49], v[76:77]
  v_pk_add_f32 v[50:51], v[50:51], v[78:79]
  s_waitcnt lgkmcnt(1)
  v_pk_add_f32 v[44:45], v[44:45], v[80:81]
  v_pk_add_f32 v[46:47], v[46:47], v[82:83]
  s_waitcnt lgkmcnt(0)
  v_pk_add_f32 v[48:49], v[48:49], v[84:85]
  v_pk_add_f32 v[50:51], v[50:51], v[86:87]
  v_cvt_pk_bf16_f32 v92, v44, v45
  v_cvt_pk_bf16_f32 v93, v46, v47
  v_cvt_pk_bf16_f32 v94, v48, v49
  v_cvt_pk_bf16_f32 v95, v50, v51
  s_nop 0
  v_permlane16_swap_b32 v92, v94
  v_permlane16_swap_b32 v93, v95
  buffer_store_dwordx4 v[92:95], v26, s[64:67], s82 offen sc1
  s_cmp_lg_u32 s87, 0
  s_cbranch_scc1 L_B_ep
  s_mov_b32 s0, 0
  s_waitcnt vmcnt(1)
  s_branch L_B_ep_chk
L_B_ep_spin:
  buffer_load_dwordx4 v[116:119], v98, s[48:51], 0 offen sc0 sc1
  s_add_u32 s0, s0, 1
  s_waitcnt vmcnt(0)
L_B_ep_chk:
  v_xor_b32 v116, s29, v116
  v_xor_b32 v117, s29, v117
  v_xor_b32 v118, s29, v118
  v_xor_b32 v119, s29, v119
  v_or_b32 v116, v116, v117
  v_or3_b32 v116, v116, v118, v119
  v_cmp_ne_u32 vcc, 0, v116
  s_cmp_ge_u32 s0, 0x8000
  s_cbranch_scc1 L_B_ep_go
  s_nop 2
  s_cbranch_vccnz L_B_ep_spin
L_B_ep_go:
  v_mov_b32 v27, 0x874000
  v_mov_b32 v52, s29
  s_mov_b64 exec, 1
  buffer_store_dword v52, v27, s[48:51], 0 offen sc0 sc1
  s_mov_b64 exec, -1
L_B_ep:
  s_branch L_end
L_end:
  s_endpgm
.section .rodata,"a"
.p2align 6
.amdhsa_kernel parallel_sum__sliding_local_dilated__geglu_ffn__prompt_kernel
  .amdhsa_next_free_vgpr 512
  .amdhsa_next_free_sgpr 102
  .amdhsa_accum_offset 256
  .amdhsa_group_segment_fixed_size 0
  .amdhsa_kernarg_size 80
  .amdhsa_user_sgpr_count 2
  .amdhsa_user_sgpr_kernarg_segment_ptr 1
  .amdhsa_system_sgpr_workgroup_id_x 1
.end_amdhsa_kernel
```
